```python
import torch

def _softmax(x, axis=-1):
    return torch.softmax(x, dim=axis)
def _gelu(x):
    return torch.nn.functional.gelu(x, approximate="tanh")
def _silu(x):
    return torch.nn.functional.silu(x)
def _sigmoid(x):
    return torch.sigmoid(x)
def _layernorm(x, axis=-1, eps=1e-5):
    m = x.mean(dim=axis, keepdim=True)
    v = x.var(dim=axis, keepdim=True, unbiased=False)
    return (x - m) / torch.sqrt(v + eps)
def _scatter_add(tgt, idx, src, axis=0):
    return tgt.clone().index_add_(axis, idx, src)
def _segment_sum(src, seg, n):
    out = torch.zeros((n,) + src.shape[1:], dtype=src.dtype)
    return out.index_add_(0, seg, src)
def _pad(x, pw):
    flat = tuple(v for pair in reversed(pw) for v in pair)
    return torch.nn.functional.pad(x, flat)

kernel_name = 'parallel_sum__ssm_conv_s5__mixer_channel_mlp__prompt'

def setup_inputs():

    _w = (lambda a: (lambda t: t.to(torch.bfloat16) if t.is_floating_point() else t)(torch.as_tensor(a)))
    def _A_setup():
        B, S, D = 1, 2048, 640
        P = D
        Lambda_re = -0.5 * (lambda _x: torch.exp(torch.as_tensor(_x)))((lambda *s: torch.randn(*s, dtype=torch.bfloat16) * 0.2)(P))
        Lambda_im = (lambda *s: torch.randn(*s, dtype=torch.bfloat16) * 0.8)(P) * 1.0
        B_re = (lambda *s: torch.randn(*s, dtype=torch.bfloat16) * 0.2)(P, D) * (D ** -0.5)
        B_im = (lambda *s: torch.randn(*s, dtype=torch.bfloat16) * 0.2)(P, D) * (D ** -0.5)
        C_re = (lambda *s: torch.randn(*s, dtype=torch.bfloat16) * 0.2)(D, P) * (P ** -0.5)
        C_im = (lambda *s: torch.randn(*s, dtype=torch.bfloat16) * 0.2)(D, P) * (P ** -0.5)
        log_dt = (lambda *s: torch.randn(*s, dtype=torch.bfloat16) * 0.2)(P) * 0.3 - 2.0
        Dskip = (lambda *s: torch.randn(*s, dtype=torch.bfloat16) * 0.05)(D)
        return {
            "x": _w((lambda *s: torch.randn(*s, dtype=torch.bfloat16) * 0.05)(B, S, D)),
            "Lambda_re": _w(Lambda_re),
            "Lambda_im": _w(Lambda_im),
            "B_re": _w(B_re),
            "B_im": _w(B_im),
            "C_re": _w(C_re),
            "C_im": _w(C_im),
            "log_dt": _w(log_dt),
            "Dskip": _w(Dskip),
        }
    _A_in = _A_setup()

    def _B_setup():
        B, S, D, F = 1, 2048, 640, 1536
        return {
            "x": _w((lambda *s: torch.randn(*s, dtype=torch.bfloat16) * 0.05)(B, S, D)),
            "w1": _w((lambda *s: torch.randn(*s, dtype=torch.bfloat16) * 1.6)(D, F) * (D ** -0.5)),
            "b1": _w((lambda *s: torch.randn(*s, dtype=torch.bfloat16) * 0.8)(F)),
            "w2": _w((lambda *s: torch.randn(*s, dtype=torch.bfloat16) * 0.05)(F, D) * (F ** -0.5)),
            "b2": _w((lambda *s: torch.randn(*s, dtype=torch.bfloat16) * 0.05)(D)),
        }
    _B_in = _B_setup()

    return {
        "A_x": _A_in["x"],
        "A_Lambda_re": _A_in["Lambda_re"],
        "A_Lambda_im": _A_in["Lambda_im"],
        "A_B_re": _A_in["B_re"],
        "A_B_im": _A_in["B_im"],
        "A_C_re": _A_in["C_re"],
        "A_C_im": _A_in["C_im"],
        "A_log_dt": _A_in["log_dt"],
        "A_Dskip": _A_in["Dskip"],
        "B_x": _B_in["x"],
        "B_w1": _B_in["w1"],
        "B_b1": _B_in["b1"],
        "B_w2": _B_in["w2"],
        "B_b2": _B_in["b2"],
    }

def reference(A_x, A_Lambda_re, A_Lambda_im, A_B_re, A_B_im, A_C_re, A_C_im, A_log_dt, A_Dskip, B_x, B_w1, B_b1, B_w2, B_b2):
    def _A_ref(x, Lambda_re, Lambda_im, B_re, B_im, C_re, C_im, log_dt, Dskip):
        Bsz, L, H = x.shape
        Lam = Lambda_re + 1j * Lambda_im
        Bmat = B_re + 1j * B_im
        Cmat = C_re + 1j * C_im
        dt = torch.exp(log_dt)
        Lam_bar = torch.exp(dt * Lam)
        B_bar = ((Lam_bar - 1.0) / Lam)[:, None] * Bmat
        Bu = torch.einsum("bld,pd->blp", x + 0j, B_bar)
        h = torch.zeros_like(Bu[:, 0, :])
        hs = []
        for t in range(L):
            h = Lam_bar[None, :] * h + Bu[:, t, :]
            hs.append(h)
        hseq = torch.stack(hs, 1)
        y = 2.0 * torch.einsum("blp,dp->bld", hseq, Cmat).real + x * Dskip[None, None, :]
        return y

    def _B_ref(x, w1, b1, w2, b2):
        y = _layernorm(x, axis=-1)
        h = _gelu(torch.einsum("bsd,df->bsf", y, w1) + b1)
        return torch.einsum("bsf,fd->bsd", h, w2) + b2

    x = A_x
    xn = _layernorm(x, axis=-1)
    return x + _A_ref(xn, A_Lambda_re, A_Lambda_im, A_B_re, A_B_im, A_C_re, A_C_im, A_log_dt, A_Dskip) + _B_ref(xn, B_w1, B_b1, B_w2, B_b2)
```

```asm
; @launch grid=(256,1,1) block=(256,1,1) lds=163840
.amdgcn_target "amdgcn-amd-amdhsa--gfx950"
.text
.globl parallel_sum__ssm_conv_s5__mixer_channel_mlp__prompt_kernel
.p2align 8
.type parallel_sum__ssm_conv_s5__mixer_channel_mlp__prompt_kernel,@function
parallel_sum__ssm_conv_s5__mixer_channel_mlp__prompt_kernel:
    s_cmp_ge_u32 s2, 256
    s_cbranch_scc1 L_end
    s_load_dwordx16 s[64:79], s[0:1], 0
    s_load_dwordx16 s[80:95], s[0:1], 64
    s_load_dwordx2 s[96:97], s[0:1], 128
    s_getpc_b64 s[48:49]
L_pc:
    s_bitcmp1_b32 s2, 0
    s_cselect_b32 s50, L_second-L_pc, 0
    s_add_u32 s48, s48, s50
    s_addc_u32 s49, s49, 0
    s_lshr_b32 s50, s2, 3
    s_lshl_b32 s50, s50, 10
    v_lshl_add_u32 v254, v0, 2, s50
    v_min_u32 v254, L_end-L_second, v254
    global_load_dword v254, v254, s[48:49]
    s_bitcmp1_b32 s2, 0
    s_cbranch_scc1 L_second
    v_lshrrev_b32 v1, 6, v0
    v_and_b32 v0, 63, v0
    v_readfirstlane_b32 s3, v1
    s_bfe_u32 s48, s2, 0x20001
    s_lshr_b32 s49, s2, 6
    s_lshl_b32 s30, s49, 2
    s_add_u32 s30, s30, s48
    s_bfe_u32 s31, s2, 0x30003
    s_lshl_b32 s48, s30, 3
    s_add_u32 s48, s48, s31
    s_lshl_b32 s48, s48, 2
    s_add_u32 s33, s48, s3
    s_lshl_b32 s34, s33, 6
    s_lshl_b32 s45, s3, 12
    s_lshl_b32 s50, s30, 7
    s_lshl_b32 s51, s3, 5
    s_add_u32 s50, s50, s51
    s_mul_i32 s36, s50, 1280
    v_lshrrev_b32 v11, 4, v0
    v_and_b32 v13, 7, v0
    v_xor_b32 v12, v13, v11
    v_lshlrev_b32 v12, 4, v12
    v_lshrrev_b32 v3, 3, v0
    v_mul_u32_u24 v3, 1280, v3
    v_lshl_add_u32 v253, v13, 4, v3
    v_add_u32 v3, v3, v12
    v_lshlrev_b32 v252, 4, v0
    v_lshrrev_b32 v13, 3, v0
    v_and_b32 v13, 3, v13
    v_lshrrev_b32 v15, 5, v0
    v_lshl_add_u32 v13, v15, 3, v13
    v_mul_u32_u24 v1, 1280, v13
    v_add_u32 v1, v1, v12
    v_xor_b32 v2, 64, v1
    s_and_b32 s52, s3, 1
    s_lshl_b32 s49, s52, 6
    v_xor_b32 v3, s49, v3
    v_xor_b32 v4, 64, v3
    s_add_u32 s37, s36, 19456
    s_add_u32 s38, s36, 3072
    s_add_u32 s39, s36, 22528
    s_lshr_b32 s48, s30, 2
    s_add_u32 s2, s48, s31
    s_and_b32 s2, s2, 1
    s_mov_b32 s0, s2
    s_lshl_b32 s1, s2, 7
    v_add_u32 v1, s1, v1
    v_add_u32 v2, s1, v2
    v_add_u32 v3, s1, v3
    v_add_u32 v4, s1, v4
    s_waitcnt lgkmcnt(0)
    s_load_dword s28, s[96:97], 0
    s_mov_b32 s4, s64
    s_mov_b32 s5, s65
    s_mov_b32 s6, 2621440
    s_mov_b32 s7, 0x20000
    s_mov_b32 s12, s96
    s_mov_b32 s13, s97
    s_mov_b32 s14, 22020096
    s_mov_b32 s15, 0x20000
    s_add_u32 m0, s45, 16384
    s_nop 0
    buffer_load_dwordx4 v1, s[4:7], s36 offen offset:0 lds
    buffer_load_dwordx4 v2, s[4:7], s37 offen offset:1024 lds
    buffer_load_dwordx4 v1, s[4:7], s38 offen offset:2048 lds
    buffer_load_dwordx4 v2, s[4:7], s39 offen offset:3072 lds
    s_cmp_lt_u32 s3, 2
    s_cselect_b32 s8, s70, s72
    s_cselect_b32 s9, s71, s73
    s_mov_b32 s10, 819200
    s_mov_b32 s11, 0x20000
    s_mul_i32 s55, s31, 80
    s_mul_i32 s51, s52, 40
    s_add_u32 s50, s55, s51
    s_mul_i32 s40, s50, 1280
    s_add_u32 s41, s40, 9216
    s_add_u32 s42, s40, 18432
    s_add_u32 s43, s40, 27648
    s_add_u32 s44, s40, 40960
    s_mul_i32 s46, s3, 5120
    s_add_u32 m0, s46, 32768
    s_nop 0
    buffer_load_dwordx4 v3, s[8:11], s40 offen offset:0 lds
    v_mul_u32_u24 v223, 3277, v0
    v_lshrrev_b32 v223, 16, v223
    v_mul_u32_u24 v224, 20, v223
    v_sub_u32 v224, v0, v224
    s_mul_i32 s49, s3, 20
    v_add_u32 v224, s49, v224
    v_add_lshl_u32 v220, v224, s55, 1
    s_cmp_lt_u32 s30, 8
    s_cselect_b32 s20, s70, s72
    s_cselect_b32 s21, s71, s73
    s_mov_b32 s22, 819200
    s_mov_b32 s23, 0x20000
    s_mul_i32 s52, s3, 3
    s_and_b32 s50, s30, 7
    s_mul_i32 s50, s50, 10
    buffer_load_dwordx4 v4, s[8:11], s41 offen offset:1024 lds
    s_add_u32 s50, s50, s55
    s_add_u32 s53, s50, s52
    s_mul_i32 s51, s31, 160
    s_mul_i32 s54, s30, 10
    s_add_u32 s51, s51, s54
    s_add_u32 s51, s51, s52
    s_lshl_b32 s51, s51, 4
    buffer_load_dwordx4 v3, s[8:11], s42 offen offset:2048 lds
    s_add_u32 s61, s51, 397312
    s_cmp_eq_u32 s3, 3
    s_cselect_b32 s49, 0, 2
    v_min_u32 v14, s49, v11
    v_mul_u32_u24 v15, 1280, v14
    v_and_b32 v13, 15, v0
    v_lshl_add_u32 v15, v13, 4, v15
    buffer_load_dwordx4 v4, s[8:11], s43 offen offset:3072 lds
    v_lshlrev_b32 v14, 4, v14
    s_mul_i32 s53, s53, 1280
    s_sub_u32 s48, s33, 400
    s_cmp_lt_u32 s33, 400
    s_cselect_b32 s62, s33, s48
    s_mul_i32 s50, s62, 6554
    s_lshr_b32 s50, s50, 16
    s_mul_i32 s48, s50, 10
    s_add_u32 m0, s46, 36864
    s_nop 0
    buffer_load_dwordx4 v3, s[8:11], s44 offen offset:0 lds
    s_sub_u32 s48, s62, s48
    s_mul_i32 s49, s50, 20480
    s_lshl_b32 s51, s48, 7
    s_add_u32 s54, s49, s51
    s_add_u32 s55, s54, 9216
    s_mul_i32 s51, s50, 40
    s_lshl_b32 s52, s48, 2
    global_load_ushort v218, v220, s[66:67]
    global_load_ushort v219, v220, s[68:69]
    global_load_ushort v220, v220, s[78:79]
    s_add_u32 s51, s51, s52
    s_lshl_b32 s51, s51, 10
    s_add_u32 s58, s51, 458752
    s_lshl_b32 s62, s62, 6
    s_add_u32 s62, s62, 4096
    s_mul_i32 s56, s31, 2560
    s_add_u32 m0, s45, 53248
    s_xor_b32 s1, s2, 1
    s_sub_u32 s66, s1, s0
    s_mov_b32 s0, s1
    s_lshl_b32 s66, s66, 7
    v_add_u32 v1, s66, v1
    buffer_load_dwordx4 v1, s[4:7], s36 offen offset:0 lds
    s_mul_i32 s48, s3, 640
    s_add_u32 s56, s56, s48
    s_add_u32 s56, s56, 397312
    s_lshl_b32 s57, s30, 11
    s_lshl_b32 s48, s3, 9
    s_add_u32 s57, s57, s48
    s_add_u32 s57, s57, 364544
    v_add_u32 v2, s66, v2
    buffer_load_dwordx4 v2, s[4:7], s37 offen offset:1024 lds
    v_and_b32 v11, 15, v0
    v_lshrrev_b32 v12, 4, v0
    v_lshrrev_b32 v13, 1, v11
    v_xor_b32 v13, v13, v12
    v_lshlrev_b32 v13, 4, v13
    v_lshl_add_u32 v13, v11, 7, v13
    v_add_u32 v5, 16384, v13
    v_add_u32 v5, s45, v5
    v_xor_b32 v6, 64, v5
    v_add_u32 v7, 32768, v13
    v_xor_b32 v8, 64, v7
    buffer_load_dwordx4 v1, s[4:7], s38 offen offset:2048 lds
    v_add_u32 v9, 73728, v5
    v_add_u32 v10, 73728, v6
    v_add_u32 v250, 73728, v7
    v_add_u32 v251, 73728, v8
    v_lshlrev_b32 v13, 7, v11
    buffer_load_dwordx4 v2, s[4:7], s39 offen offset:3072 lds
    v_lshrrev_b32 v12, 5, v0
    v_lshl_add_u32 v13, v12, 11, v13
    v_bfe_u32 v12, v0, 4, 1
    v_lshl_add_u32 v13, v12, 4, v13
    v_add_u32 v13, s45, v13
    s_add_u32 m0, s46, 69632
    v_add_u32 v3, s66, v3
    buffer_load_dwordx4 v3, s[8:11], s40 offen offset:0 lds
    v_mul_u32_u24 v11, 184, v11
    v_mul_u32_u24 v225, 184, v224
    v_and_b32 v216, 31, v0
    v_lshlrev_b32 v216, 4, v216
    v_min_u32 v217, 39, v0
    v_add_u32 v4, s66, v4
    buffer_load_dwordx4 v4, s[8:11], s41 offen offset:1024 lds
    v_lshlrev_b32 v217, 4, v217
    s_mul_i32 s60, s3, 10
    s_lshr_b32 s60, s60, 2
    s_mul_i32 s51, s31, 50
    s_add_u32 s60, s60, s51
    buffer_load_dwordx4 v3, s[8:11], s42 offen offset:2048 lds
    s_lshl_b32 s60, s60, 6
    s_add_u32 s60, s60, 4096
    s_mul_i32 s47, s31, 200
    s_mul_i32 s51, s3, 10
    s_add_u32 s47, s47, s51
    buffer_load_dwordx4 v4, s[8:11], s43 offen offset:3072 lds
    s_lshl_b32 s47, s47, 10
    s_add_u32 s47, s47, 458752
    s_mov_b32 s24, s74
    s_and_b32 s25, s75, 0xffff
    s_mov_b32 s26, 819200
    s_add_u32 m0, s46, 73728
    s_nop 0
    buffer_load_dwordx4 v3, s[8:11], s44 offen offset:0 lds
    s_mov_b32 s27, 0x20000
    s_mov_b32 s16, s76
    s_and_b32 s17, s77, 0xffff
    s_mov_b32 s18, 819200
    s_mov_b32 s19, 0x20000
    s_waitcnt lgkmcnt(0)
    s_bitcmp1_b32 s28, 0
    s_cselect_b32 s32, 0x10000, 1
    s_cselect_b32 s82, 2, 1
    s_mul_i32 s28, s28, 0x9E3779B1
    s_add_u32 s28, s28, 0x7F4A7C15
    s_and_b32 s28, s28, 0xfffefffc
    s_or_b32 s28, s28, s32
    s_or_b32 s28, s28, s82
    s_xor_b32 s29, s28, 0x5bd1e995
    s_brev_b32 s29, s29
    s_mov_b32 s83, 0xfffefffe
    v_and_b32 v16, 1, v0
    v_lshlrev_b32 v16, 4, v16
    v_lshrrev_b32_e64 v16, v16, s32
    v_and_b32 v16, 1, v16
    v_mul_u32_u24 v16, 0x10001, v16
    s_cmp_lt_u32 s3, 2
    s_cselect_b32 s83, s83, -1
    s_cselect_b32 s48, -1, 0
    v_and_b32 v16, s48, v16
    v_accvgpr_write_b32 a211, v16
    s_waitcnt vmcnt(12)
    s_barrier
L_ssm_code:
    ds_read_b128 v[96:99], v5 offset:0
    ds_read_b128 v[100:103], v5 offset:2048
    ds_read_b128 v[104:107], v7 offset:0
    ds_read_b128 v[108:111], v7 offset:2048
    ds_read_b128 v[112:115], v7 offset:4096
    ds_read_b128 v[116:119], v7 offset:6144
    ds_read_b128 v[120:123], v7 offset:8192
    ds_read_b128 v[124:127], v7 offset:10240
    ds_read_b128 v[128:131], v7 offset:12288
    ds_read_b128 v[132:135], v7 offset:14336
    ds_read_b128 v[136:139], v7 offset:16384
    ds_read_b128 v[140:143], v7 offset:18432
    s_waitcnt lgkmcnt(9)
    v_mfma_f32_16x16x32_bf16 v[16:19], v[96:99], v[104:107], 0
    buffer_load_dwordx4 v[192:195], v15, s[20:23], s53 offen offset:0
    ds_read_b128 v[144:147], v6 offset:0
    v_mfma_f32_16x16x32_bf16 v[56:59], v[100:103], v[104:107], 0
    ds_read_b128 v[148:151], v6 offset:2048
    s_waitcnt vmcnt(10)
    s_waitcnt lgkmcnt(10)
    v_mfma_f32_16x16x32_bf16 v[20:23], v[96:99], v[108:111], 0
    buffer_load_dwordx4 v[196:199], v15, s[20:23], s53 offen offset:256
    v_lshlrev_b32 v220, 16, v220
    v_mfma_f32_16x16x32_bf16 v[60:63], v[100:103], v[108:111], 0
    ds_read_b128 v[152:155], v8 offset:0
    v_mul_f32 v220, 0x3fb8aa3b, v220
    s_waitcnt lgkmcnt(10)
    v_mfma_f32_16x16x32_bf16 v[24:27], v[96:99], v[112:115], 0
    ds_read_b128 v[156:159], v8 offset:2048
    v_exp_f32 v220, v220
    v_mfma_f32_16x16x32_bf16 v[64:67], v[100:103], v[112:115], 0
    buffer_load_dwordx4 v[200:203], v15, s[20:23], s53 offen offset:512
    v_lshlrev_b32 v218, 16, v218
    s_waitcnt lgkmcnt(10)
    v_mfma_f32_16x16x32_bf16 v[28:31], v[96:99], v[116:119], 0
    ds_read_b128 v[160:163], v8 offset:4096
    v_lshlrev_b32 v219, 16, v219
    v_mfma_f32_16x16x32_bf16 v[68:71], v[100:103], v[116:119], 0
    ds_read_b128 v[164:167], v8 offset:6144
    v_cvt_pk_bf16_f32 v220, v220, v220
    s_waitcnt lgkmcnt(11)
    v_mfma_f32_16x16x32_bf16 v[32:35], v[96:99], v[120:123], 0
    buffer_load_dwordx4 v[204:207], v15, s[20:23], s53 offen offset:768
    v_and_b32 v220, 0xffff0000, v220
    v_mfma_f32_16x16x32_bf16 v[72:75], v[100:103], v[120:123], 0
    ds_read_b128 v[168:171], v8 offset:8192
    v_mul_f32 v221, v218, v220
    s_waitcnt lgkmcnt(11)
    v_mfma_f32_16x16x32_bf16 v[36:39], v[96:99], v[124:127], 0
    ds_read_b128 v[172:175], v8 offset:10240
    v_mul_f32 v222, v219, v220
    v_mfma_f32_16x16x32_bf16 v[76:79], v[100:103], v[124:127], 0
    buffer_load_dwordx4 v[208:211], v15, s[20:23], s53 offen offset:1024
    v_mul_f32 v221, 0x3fb8aa3b, v221
    s_waitcnt lgkmcnt(11)
    v_mfma_f32_16x16x32_bf16 v[40:43], v[96:99], v[128:131], 0
    ds_read_b128 v[176:179], v8 offset:12288
    v_mul_f32 v222, 0.15915494, v222
    v_mfma_f32_16x16x32_bf16 v[80:83], v[100:103], v[128:131], 0
    ds_read_b128 v[180:183], v8 offset:14336
    s_add_u32 m0, s45, 90112
    s_xor_b32 s1, s2, 2
    s_sub_u32 s66, s1, s0
    s_mov_b32 s0, s1
    s_lshl_b32 s66, s66, 7
    v_add_u32 v1, s66, v1
    s_waitcnt lgkmcnt(12)
    v_mfma_f32_16x16x32_bf16 v[44:47], v[96:99], v[132:135], 0
    buffer_load_dwordx4 v1, s[4:7], s36 offen offset:0 lds
    v_accvgpr_write_b32 a250, v221
    v_mfma_f32_16x16x32_bf16 v[84:87], v[100:103], v[132:135], 0
    ds_read_b128 v[184:187], v8 offset:16384
    v_accvgpr_write_b32 a251, v222
    s_waitcnt lgkmcnt(12)
    v_mfma_f32_16x16x32_bf16 v[48:51], v[96:99], v[136:139], 0
    ds_read_b128 v[188:191], v8 offset:18432
    v_add_u32 v2, s66, v2
    v_mfma_f32_16x16x32_bf16 v[88:91], v[100:103], v[136:139], 0
    buffer_load_dwordx4 v2, s[4:7], s37 offen offset:1024 lds
    v_accvgpr_write_b32 a252, v218
    s_waitcnt lgkmcnt(12)
    v_mfma_f32_16x16x32_bf16 v[52:55], v[96:99], v[140:143], 0
    buffer_load_dwordx4 v1, s[4:7], s38 offen offset:2048 lds
    v_accvgpr_write_b32 a253, v219
    v_mfma_f32_16x16x32_bf16 v[92:95], v[100:103], v[140:143], 0
    buffer_load_dwordx4 v2, s[4:7], s39 offen offset:3072 lds
    v_mov_b32 v232, 0x41000000
    s_add_u32 m0, s46, 106496
    v_add_u32 v3, s66, v3
    s_waitcnt lgkmcnt(8)
    v_mfma_f32_16x16x32_bf16 v[16:19], v[144:147], v[152:155], v[16:19]
    buffer_load_dwordx4 v3, s[8:11], s40 offen offset:0 lds
    v_add_u32 v4, s66, v4
    v_mfma_f32_16x16x32_bf16 v[56:59], v[148:151], v[152:155], v[56:59]
    buffer_load_dwordx4 v4, s[8:11], s41 offen offset:1024 lds
    v_mul_f32 v233, 1.0, v222
    v_mfma_f32_16x16x32_bf16 v[20:23], v[144:147], v[156:159], v[20:23]
    buffer_load_dwordx4 v3, s[8:11], s42 offen offset:2048 lds
    v_mul_f32 v235, v232, v222
    v_mfma_f32_16x16x32_bf16 v[60:63], v[148:151], v[156:159], v[60:63]
    s_waitcnt vmcnt(12) lgkmcnt(0)
    s_barrier
    v_mfma_f32_16x16x32_bf16 v[24:27], v[144:147], v[160:163], v[24:27]
    ds_read_b128 v[96:99], v5 offset:36864
    v_mul_f32 v240, 1.0, v221
    v_mfma_f32_16x16x32_bf16 v[64:67], v[148:151], v[160:163], v[64:67]
    buffer_load_dwordx4 v4, s[8:11], s43 offen offset:3072 lds
    ds_read_b128 v[100:103], v5 offset:38912
    v_mfma_f32_16x16x32_bf16 v[28:31], v[144:147], v[164:167], v[28:31]
    ds_read_b128 v[104:107], v7 offset:36864
    s_add_u32 m0, s46, 110592
    v_mfma_f32_16x16x32_bf16 v[68:71], v[148:151], v[164:167], v[68:71]
    buffer_load_dwordx4 v3, s[8:11], s44 offen offset:0 lds
    v_mul_f32 v248, v232, v221
    v_mfma_f32_16x16x32_bf16 v[32:35], v[144:147], v[168:171], v[32:35]
    ds_read_b128 v[108:111], v7 offset:38912
    s_add_u32 m0, s45, 0
    v_mfma_f32_16x16x32_bf16 v[72:75], v[148:151], v[168:171], v[72:75]
    buffer_load_dwordx4 v253, s[24:27], s54 offen offset:0 lds
    ds_read_b128 v[112:115], v7 offset:40960
    v_mfma_f32_16x16x32_bf16 v[36:39], v[144:147], v[172:175], v[36:39]
    ds_read_b128 v[116:119], v7 offset:43008
    v_fract_f32 v233, v233
    v_mfma_f32_16x16x32_bf16 v[76:79], v[148:151], v[172:175], v[76:79]
    buffer_load_dwordx4 v253, s[24:27], s55 offen offset:1024 lds
    v_fract_f32 v235, v235
    v_mfma_f32_16x16x32_bf16 v[40:43], v[144:147], v[176:179], v[40:43]
    ds_read_b128 v[120:123], v7 offset:45056
    v_exp_f32 v240, v240
    v_mfma_f32_16x16x32_bf16 v[80:83], v[148:151], v[176:179], v[80:83]
    ds_read_b128 v[124:127], v7 offset:47104
    v_exp_f32 v248, v248
    v_mfma_f32_16x16x32_bf16 v[44:47], v[144:147], v[180:183], v[44:47]
    ds_read_b128 v[128:131], v7 offset:49152
    s_add_u32 m0, s45, 2048
    v_mfma_f32_16x16x32_bf16 v[84:87], v[148:151], v[180:183], v[84:87]
    buffer_load_dwordx4 v253, s[16:19], s54 offen offset:0 lds
    v_sin_f32 v241, v233
    v_mfma_f32_16x16x32_bf16 v[48:51], v[144:147], v[184:187], v[48:51]
    ds_read_b128 v[132:135], v7 offset:51200
    v_sin_f32 v249, v235
    v_mfma_f32_16x16x32_bf16 v[88:91], v[148:151], v[184:187], v[88:91]
    ds_read_b128 v[136:139], v7 offset:53248
    v_cos_f32 v233, v233
    v_mfma_f32_16x16x32_bf16 v[52:55], v[144:147], v[188:191], v[52:55]
    ds_read_b128 v[140:143], v7 offset:55296
    v_cos_f32 v235, v235
    v_mfma_f32_16x16x32_bf16 v[92:95], v[148:151], v[188:191], v[92:95]
    buffer_load_dwordx4 v253, s[16:19], s55 offen offset:1024 lds
    v_mul_f32 v241, v241, v240
    s_waitcnt lgkmcnt(6)
    v_mfma_f32_16x16x32_bf16 v[16:19], v[96:99], v[104:107], v[16:19]
    ds_read_b128 v[144:147], v6 offset:36864
    v_mul_f32 v249, v249, v248
    v_mfma_f32_16x16x32_bf16 v[56:59], v[100:103], v[104:107], v[56:59]
    ds_read_b128 v[148:151], v6 offset:38912
    s_add_u32 m0, s45, 126976
    s_xor_b32 s1, s2, 3
    s_sub_u32 s66, s1, s0
    s_mov_b32 s0, s1
    s_lshl_b32 s66, s66, 7
    v_add_u32 v1, s66, v1
    v_mfma_f32_16x16x32_bf16 v[20:23], v[96:99], v[108:111], v[20:23]
    buffer_load_dwordx4 v1, s[4:7], s36 offen offset:0 lds
    v_mul_f32 v240, v233, v240
    v_mfma_f32_16x16x32_bf16 v[60:63], v[100:103], v[108:111], v[60:63]
    ds_read_b128 v[152:155], v8 offset:36864
    v_mul_f32 v248, v235, v248
    v_mfma_f32_16x16x32_bf16 v[24:27], v[96:99], v[112:115], v[24:27]
    ds_read_b128 v[156:159], v8 offset:38912
    v_add_u32 v2, s66, v2
    v_mfma_f32_16x16x32_bf16 v[64:67], v[100:103], v[112:115], v[64:67]
    buffer_load_dwordx4 v2, s[4:7], s37 offen offset:1024 lds
    v_accvgpr_write_b32 a254, v240
    v_mfma_f32_16x16x32_bf16 v[28:31], v[96:99], v[116:119], v[28:31]
    ds_read_b128 v[160:163], v8 offset:40960
    v_accvgpr_write_b32 a255, v241
    v_mfma_f32_16x16x32_bf16 v[68:71], v[100:103], v[116:119], v[68:71]
    ds_read_b128 v[164:167], v8 offset:43008
    v_mul_f32 v242, v240, v240
    s_waitcnt lgkmcnt(9)
    v_mfma_f32_16x16x32_bf16 v[32:35], v[96:99], v[120:123], v[32:35]
    buffer_load_dwordx4 v1, s[4:7], s38 offen offset:2048 lds
    v_mul_f32 v243, v240, v241
    v_mfma_f32_16x16x32_bf16 v[72:75], v[100:103], v[120:123], v[72:75]
    ds_read_b128 v[168:171], v8 offset:45056
    v_fma_f32 v242, -v241, v241, v242
    v_mfma_f32_16x16x32_bf16 v[36:39], v[96:99], v[124:127], v[36:39]
    ds_read_b128 v[172:175], v8 offset:47104
    v_add_f32 v243, v243, v243
    v_mfma_f32_16x16x32_bf16 v[76:79], v[100:103], v[124:127], v[76:79]
    v_mul_f32 v244, v242, v242
    v_mul_f32 v245, v242, v243
    v_mfma_f32_16x16x32_bf16 v[40:43], v[96:99], v[128:131], v[40:43]
    ds_read_b128 v[176:179], v8 offset:49152
    v_fma_f32 v244, -v243, v243, v244
    v_mfma_f32_16x16x32_bf16 v[80:83], v[100:103], v[128:131], v[80:83]
    ds_read_b128 v[180:183], v8 offset:51200
    v_add_f32 v245, v245, v245
    s_waitcnt lgkmcnt(10)
    v_mfma_f32_16x16x32_bf16 v[44:47], v[96:99], v[132:135], v[44:47]
    buffer_load_dwordx4 v2, s[4:7], s39 offen offset:3072 lds
    v_mfma_f32_16x16x32_bf16 v[84:87], v[100:103], v[132:135], v[84:87]
    ds_read_b128 v[184:187], v8 offset:53248
    v_mfma_f32_16x16x32_bf16 v[48:51], v[96:99], v[136:139], v[48:51]
    ds_read_b128 v[188:191], v8 offset:55296
    v_mfma_f32_16x16x32_bf16 v[88:91], v[100:103], v[136:139], v[88:91]
    v_mfma_f32_16x16x32_bf16 v[52:55], v[96:99], v[140:143], v[52:55]
    s_add_u32 m0, s46, 143360
    v_add_u32 v3, s66, v3
    v_mfma_f32_16x16x32_bf16 v[92:95], v[100:103], v[140:143], v[92:95]
    buffer_load_dwordx4 v3, s[8:11], s40 offen offset:0 lds
    v_add_u32 v4, s66, v4
    s_waitcnt lgkmcnt(8)
    v_mfma_f32_16x16x32_bf16 v[16:19], v[144:147], v[152:155], v[16:19]
    buffer_load_dwordx4 v4, s[8:11], s41 offen offset:1024 lds
    v_min_u32 v253, 14, v0
    v_mfma_f32_16x16x32_bf16 v[56:59], v[148:151], v[152:155], v[56:59]
    v_mul_u32_u24 v254, 86, v253
    v_lshrrev_b32 v254, 8, v254
    v_mfma_f32_16x16x32_bf16 v[20:23], v[144:147], v[156:159], v[20:23]
    buffer_load_dwordx4 v3, s[8:11], s42 offen offset:2048 lds
    v_mul_u32_u24 v254, 7, v254
    v_mfma_f32_16x16x32_bf16 v[60:63], v[148:151], v[156:159], v[60:63]
    s_waitcnt vmcnt(20)
    s_mov_b32 s52, 0x3f803f80
    v_mov_b32 v213, s28
    v_dot2_f32_bf16 v212, v192, s52, 0
    v_dot2_f32_bf16 v212, v193, s52, v212
    v_dot2_f32_bf16 v212, v194, s52, v212
    v_dot2_f32_bf16 v212, v195, s52, v212
    v_dot2_f32_bf16 v212, v196, s52, v212
    v_dot2_f32_bf16 v212, v197, s52, v212
    v_dot2_f32_bf16 v212, v198, s52, v212
    v_dot2_f32_bf16 v212, v199, s52, v212
    v_dot2_f32_bf16 v212, v200, s52, v212
    v_dot2_f32_bf16 v212, v201, s52, v212
    v_dot2_f32_bf16 v212, v202, s52, v212
    v_dot2_f32_bf16 v212, v203, s52, v212
    v_dot2_f32_bf16 v212, v204, s52, v212
    v_dot2_f32_bf16 v212, v205, s52, v212
    v_dot2_f32_bf16 v212, v206, s52, v212
    v_dot2_f32_bf16 v212, v207, s52, v212
    v_dot2_f32_bf16 v212, v208, s52, v212
    v_dot2_f32_bf16 v212, v209, s52, v212
    v_dot2_f32_bf16 v212, v210, s52, v212
    v_dot2_f32_bf16 v212, v211, s52, v212
    s_nop 2
    v_add_f32_dpp v212, v212, v212 row_ror:8 row_mask:0xf bank_mask:0xf
    s_nop 1
    v_add_f32_dpp v212, v212, v212 row_ror:4 row_mask:0xf bank_mask:0xf
    s_nop 1
    v_add_f32_dpp v212, v212, v212 row_ror:2 row_mask:0xf bank_mask:0xf
    s_nop 1
    v_add_f32_dpp v212, v212, v212 row_ror:1 row_mask:0xf bank_mask:0xf
    s_mov_b32 exec_lo, 0x00010001
    s_mov_b32 exec_hi, 0x00010001
    buffer_store_dwordx2 v[212:213], v14, s[12:15], s61 offen sc1
    s_mov_b64 exec, -1
    s_waitcnt vmcnt(12) lgkmcnt(0)
    s_barrier
    v_mfma_f32_16x16x32_bf16 v[24:27], v[144:147], v[160:163], v[24:27]
    ds_read_b128 v[96:99], v9 offset:0
    v_add_lshl_u32 v253, v253, v254, 6
    v_mfma_f32_16x16x32_bf16 v[64:67], v[148:151], v[160:163], v[64:67]
    ds_read_b128 v[100:103], v9 offset:2048
    v_mfma_f32_16x16x32_bf16 v[28:31], v[144:147], v[164:167], v[28:31]
    ds_read_b128 v[104:107], v250 offset:0
    v_mfma_f32_16x16x32_bf16 v[68:71], v[148:151], v[164:167], v[68:71]
    buffer_load_dwordx4 v4, s[8:11], s43 offen offset:3072 lds
    v_mfma_f32_16x16x32_bf16 v[32:35], v[144:147], v[168:171], v[32:35]
    ds_read_b128 v[108:111], v250 offset:2048
    v_mfma_f32_16x16x32_bf16 v[72:75], v[148:151], v[168:171], v[72:75]
    ds_read_b128 v[112:115], v250 offset:4096
    v_mfma_f32_16x16x32_bf16 v[36:39], v[144:147], v[172:175], v[36:39]
    ds_read_b128 v[116:119], v250 offset:6144
    s_add_u32 m0, s46, 147456
    v_mfma_f32_16x16x32_bf16 v[76:79], v[148:151], v[172:175], v[76:79]
    buffer_load_dwordx4 v3, s[8:11], s44 offen offset:0 lds
    v_mfma_f32_16x16x32_bf16 v[40:43], v[144:147], v[176:179], v[40:43]
    ds_read_b128 v[120:123], v250 offset:8192
    v_mfma_f32_16x16x32_bf16 v[80:83], v[148:151], v[176:179], v[80:83]
    ds_read_b128 v[124:127], v250 offset:10240
    v_mfma_f32_16x16x32_bf16 v[44:47], v[144:147], v[180:183], v[44:47]
    ds_read_b128 v[128:131], v250 offset:12288
    s_add_u32 m0, s45, 16384
    s_xor_b32 s1, s2, 4
    s_sub_u32 s66, s1, s0
    s_mov_b32 s0, s1
    s_lshl_b32 s66, s66, 7
    v_add_u32 v1, s66, v1
    v_mfma_f32_16x16x32_bf16 v[84:87], v[148:151], v[180:183], v[84:87]
    buffer_load_dwordx4 v1, s[4:7], s36 offen offset:0 lds
    v_mfma_f32_16x16x32_bf16 v[48:51], v[144:147], v[184:187], v[48:51]
    ds_read_b128 v[132:135], v250 offset:14336
    v_mfma_f32_16x16x32_bf16 v[88:91], v[148:151], v[184:187], v[88:91]
    ds_read_b128 v[136:139], v250 offset:16384
    v_mfma_f32_16x16x32_bf16 v[52:55], v[144:147], v[188:191], v[52:55]
    ds_read_b128 v[140:143], v250 offset:18432
    v_mfma_f32_16x16x32_bf16 v[92:95], v[148:151], v[188:191], v[92:95]
    s_waitcnt vmcnt(11)
    ds_read_b128 a[220:223], v13 offset:0
    ds_read_b128 a[224:227], v13 offset:32
    s_waitcnt lgkmcnt(9)
    ds_read_b128 a[228:231], v13 offset:64
    ds_read_b128 a[232:235], v13 offset:96
    s_waitcnt lgkmcnt(10)
    v_mfma_f32_16x16x32_bf16 v[16:19], v[96:99], v[104:107], v[16:19]
    ds_read_b128 v[144:147], v10 offset:0
    v_mfma_f32_16x16x32_bf16 v[56:59], v[100:103], v[104:107], v[56:59]
    ds_read_b128 v[148:151], v10 offset:2048
    v_add_u32 v2, s66, v2
    v_mfma_f32_16x16x32_bf16 v[20:23], v[96:99], v[108:111], v[20:23]
    buffer_load_dwordx4 v2, s[4:7], s37 offen offset:1024 lds
    v_mfma_f32_16x16x32_bf16 v[60:63], v[100:103], v[108:111], v[60:63]
    ds_read_b128 v[152:155], v251 offset:0
    v_mfma_f32_16x16x32_bf16 v[24:27], v[96:99], v[112:115], v[24:27]
    ds_read_b128 v[156:159], v251 offset:2048
    v_mfma_f32_16x16x32_bf16 v[64:67], v[100:103], v[112:115], v[64:67]
    buffer_load_dwordx4 v1, s[4:7], s38 offen offset:2048 lds
    v_mfma_f32_16x16x32_bf16 v[28:31], v[96:99], v[116:119], v[28:31]
    s_waitcnt lgkmcnt(9)
    ds_read_b128 v[160:163], v251 offset:4096
    v_mfma_f32_16x16x32_bf16 v[68:71], v[100:103], v[116:119], v[68:71]
    ds_read_b128 v[164:167], v251 offset:6144
    v_mfma_f32_16x16x32_bf16 v[32:35], v[96:99], v[120:123], v[32:35]
    buffer_load_dwordx4 v2, s[4:7], s39 offen offset:3072 lds
    v_mfma_f32_16x16x32_bf16 v[72:75], v[100:103], v[120:123], v[72:75]
    ds_read_b128 v[168:171], v251 offset:8192
    v_mfma_f32_16x16x32_bf16 v[36:39], v[96:99], v[124:127], v[36:39]
    ds_read_b128 v[172:175], v251 offset:10240
    v_mfma_f32_16x16x32_bf16 v[76:79], v[100:103], v[124:127], v[76:79]
    v_mfma_f32_16x16x32_bf16 v[40:43], v[96:99], v[128:131], v[40:43]
    ds_read_b128 v[176:179], v251 offset:12288
    v_mfma_f32_16x16x32_bf16 v[80:83], v[100:103], v[128:131], v[80:83]
    s_waitcnt lgkmcnt(9)
    ds_read_b128 v[180:183], v251 offset:14336
    s_add_u32 m0, s46, 32768
    v_add_u32 v3, s66, v3
    v_mfma_f32_16x16x32_bf16 v[44:47], v[96:99], v[132:135], v[44:47]
    buffer_load_dwordx4 v3, s[8:11], s40 offen offset:0 lds
    v_mfma_f32_16x16x32_bf16 v[84:87], v[100:103], v[132:135], v[84:87]
    ds_read_b128 v[184:187], v251 offset:16384
    v_mfma_f32_16x16x32_bf16 v[48:51], v[96:99], v[136:139], v[48:51]
    ds_read_b128 v[188:191], v251 offset:18432
    v_mfma_f32_16x16x32_bf16 v[88:91], v[100:103], v[136:139], v[88:91]
    v_mfma_f32_16x16x32_bf16 v[52:55], v[96:99], v[140:143], v[52:55]
    v_add_u32 v4, s66, v4
    v_mfma_f32_16x16x32_bf16 v[92:95], v[100:103], v[140:143], v[92:95]
    buffer_load_dwordx4 v4, s[8:11], s41 offen offset:1024 lds
    s_waitcnt lgkmcnt(8)
    v_mfma_f32_16x16x32_bf16 v[16:19], v[144:147], v[152:155], v[16:19]
    buffer_load_dwordx4 v3, s[8:11], s42 offen offset:2048 lds
    v_mfma_f32_16x16x32_bf16 v[56:59], v[148:151], v[152:155], v[56:59]
    v_mfma_f32_16x16x32_bf16 v[20:23], v[144:147], v[156:159], v[20:23]
    buffer_load_dwordx4 v4, s[8:11], s43 offen offset:3072 lds
    v_mfma_f32_16x16x32_bf16 v[60:63], v[148:151], v[156:159], v[60:63]
    v_and_b32 v230, 15, v0
    v_lshrrev_b32 v231, 4, v0
    s_lshl_b32 s50, s3, 2
    v_add_u32 v234, s50, v231
    v_mul_u32_u24 v227, 768, v234
    v_mul_u32_u24 v228, 48, v230
    v_add_u32 v227, v227, v228
    v_accvgpr_write_b32 a200, v227
    v_and_b32 v227, 15, v224
    v_lshrrev_b32 v229, 4, v224
    v_mul_u32_u24 v228, 48, v227
    v_lshl_add_u32 v228, v229, 3, v228
    v_accvgpr_write_b32 a201, v228
    v_min_u32 v223, 2, v223
    v_mul_u32_u24 v227, 160, v227
    v_lshlrev_b32 v229, 5, v229
    v_lshl_add_u32 v229, v223, 3, v229
    v_add3_u32 v227, v227, v229, 0
    v_add_u32 v227, 102400, v227
    v_accvgpr_write_b32 a207, v227
    v_lshlrev_b32 v227, 4, v224
    v_accvgpr_write_b32 a202, v227
    v_mul_u32_u24 v229, 5, v223
    v_mul_u32_u24 v228, 1280, v229
    v_add_u32 v227, v227, v228
    v_accvgpr_write_b32 a204, v227
    v_add_u32 v227, 5, v229
    v_min_u32 v227, s30, v227
    v_sub_u32 v227, s30, v227
    v_lshlrev_b32 v227, 7, v227
    v_cvt_f32_u32 v227, v227
    v_accvgpr_write_b32 a206, v227
    v_add_u32 v227, 0, v229
    v_cmp_gt_u32 s[68:69], s30, v227
    v_add_u32 v227, 1, v229
    v_cmp_gt_u32 s[70:71], s30, v227
    v_add_u32 v227, 2, v229
    v_cmp_gt_u32 s[72:73], s30, v227
    v_add_u32 v227, 3, v229
    v_cmp_gt_u32 s[74:75], s30, v227
    v_add_u32 v227, 4, v229
    v_cmp_gt_u32 s[76:77], s30, v227
    v_mul_u32_u24 v227, 184, v224
    v_accvgpr_write_b32 a203, v227
    v_mul_u32_u24 v227, 184, v230
    v_lshl_add_u32 v227, v234, 3, v227
    v_accvgpr_write_b32 a205, v227
    v_mul_u32_u24 v227, 160, v230
    v_add_u32 v227, 102400, v227
    v_accvgpr_write_b32 a208, v227
    s_mul_i32 s50, s3, 21504
    s_add_u32 s50, s50, 16384
    v_mul_u32_u24 v227, 80, v230
    v_lshl_add_u32 v227, v231, 4, v227
    v_add_u32 v227, s50, v227
    v_accvgpr_write_b32 a209, v227
    v_lshrrev_b32 v227, 2, v230
    v_lshl_add_u32 v227, v231, 3, v227
    v_mul_u32_u24 v227, 80, v227
    v_and_b32 v228, 3, v230
    v_lshl_add_u32 v227, v228, 3, v227
    v_add_u32 v227, s50, v227
    v_accvgpr_write_b32 a210, v227
    v_mul_u32_u24 v227, 336, v230
    v_lshl_add_u32 v227, v231, 4, v227
    v_add_u32 v227, s50, v227
    s_waitcnt vmcnt(8) lgkmcnt(0)
    s_barrier
    v_mfma_f32_16x16x32_bf16 v[24:27], v[144:147], v[160:163], v[24:27]
    ds_read_b128 v[96:99], v9 offset:36864
    v_mfma_f32_16x16x32_bf16 v[64:67], v[148:151], v[160:163], v[64:67]
    ds_read_b128 v[100:103], v9 offset:38912
    v_mfma_f32_16x16x32_bf16 v[28:31], v[144:147], v[164:167], v[28:31]
    ds_read_b128 v[104:107], v250 offset:36864
    s_add_u32 m0, s46, 36864
    v_mfma_f32_16x16x32_bf16 v[68:71], v[148:151], v[164:167], v[68:71]
    buffer_load_dwordx4 v3, s[8:11], s44 offen offset:0 lds
    v_mfma_f32_16x16x32_bf16 v[32:35], v[144:147], v[168:171], v[32:35]
    ds_read_b128 v[108:111], v250 offset:38912
    v_mfma_f32_16x16x32_bf16 v[72:75], v[148:151], v[168:171], v[72:75]
    ds_read_b128 v[112:115], v250 offset:40960
    v_mfma_f32_16x16x32_bf16 v[36:39], v[144:147], v[172:175], v[36:39]
    ds_read_b128 v[116:119], v250 offset:43008
    v_mfma_f32_16x16x32_bf16 v[76:79], v[148:151], v[172:175], v[76:79]
    buffer_store_dwordx4 a[220:223], v252, s[12:15], s58 offen offset:0 sc1
    v_mfma_f32_16x16x32_bf16 v[40:43], v[144:147], v[176:179], v[40:43]
    ds_read_b128 v[120:123], v250 offset:45056
    v_mfma_f32_16x16x32_bf16 v[80:83], v[148:151], v[176:179], v[80:83]
    ds_read_b128 v[124:127], v250 offset:47104
    v_mfma_f32_16x16x32_bf16 v[44:47], v[144:147], v[180:183], v[44:47]
    ds_read_b128 v[128:131], v250 offset:49152
    v_mfma_f32_16x16x32_bf16 v[84:87], v[148:151], v[180:183], v[84:87]
    buffer_store_dwordx4 a[224:227], v252, s[12:15], s58 offen offset:1024 sc1
    v_mfma_f32_16x16x32_bf16 v[48:51], v[144:147], v[184:187], v[48:51]
    ds_read_b128 v[132:135], v250 offset:51200
    v_mfma_f32_16x16x32_bf16 v[88:91], v[148:151], v[184:187], v[88:91]
    ds_read_b128 v[136:139], v250 offset:53248
    v_mfma_f32_16x16x32_bf16 v[52:55], v[144:147], v[188:191], v[52:55]
    ds_read_b128 v[140:143], v250 offset:55296
    v_mfma_f32_16x16x32_bf16 v[92:95], v[148:151], v[188:191], v[92:95]
    s_waitcnt lgkmcnt(6)
    v_mfma_f32_16x16x32_bf16 v[16:19], v[96:99], v[104:107], v[16:19]
    ds_read_b128 v[144:147], v10 offset:36864
    ds_write_b64 v225, v[240:241] offset:144
    v_mfma_f32_16x16x32_bf16 v[56:59], v[100:103], v[104:107], v[56:59]
    ds_read_b128 v[148:151], v10 offset:38912
    ds_write_b64 v225, v[242:243] offset:152
    v_mfma_f32_16x16x32_bf16 v[20:23], v[96:99], v[108:111], v[20:23]
    buffer_store_dwordx4 a[228:231], v252, s[12:15], s58 offen offset:2048 sc1
    ds_write_b64 v225, v[244:245] offset:160
    v_mfma_f32_16x16x32_bf16 v[60:63], v[100:103], v[108:111], v[60:63]
    ds_read_b128 v[152:155], v251 offset:36864
    s_lshl_b32 s48, s3, 7
    v_mfma_f32_16x16x32_bf16 v[24:27], v[96:99], v[112:115], v[24:27]
    ds_read_b128 v[156:159], v251 offset:38912
    v_lshrrev_b32 v12, 2, v216
    v_mfma_f32_16x16x32_bf16 v[64:67], v[100:103], v[112:115], v[64:67]
    buffer_store_dwordx4 a[232:235], v252, s[12:15], s58 offen offset:3072 sc1
    v_add_u32 v12, s48, v12
    v_mfma_f32_16x16x32_bf16 v[28:31], v[96:99], v[116:119], v[28:31]
    ds_read_b128 v[160:163], v251 offset:40960
    v_add_u32 v12, 14720, v12
    v_mfma_f32_16x16x32_bf16 v[68:71], v[100:103], v[116:119], v[68:71]
    s_waitcnt lgkmcnt(9)
    ds_read_b128 v[164:167], v251 offset:43008
    s_add_u32 m0, s45, 53248
    s_xor_b32 s1, s2, 5
    s_sub_u32 s66, s1, s0
    s_mov_b32 s0, s1
    s_lshl_b32 s66, s66, 7
    v_add_u32 v1, s66, v1
    v_mfma_f32_16x16x32_bf16 v[32:35], v[96:99], v[120:123], v[32:35]
    buffer_load_dwordx4 v1, s[4:7], s36 offen offset:0 lds
    v_lshrrev_b32 v14, 4, v0
    v_mfma_f32_16x16x32_bf16 v[72:75], v[100:103], v[120:123], v[72:75]
    ds_read_b128 v[168:171], v251 offset:45056
    v_lshl_add_u32 v239, v14, 5, s48
    v_mfma_f32_16x16x32_bf16 v[36:39], v[96:99], v[124:127], v[36:39]
    ds_read_b128 v[172:175], v251 offset:47104
    s_and_b32 s48, s3, 1
    v_mfma_f32_16x16x32_bf16 v[76:79], v[100:103], v[124:127], v[76:79]
    s_mul_i32 s48, s48, 40
    v_lshrrev_b32 v13, 4, v217
    v_mfma_f32_16x16x32_bf16 v[40:43], v[96:99], v[128:131], v[40:43]
    ds_read_b128 v[176:179], v251 offset:49152
    v_add_u32 v13, s48, v13
    v_mfma_f32_16x16x32_bf16 v[80:83], v[100:103], v[128:131], v[80:83]
    ds_read_b128 v[180:183], v251 offset:51200
    v_add_u32 v2, s66, v2
    s_waitcnt lgkmcnt(13)
    v_mfma_f32_16x16x32_bf16 v[44:47], v[96:99], v[132:135], v[44:47]
    buffer_load_dwordx4 v2, s[4:7], s37 offen offset:1024 lds
    v_mul_u32_u24 v13, 184, v13
    v_mfma_f32_16x16x32_bf16 v[84:87], v[100:103], v[132:135], v[84:87]
    ds_read_b128 v[184:187], v251 offset:53248
    s_lshr_b32 s48, s3, 1
    v_mfma_f32_16x16x32_bf16 v[48:51], v[96:99], v[136:139], v[48:51]
    s_waitcnt lgkmcnt(9)
    ds_read_b128 v[188:191], v251 offset:55296
    s_lshl_b32 s48, s48, 2
    v_mfma_f32_16x16x32_bf16 v[88:91], v[100:103], v[136:139], v[88:91]
    v_add_u32 v13, s48, v13
    s_mov_b32 s48, 0x3acccccd
    v_mfma_f32_16x16x32_bf16 v[52:55], v[96:99], v[140:143], v[52:55]
    v_mfma_f32_16x16x32_bf16 v[92:95], v[100:103], v[140:143], v[92:95]
    buffer_load_dwordx4 v1, s[4:7], s38 offen offset:2048 lds
    s_waitcnt lgkmcnt(8)
    v_mfma_f32_16x16x32_bf16 v[16:19], v[144:147], v[152:155], v[16:19]
    buffer_load_dwordx4 v2, s[4:7], s39 offen offset:3072 lds
    v_mfma_f32_16x16x32_bf16 v[56:59], v[148:151], v[152:155], v[56:59]
    s_add_u32 m0, s46, 69632
    v_add_u32 v3, s66, v3
    v_mfma_f32_16x16x32_bf16 v[20:23], v[144:147], v[156:159], v[20:23]
    buffer_load_dwordx4 v3, s[8:11], s40 offen offset:0 lds
    v_mfma_f32_16x16x32_bf16 v[60:63], v[148:151], v[156:159], v[60:63]
    v_accvgpr_write_b32 a246, v227
    v_add_u32 v227, 0, v0
    v_mul_u32_u24 v228, 6554, v227
    v_lshrrev_b32 v228, 16, v228
    v_mul_u32_u24 v229, 10, v228
    v_sub_u32 v229, v227, v229
    v_lshrrev_b32 v234, 4, v228
    v_mul_u32_u24 v234, 48, v234
    v_add_u32 v228, v228, v234
    v_mul_u32_u24 v228, 1280, v228
    v_lshl_add_u32 v228, v229, 4, v228
    v_accvgpr_write_b32 a212, v228
    v_mul_u32_u24 v228, 3277, v227
    v_lshrrev_b32 v228, 16, v228
    v_mul_u32_u24 v229, 20, v228
    v_sub_u32 v229, v227, v229
    v_accvgpr_write_b32 a236, v228
    v_accvgpr_write_b32 a241, v229
    v_add_u32 v227, 64, v0
    v_mul_u32_u24 v228, 6554, v227
    v_lshrrev_b32 v228, 16, v228
    v_mul_u32_u24 v229, 10, v228
    v_sub_u32 v229, v227, v229
    v_lshrrev_b32 v234, 4, v228
    v_mul_u32_u24 v234, 48, v234
    v_add_u32 v228, v228, v234
    v_mul_u32_u24 v228, 1280, v228
    v_lshl_add_u32 v228, v229, 4, v228
    v_accvgpr_write_b32 a213, v228
    v_mul_u32_u24 v228, 3277, v227
    v_lshrrev_b32 v228, 16, v228
    v_mul_u32_u24 v229, 20, v228
    v_sub_u32 v229, v227, v229
    v_accvgpr_write_b32 a237, v228
    v_accvgpr_write_b32 a242, v229
    v_add_u32 v227, 128, v0
    v_mul_u32_u24 v228, 6554, v227
    v_lshrrev_b32 v228, 16, v228
    v_mul_u32_u24 v229, 10, v228
    v_sub_u32 v229, v227, v229
    v_lshrrev_b32 v234, 4, v228
    v_mul_u32_u24 v234, 48, v234
    v_add_u32 v228, v228, v234
    v_mul_u32_u24 v228, 1280, v228
    v_lshl_add_u32 v228, v229, 4, v228
    v_accvgpr_write_b32 a214, v228
    v_mul_u32_u24 v228, 3277, v227
    v_lshrrev_b32 v228, 16, v228
    v_mul_u32_u24 v229, 20, v228
    v_sub_u32 v229, v227, v229
    v_accvgpr_write_b32 a238, v228
    v_accvgpr_write_b32 a243, v229
    v_add_u32 v227, 192, v0
    v_mul_u32_u24 v228, 6554, v227
    v_lshrrev_b32 v228, 16, v228
    v_mul_u32_u24 v229, 10, v228
    v_sub_u32 v229, v227, v229
    v_lshrrev_b32 v234, 4, v228
    v_mul_u32_u24 v234, 48, v234
    v_add_u32 v228, v228, v234
    v_mul_u32_u24 v228, 1280, v228
    v_lshl_add_u32 v228, v229, 4, v228
    v_accvgpr_write_b32 a215, v228
    v_mul_u32_u24 v228, 3277, v227
    v_lshrrev_b32 v228, 16, v228
    v_mul_u32_u24 v229, 20, v228
    s_waitcnt vmcnt(9) lgkmcnt(0)
    s_barrier
    v_mfma_f32_16x16x32_bf16 v[24:27], v[144:147], v[160:163], v[24:27]
    ds_read_b128 v[96:99], v5 offset:0
    v_mfma_f32_16x16x32_bf16 v[64:67], v[148:151], v[160:163], v[64:67]
    ds_read_b128 v[100:103], v5 offset:2048
    v_mfma_f32_16x16x32_bf16 v[28:31], v[144:147], v[164:167], v[28:31]
    ds_read_b128 v[104:107], v7 offset:0
    v_add_u32 v4, s66, v4
    v_mfma_f32_16x16x32_bf16 v[68:71], v[148:151], v[164:167], v[68:71]
    buffer_load_dwordx4 v4, s[8:11], s41 offen offset:1024 lds
    v_mfma_f32_16x16x32_bf16 v[32:35], v[144:147], v[168:171], v[32:35]
    ds_read_b128 v[108:111], v7 offset:2048
    v_mfma_f32_16x16x32_bf16 v[72:75], v[148:151], v[168:171], v[72:75]
    ds_read_b128 v[112:115], v7 offset:4096
    v_mfma_f32_16x16x32_bf16 v[36:39], v[144:147], v[172:175], v[36:39]
    ds_read_b128 v[116:119], v7 offset:6144
    v_mfma_f32_16x16x32_bf16 v[76:79], v[148:151], v[172:175], v[76:79]
    buffer_load_dwordx4 v3, s[8:11], s42 offen offset:2048 lds
    v_mfma_f32_16x16x32_bf16 v[40:43], v[144:147], v[176:179], v[40:43]
    ds_read_b128 v[120:123], v7 offset:8192
    v_mfma_f32_16x16x32_bf16 v[80:83], v[148:151], v[176:179], v[80:83]
    ds_read_b128 v[124:127], v7 offset:10240
    v_mfma_f32_16x16x32_bf16 v[44:47], v[144:147], v[180:183], v[44:47]
    ds_read_b128 v[128:131], v7 offset:12288
    v_mfma_f32_16x16x32_bf16 v[84:87], v[148:151], v[180:183], v[84:87]
    buffer_load_dwordx4 v4, s[8:11], s43 offen offset:3072 lds
    v_mfma_f32_16x16x32_bf16 v[48:51], v[144:147], v[184:187], v[48:51]
    ds_read_b128 v[132:135], v7 offset:14336
    v_mfma_f32_16x16x32_bf16 v[88:91], v[148:151], v[184:187], v[88:91]
    ds_read_b128 v[136:139], v7 offset:16384
    v_mfma_f32_16x16x32_bf16 v[52:55], v[144:147], v[188:191], v[52:55]
    ds_read_b128 v[140:143], v7 offset:18432
    v_mfma_f32_16x16x32_bf16 v[92:95], v[148:151], v[188:191], v[92:95]
    s_waitcnt lgkmcnt(6)
    v_mfma_f32_16x16x32_bf16 v[16:19], v[96:99], v[104:107], v[16:19]
    ds_read_b128 v[144:147], v6 offset:0
    v_mfma_f32_16x16x32_bf16 v[56:59], v[100:103], v[104:107], v[56:59]
    ds_read_b128 v[148:151], v6 offset:2048
    s_add_u32 m0, s46, 73728
    v_mfma_f32_16x16x32_bf16 v[20:23], v[96:99], v[108:111], v[20:23]
    buffer_load_dwordx4 v3, s[8:11], s44 offen offset:0 lds
    v_mfma_f32_16x16x32_bf16 v[60:63], v[100:103], v[108:111], v[60:63]
    ds_read_b128 v[152:155], v8 offset:0
    v_mfma_f32_16x16x32_bf16 v[24:27], v[96:99], v[112:115], v[24:27]
    ds_read_b128 v[156:159], v8 offset:2048
    s_add_u32 m0, s45, 90112
    s_xor_b32 s1, s2, 6
    s_sub_u32 s66, s1, s0
    s_mov_b32 s0, s1
    s_lshl_b32 s66, s66, 7
    v_add_u32 v1, s66, v1
    v_mfma_f32_16x16x32_bf16 v[64:67], v[100:103], v[112:115], v[64:67]
    buffer_load_dwordx4 v1, s[4:7], s36 offen offset:0 lds
    v_mfma_f32_16x16x32_bf16 v[28:31], v[96:99], v[116:119], v[28:31]
    ds_read_b128 v[160:163], v8 offset:4096
    v_mfma_f32_16x16x32_bf16 v[68:71], v[100:103], v[116:119], v[68:71]
    ds_read_b128 v[164:167], v8 offset:6144
    v_add_u32 v2, s66, v2
    s_waitcnt lgkmcnt(9)
    v_mfma_f32_16x16x32_bf16 v[32:35], v[96:99], v[120:123], v[32:35]
    buffer_load_dwordx4 v2, s[4:7], s37 offen offset:1024 lds
    v_mfma_f32_16x16x32_bf16 v[72:75], v[100:103], v[120:123], v[72:75]
    ds_read_b128 v[168:171], v8 offset:8192
    v_mfma_f32_16x16x32_bf16 v[36:39], v[96:99], v[124:127], v[36:39]
    ds_read_b128 v[172:175], v8 offset:10240
    v_mfma_f32_16x16x32_bf16 v[76:79], v[100:103], v[124:127], v[76:79]
    v_mfma_f32_16x16x32_bf16 v[40:43], v[96:99], v[128:131], v[40:43]
    ds_read_b128 v[176:179], v8 offset:12288
    v_mfma_f32_16x16x32_bf16 v[80:83], v[100:103], v[128:131], v[80:83]
    ds_read_b128 v[180:183], v8 offset:14336
    s_waitcnt lgkmcnt(10)
    v_mfma_f32_16x16x32_bf16 v[44:47], v[96:99], v[132:135], v[44:47]
    buffer_load_dwordx4 v1, s[4:7], s38 offen offset:2048 lds
    v_mfma_f32_16x16x32_bf16 v[84:87], v[100:103], v[132:135], v[84:87]
    ds_read_b128 v[184:187], v8 offset:16384
    v_mfma_f32_16x16x32_bf16 v[48:51], v[96:99], v[136:139], v[48:51]
    ds_read_b128 v[188:191], v8 offset:18432
    v_mfma_f32_16x16x32_bf16 v[88:91], v[100:103], v[136:139], v[88:91]
    v_mfma_f32_16x16x32_bf16 v[52:55], v[96:99], v[140:143], v[52:55]
    v_mfma_f32_16x16x32_bf16 v[92:95], v[100:103], v[140:143], v[92:95]
    buffer_load_dwordx4 v2, s[4:7], s39 offen offset:3072 lds
    s_add_u32 m0, s46, 106496
    v_add_u32 v3, s66, v3
    s_waitcnt lgkmcnt(8)
    v_mfma_f32_16x16x32_bf16 v[16:19], v[144:147], v[152:155], v[16:19]
    buffer_load_dwordx4 v3, s[8:11], s40 offen offset:0 lds
    v_mfma_f32_16x16x32_bf16 v[56:59], v[148:151], v[152:155], v[56:59]
    v_add_u32 v4, s66, v4
    v_mfma_f32_16x16x32_bf16 v[20:23], v[144:147], v[156:159], v[20:23]
    buffer_load_dwordx4 v4, s[8:11], s41 offen offset:1024 lds
    v_mfma_f32_16x16x32_bf16 v[60:63], v[148:151], v[156:159], v[60:63]
    v_sub_u32 v229, v227, v229
    v_accvgpr_write_b32 a239, v228
    v_accvgpr_write_b32 a244, v229
    v_add_u32 v227, 256, v0
    v_mul_u32_u24 v228, 6554, v227
    v_lshrrev_b32 v228, 16, v228
    v_mul_u32_u24 v229, 10, v228
    v_sub_u32 v229, v227, v229
    v_lshrrev_b32 v234, 4, v228
    v_mul_u32_u24 v234, 48, v234
    v_add_u32 v228, v228, v234
    v_mul_u32_u24 v228, 1280, v228
    v_lshl_add_u32 v228, v229, 4, v228
    v_accvgpr_write_b32 a216, v228
    v_mul_u32_u24 v228, 3277, v227
    v_lshrrev_b32 v228, 16, v228
    v_mul_u32_u24 v229, 20, v228
    v_sub_u32 v229, v227, v229
    v_accvgpr_write_b32 a240, v228
    v_accvgpr_write_b32 a245, v229
    s_mul_i32 s79, s31, 20480
    s_add_u32 s79, s79, 200704
    s_mul_i32 s78, s30, 1280
    s_add_u32 s78, s78, s79
    s_lshl_b32 s50, s30, 3
    s_lshl_b32 s51, s3, 1
    s_add_u32 s50, s50, s51
    s_mul_i32 s50, s50, 40
    s_mul_i32 s51, s31, 5
    s_add_u32 s50, s50, s51
    s_lshl_b32 s50, s50, 10
    s_add_u32 s84, s50, 4194304
    s_lshl_b32 s85, s30, 7
    s_lshl_b32 s50, s3, 4
    s_add_u32 s85, s85, s50
    s_mul_i32 s85, s85, 1280
    s_mul_i32 s87, s31, 160
    s_add_u32 s85, s85, s87
    s_mul_i32 s86, s3, 5120
    s_add_u32 s86, s86, 106496
    s_lshl_b32 s50, s30, 5
    s_lshl_b32 s51, s3, 3
    s_add_u32 s50, s50, s51
    s_lshl_b32 s50, s50, 6
    s_add_u32 s95, s50, 69632
    s_lshr_b32 s50, s33, 2
    s_mul_i32 s50, s50, 20480
    s_mul_i32 s51, s3, 5120
    s_add_u32 s50, s50, s51
    s_add_u32 s88, s50, 18350080
    s_add_u32 s89, s88, 4096
    s_add_u32 s96, s50, 15728640
    s_add_u32 s97, s96, 4096
    s_lshl_b32 s50, s30, 7
    s_lshl_b32 s51, s3, 4
    s_add_u32 s50, s50, s51
    s_add_u32 s50, s50, 64
    s_mul_i32 s50, s50, 2560
    s_mul_i32 s51, s31, 320
    s_add_u32 s35, s50, s51
    s_mov_b32 s16, s92
    s_mov_b32 s17, s93
    s_mov_b32 s18, 5242880
    s_mov_b32 s19, 0x20000
    s_waitcnt vmcnt(6) lgkmcnt(0)
    s_barrier
    v_mfma_f32_16x16x32_bf16 v[24:27], v[144:147], v[160:163], v[24:27]
    ds_read_b128 v[96:99], v5 offset:36864
    v_mfma_f32_16x16x32_bf16 v[64:67], v[148:151], v[160:163], v[64:67]
    ds_read_b128 v[100:103], v5 offset:38912
    v_mfma_f32_16x16x32_bf16 v[28:31], v[144:147], v[164:167], v[28:31]
    ds_read_b128 v[104:107], v7 offset:36864
    v_mfma_f32_16x16x32_bf16 v[68:71], v[148:151], v[164:167], v[68:71]
    buffer_load_dwordx4 v3, s[8:11], s42 offen offset:2048 lds
    v_mfma_f32_16x16x32_bf16 v[32:35], v[144:147], v[168:171], v[32:35]
    ds_read_b128 v[108:111], v7 offset:38912
    v_mfma_f32_16x16x32_bf16 v[72:75], v[148:151], v[168:171], v[72:75]
    ds_read_b128 v[112:115], v7 offset:40960
    v_mfma_f32_16x16x32_bf16 v[36:39], v[144:147], v[172:175], v[36:39]
    ds_read_b128 v[116:119], v7 offset:43008
    v_mfma_f32_16x16x32_bf16 v[76:79], v[148:151], v[172:175], v[76:79]
    buffer_load_dwordx4 v4, s[8:11], s43 offen offset:3072 lds
    v_mfma_f32_16x16x32_bf16 v[40:43], v[144:147], v[176:179], v[40:43]
    ds_read_b128 v[120:123], v7 offset:45056
    v_mfma_f32_16x16x32_bf16 v[80:83], v[148:151], v[176:179], v[80:83]
    ds_read_b128 v[124:127], v7 offset:47104
    v_mfma_f32_16x16x32_bf16 v[44:47], v[144:147], v[180:183], v[44:47]
    ds_read_b128 v[128:131], v7 offset:49152
    s_add_u32 m0, s46, 110592
    v_mfma_f32_16x16x32_bf16 v[84:87], v[148:151], v[180:183], v[84:87]
    buffer_load_dwordx4 v3, s[8:11], s44 offen offset:0 lds
    v_mfma_f32_16x16x32_bf16 v[48:51], v[144:147], v[184:187], v[48:51]
    ds_read_b128 v[132:135], v7 offset:51200
    v_mfma_f32_16x16x32_bf16 v[88:91], v[148:151], v[184:187], v[88:91]
    ds_read_b128 v[136:139], v7 offset:53248
    v_mfma_f32_16x16x32_bf16 v[52:55], v[144:147], v[188:191], v[52:55]
    ds_read_b128 v[140:143], v7 offset:55296
    v_mfma_f32_16x16x32_bf16 v[92:95], v[148:151], v[188:191], v[92:95]
    v_mov_b32 v15, s28
    s_mov_b64 exec, 1
    buffer_store_dword v15, off, s[12:15], s62 offset:0 sc1
    s_mov_b64 exec, -1
    s_waitcnt lgkmcnt(6)
    v_mfma_f32_16x16x32_bf16 v[16:19], v[96:99], v[104:107], v[16:19]
    ds_read_b128 v[144:147], v6 offset:36864
    v_mfma_f32_16x16x32_bf16 v[56:59], v[100:103], v[104:107], v[56:59]
    ds_read_b128 v[148:151], v6 offset:38912
    s_add_u32 m0, s45, 126976
    s_xor_b32 s1, s2, 7
    s_sub_u32 s66, s1, s0
    s_mov_b32 s0, s1
    s_lshl_b32 s66, s66, 7
    v_add_u32 v1, s66, v1
    v_mfma_f32_16x16x32_bf16 v[20:23], v[96:99], v[108:111], v[20:23]
    buffer_load_dwordx4 v1, s[4:7], s36 offen offset:0 lds
    v_mfma_f32_16x16x32_bf16 v[60:63], v[100:103], v[108:111], v[60:63]
    ds_read_b128 v[152:155], v8 offset:36864
    v_mfma_f32_16x16x32_bf16 v[24:27], v[96:99], v[112:115], v[24:27]
    ds_read_b128 v[156:159], v8 offset:38912
    v_add_u32 v2, s66, v2
    v_mfma_f32_16x16x32_bf16 v[64:67], v[100:103], v[112:115], v[64:67]
    buffer_load_dwordx4 v2, s[4:7], s37 offen offset:1024 lds
    v_mfma_f32_16x16x32_bf16 v[28:31], v[96:99], v[116:119], v[28:31]
    ds_read_b128 v[160:163], v8 offset:40960
    v_mfma_f32_16x16x32_bf16 v[68:71], v[100:103], v[116:119], v[68:71]
    ds_read_b128 v[164:167], v8 offset:43008
    s_waitcnt lgkmcnt(9)
    v_mfma_f32_16x16x32_bf16 v[32:35], v[96:99], v[120:123], v[32:35]
    buffer_load_dwordx4 v1, s[4:7], s38 offen offset:2048 lds
    v_mfma_f32_16x16x32_bf16 v[72:75], v[100:103], v[120:123], v[72:75]
    ds_read_b128 v[168:171], v8 offset:45056
    v_mfma_f32_16x16x32_bf16 v[36:39], v[96:99], v[124:127], v[36:39]
    ds_read_b128 v[172:175], v8 offset:47104
    v_mfma_f32_16x16x32_bf16 v[76:79], v[100:103], v[124:127], v[76:79]
    v_mfma_f32_16x16x32_bf16 v[40:43], v[96:99], v[128:131], v[40:43]
    ds_read_b128 v[176:179], v8 offset:49152
    v_mfma_f32_16x16x32_bf16 v[80:83], v[100:103], v[128:131], v[80:83]
    ds_read_b128 v[180:183], v8 offset:51200
    s_waitcnt lgkmcnt(10)
    v_mfma_f32_16x16x32_bf16 v[44:47], v[96:99], v[132:135], v[44:47]
    buffer_load_dwordx4 v2, s[4:7], s39 offen offset:3072 lds
    v_mfma_f32_16x16x32_bf16 v[84:87], v[100:103], v[132:135], v[84:87]
    ds_read_b128 v[184:187], v8 offset:53248
    v_mfma_f32_16x16x32_bf16 v[48:51], v[96:99], v[136:139], v[48:51]
    ds_read_b128 v[188:191], v8 offset:55296
    v_mfma_f32_16x16x32_bf16 v[88:91], v[100:103], v[136:139], v[88:91]
    v_mfma_f32_16x16x32_bf16 v[52:55], v[96:99], v[140:143], v[52:55]
    s_add_u32 m0, s46, 143360
    v_add_u32 v3, s66, v3
    v_mfma_f32_16x16x32_bf16 v[92:95], v[100:103], v[140:143], v[92:95]
    buffer_load_dwordx4 v3, s[8:11], s40 offen offset:0 lds
    v_add_u32 v4, s66, v4
    s_waitcnt lgkmcnt(8)
    v_mfma_f32_16x16x32_bf16 v[16:19], v[144:147], v[152:155], v[16:19]
    buffer_load_dwordx4 v4, s[8:11], s41 offen offset:1024 lds
    v_mfma_f32_16x16x32_bf16 v[56:59], v[148:151], v[152:155], v[56:59]
    v_mfma_f32_16x16x32_bf16 v[20:23], v[144:147], v[156:159], v[20:23]
    buffer_load_dwordx4 v3, s[8:11], s42 offen offset:2048 lds
    v_mfma_f32_16x16x32_bf16 v[60:63], v[148:151], v[156:159], v[60:63]
    s_waitcnt vmcnt(8) lgkmcnt(0)
    s_barrier
    v_mfma_f32_16x16x32_bf16 v[24:27], v[144:147], v[160:163], v[24:27]
    ds_read_b128 v[96:99], v9 offset:0
    v_mfma_f32_16x16x32_bf16 v[64:67], v[148:151], v[160:163], v[64:67]
    ds_read_b128 v[100:103], v9 offset:2048
    v_mfma_f32_16x16x32_bf16 v[28:31], v[144:147], v[164:167], v[28:31]
    ds_read_b128 v[104:107], v250 offset:0
    v_mfma_f32_16x16x32_bf16 v[68:71], v[148:151], v[164:167], v[68:71]
    buffer_load_dwordx4 v4, s[8:11], s43 offen offset:3072 lds
    v_mfma_f32_16x16x32_bf16 v[32:35], v[144:147], v[168:171], v[32:35]
    ds_read_b128 v[108:111], v250 offset:2048
    v_mfma_f32_16x16x32_bf16 v[72:75], v[148:151], v[168:171], v[72:75]
    ds_read_b128 v[112:115], v250 offset:4096
    v_mfma_f32_16x16x32_bf16 v[36:39], v[144:147], v[172:175], v[36:39]
    ds_read_b128 v[116:119], v250 offset:6144
    s_add_u32 m0, s46, 147456
    v_mfma_f32_16x16x32_bf16 v[76:79], v[148:151], v[172:175], v[76:79]
    buffer_load_dwordx4 v3, s[8:11], s44 offen offset:0 lds
    v_mfma_f32_16x16x32_bf16 v[40:43], v[144:147], v[176:179], v[40:43]
    ds_read_b128 v[120:123], v250 offset:8192
    v_mfma_f32_16x16x32_bf16 v[80:83], v[148:151], v[176:179], v[80:83]
    ds_read_b128 v[124:127], v250 offset:10240
    v_mfma_f32_16x16x32_bf16 v[44:47], v[144:147], v[180:183], v[44:47]
    ds_read_b128 v[128:131], v250 offset:12288
    s_add_u32 m0, s45, 16384
    s_xor_b32 s1, s2, 8
    s_sub_u32 s66, s1, s0
    s_mov_b32 s0, s1
    s_lshl_b32 s66, s66, 7
    v_add_u32 v1, s66, v1
    v_mfma_f32_16x16x32_bf16 v[84:87], v[148:151], v[180:183], v[84:87]
    buffer_load_dwordx4 v1, s[4:7], s36 offen offset:0 lds
    v_mfma_f32_16x16x32_bf16 v[48:51], v[144:147], v[184:187], v[48:51]
    ds_read_b128 v[132:135], v250 offset:14336
    v_mfma_f32_16x16x32_bf16 v[88:91], v[148:151], v[184:187], v[88:91]
    ds_read_b128 v[136:139], v250 offset:16384
    v_mfma_f32_16x16x32_bf16 v[52:55], v[144:147], v[188:191], v[52:55]
    ds_read_b128 v[140:143], v250 offset:18432
    v_mfma_f32_16x16x32_bf16 v[92:95], v[148:151], v[188:191], v[92:95]
    s_waitcnt lgkmcnt(6)
    v_mfma_f32_16x16x32_bf16 v[16:19], v[96:99], v[104:107], v[16:19]
    ds_read_b128 v[144:147], v10 offset:0
    v_mfma_f32_16x16x32_bf16 v[56:59], v[100:103], v[104:107], v[56:59]
    ds_read_b128 v[148:151], v10 offset:2048
    v_add_u32 v2, s66, v2
    v_mfma_f32_16x16x32_bf16 v[20:23], v[96:99], v[108:111], v[20:23]
    buffer_load_dwordx4 v2, s[4:7], s37 offen offset:1024 lds
    v_mfma_f32_16x16x32_bf16 v[60:63], v[100:103], v[108:111], v[60:63]
    ds_read_b128 v[152:155], v251 offset:0
    v_mfma_f32_16x16x32_bf16 v[24:27], v[96:99], v[112:115], v[24:27]
    ds_read_b128 v[156:159], v251 offset:2048
    v_mfma_f32_16x16x32_bf16 v[64:67], v[100:103], v[112:115], v[64:67]
    buffer_load_dwordx4 v1, s[4:7], s38 offen offset:2048 lds
    v_mfma_f32_16x16x32_bf16 v[28:31], v[96:99], v[116:119], v[28:31]
    ds_read_b128 v[160:163], v251 offset:4096
    v_mfma_f32_16x16x32_bf16 v[68:71], v[100:103], v[116:119], v[68:71]
    ds_read_b128 v[164:167], v251 offset:6144
    s_waitcnt lgkmcnt(9)
    v_mfma_f32_16x16x32_bf16 v[32:35], v[96:99], v[120:123], v[32:35]
    buffer_load_dwordx4 v2, s[4:7], s39 offen offset:3072 lds
    v_mfma_f32_16x16x32_bf16 v[72:75], v[100:103], v[120:123], v[72:75]
    ds_read_b128 v[168:171], v251 offset:8192
    v_mfma_f32_16x16x32_bf16 v[36:39], v[96:99], v[124:127], v[36:39]
    ds_read_b128 v[172:175], v251 offset:10240
    v_mfma_f32_16x16x32_bf16 v[76:79], v[100:103], v[124:127], v[76:79]
    v_mfma_f32_16x16x32_bf16 v[40:43], v[96:99], v[128:131], v[40:43]
    ds_read_b128 v[176:179], v251 offset:12288
    v_mfma_f32_16x16x32_bf16 v[80:83], v[100:103], v[128:131], v[80:83]
    ds_read_b128 v[180:183], v251 offset:14336
    s_add_u32 m0, s46, 32768
    v_add_u32 v3, s66, v3
    s_waitcnt lgkmcnt(10)
    v_mfma_f32_16x16x32_bf16 v[44:47], v[96:99], v[132:135], v[44:47]
    buffer_load_dwordx4 v3, s[8:11], s40 offen offset:0 lds
    v_mfma_f32_16x16x32_bf16 v[84:87], v[100:103], v[132:135], v[84:87]
    ds_read_b128 v[184:187], v251 offset:16384
    v_mfma_f32_16x16x32_bf16 v[48:51], v[96:99], v[136:139], v[48:51]
    ds_read_b128 v[188:191], v251 offset:18432
    v_mfma_f32_16x16x32_bf16 v[88:91], v[100:103], v[136:139], v[88:91]
    v_mfma_f32_16x16x32_bf16 v[52:55], v[96:99], v[140:143], v[52:55]
    v_add_u32 v4, s66, v4
    v_mfma_f32_16x16x32_bf16 v[92:95], v[100:103], v[140:143], v[92:95]
    buffer_load_dwordx4 v4, s[8:11], s41 offen offset:1024 lds
    s_waitcnt lgkmcnt(8)
    v_mfma_f32_16x16x32_bf16 v[16:19], v[144:147], v[152:155], v[16:19]
    buffer_load_dwordx4 v[192:195], v216, s[12:15], s57 offen sc1
    v_mfma_f32_16x16x32_bf16 v[56:59], v[148:151], v[152:155], v[56:59]
    v_mfma_f32_16x16x32_bf16 v[20:23], v[144:147], v[156:159], v[20:23]
    buffer_load_dwordx2 v[196:197], v217, s[12:15], s56 offen sc1
    v_mfma_f32_16x16x32_bf16 v[60:63], v[148:151], v[156:159], v[60:63]
    s_waitcnt vmcnt(8) lgkmcnt(0)
    s_barrier
    v_mfma_f32_16x16x32_bf16 v[24:27], v[144:147], v[160:163], v[24:27]
    ds_read_b128 v[96:99], v9 offset:36864
    v_mfma_f32_16x16x32_bf16 v[64:67], v[148:151], v[160:163], v[64:67]
    ds_read_b128 v[100:103], v9 offset:38912
    v_mfma_f32_16x16x32_bf16 v[28:31], v[144:147], v[164:167], v[28:31]
    ds_read_b128 v[104:107], v250 offset:36864
    v_mfma_f32_16x16x32_bf16 v[68:71], v[148:151], v[164:167], v[68:71]
    buffer_load_dwordx4 v3, s[8:11], s42 offen offset:2048 lds
    v_mfma_f32_16x16x32_bf16 v[32:35], v[144:147], v[168:171], v[32:35]
    ds_read_b128 v[108:111], v250 offset:38912
    v_mfma_f32_16x16x32_bf16 v[72:75], v[148:151], v[168:171], v[72:75]
    ds_read_b128 v[112:115], v250 offset:40960
    v_mfma_f32_16x16x32_bf16 v[36:39], v[144:147], v[172:175], v[36:39]
    ds_read_b128 v[116:119], v250 offset:43008
    v_mfma_f32_16x16x32_bf16 v[76:79], v[148:151], v[172:175], v[76:79]
    buffer_load_dwordx4 v4, s[8:11], s43 offen offset:3072 lds
    v_mfma_f32_16x16x32_bf16 v[40:43], v[144:147], v[176:179], v[40:43]
    ds_read_b128 v[120:123], v250 offset:45056
    v_mfma_f32_16x16x32_bf16 v[80:83], v[148:151], v[176:179], v[80:83]
    ds_read_b128 v[124:127], v250 offset:47104
    v_mfma_f32_16x16x32_bf16 v[44:47], v[144:147], v[180:183], v[44:47]
    ds_read_b128 v[128:131], v250 offset:49152
    s_add_u32 m0, s46, 36864
    v_mfma_f32_16x16x32_bf16 v[84:87], v[148:151], v[180:183], v[84:87]
    buffer_load_dwordx4 v3, s[8:11], s44 offen offset:0 lds
    v_mfma_f32_16x16x32_bf16 v[48:51], v[144:147], v[184:187], v[48:51]
    ds_read_b128 v[132:135], v250 offset:51200
    v_mfma_f32_16x16x32_bf16 v[88:91], v[148:151], v[184:187], v[88:91]
    ds_read_b128 v[136:139], v250 offset:53248
    v_mfma_f32_16x16x32_bf16 v[52:55], v[144:147], v[188:191], v[52:55]
    ds_read_b128 v[140:143], v250 offset:55296
    v_mfma_f32_16x16x32_bf16 v[92:95], v[148:151], v[188:191], v[92:95]
    s_waitcnt lgkmcnt(6)
    v_mfma_f32_16x16x32_bf16 v[16:19], v[96:99], v[104:107], v[16:19]
    ds_read_b128 v[144:147], v10 offset:36864
    ds_read_b64 v[202:203], v11 offset:152
    v_mfma_f32_16x16x32_bf16 v[56:59], v[100:103], v[104:107], v[56:59]
    ds_read_b128 v[148:151], v10 offset:38912
    ds_read_b64 v[204:205], v11 offset:3096
    v_mfma_f32_16x16x32_bf16 v[20:23], v[96:99], v[108:111], v[20:23]
    buffer_load_dword v254, v253, s[12:15], s60 offen sc1
    ds_read_b64 v[206:207], v11 offset:6040
    v_mfma_f32_16x16x32_bf16 v[60:63], v[100:103], v[108:111], v[60:63]
    ds_read_b128 v[152:155], v251 offset:36864
    ds_read_b64 v[208:209], v11 offset:8984
    v_mfma_f32_16x16x32_bf16 v[24:27], v[96:99], v[112:115], v[24:27]
    ds_read_b128 v[156:159], v251 offset:38912
    s_add_u32 m0, s45, 53248
    s_xor_b32 s1, s2, 9
    s_sub_u32 s66, s1, s0
    s_mov_b32 s0, s1
    s_lshl_b32 s66, s66, 7
    v_add_u32 v1, s66, v1
    v_mfma_f32_16x16x32_bf16 v[64:67], v[100:103], v[112:115], v[64:67]
    buffer_load_dwordx4 v1, s[4:7], s36 offen offset:0 lds
    s_waitcnt lgkmcnt(9)
    ds_read_b64 v[210:211], v11 offset:11928
    v_mfma_f32_16x16x32_bf16 v[28:31], v[96:99], v[116:119], v[28:31]
    ds_read_b128 v[160:163], v251 offset:40960
    v_mfma_f32_16x16x32_bf16 v[68:71], v[100:103], v[116:119], v[68:71]
    ds_read_b128 v[164:167], v251 offset:43008
    v_add_u32 v2, s66, v2
    v_mfma_f32_16x16x32_bf16 v[32:35], v[96:99], v[120:123], v[32:35]
    buffer_load_dwordx4 v2, s[4:7], s37 offen offset:1024 lds
    v_mfma_f32_16x16x32_bf16 v[72:75], v[100:103], v[120:123], v[72:75]
    ds_read_b128 v[168:171], v251 offset:45056
    v_mfma_f32_16x16x32_bf16 v[36:39], v[96:99], v[124:127], v[36:39]
    ds_read_b128 v[172:175], v251 offset:47104
    v_mfma_f32_16x16x32_bf16 v[76:79], v[100:103], v[124:127], v[76:79]
    v_mfma_f32_16x16x32_bf16 v[40:43], v[96:99], v[128:131], v[40:43]
    s_waitcnt lgkmcnt(9)
    ds_read_b128 v[176:179], v251 offset:49152
    v_mfma_f32_16x16x32_bf16 v[80:83], v[100:103], v[128:131], v[80:83]
    ds_read_b128 v[180:183], v251 offset:51200
    v_mfma_f32_16x16x32_bf16 v[44:47], v[96:99], v[132:135], v[44:47]
    buffer_load_dwordx4 v1, s[4:7], s38 offen offset:2048 lds
    v_mfma_f32_16x16x32_bf16 v[84:87], v[100:103], v[132:135], v[84:87]
    ds_read_b128 v[184:187], v251 offset:53248
    v_mfma_f32_16x16x32_bf16 v[48:51], v[96:99], v[136:139], v[48:51]
    ds_read_b128 v[188:191], v251 offset:55296
    v_mfma_f32_16x16x32_bf16 v[88:91], v[100:103], v[136:139], v[88:91]
    v_mfma_f32_16x16x32_bf16 v[52:55], v[96:99], v[140:143], v[52:55]
    v_mfma_f32_16x16x32_bf16 v[92:95], v[100:103], v[140:143], v[92:95]
    buffer_load_dwordx4 v2, s[4:7], s39 offen offset:3072 lds
    s_add_u32 m0, s46, 69632
    v_add_u32 v3, s66, v3
    s_waitcnt lgkmcnt(9)
    v_mfma_f32_16x16x32_bf16 v[16:19], v[144:147], v[152:155], v[16:19]
    buffer_load_dwordx4 v3, s[8:11], s40 offen offset:0 lds
    v_mfma_f32_16x16x32_bf16 v[56:59], v[148:151], v[152:155], v[56:59]
    v_add_u32 v4, s66, v4
    v_mfma_f32_16x16x32_bf16 v[20:23], v[144:147], v[156:159], v[20:23]
    buffer_load_dwordx4 v4, s[8:11], s41 offen offset:1024 lds
    v_mfma_f32_16x16x32_bf16 v[60:63], v[148:151], v[156:159], v[60:63]
    s_waitcnt vmcnt(7) lgkmcnt(0)
    s_barrier
    v_mfma_f32_16x16x32_bf16 v[24:27], v[144:147], v[160:163], v[24:27]
    ds_read_b128 v[96:99], v5 offset:0
    v_mfma_f32_16x16x32_bf16 v[64:67], v[148:151], v[160:163], v[64:67]
    ds_read_b128 v[100:103], v5 offset:2048
    v_mfma_f32_16x16x32_bf16 v[28:31], v[144:147], v[164:167], v[28:31]
    ds_read_b128 v[104:107], v7 offset:0
    v_mfma_f32_16x16x32_bf16 v[68:71], v[148:151], v[164:167], v[68:71]
    buffer_load_dwordx4 v3, s[8:11], s42 offen offset:2048 lds
    v_mfma_f32_16x16x32_bf16 v[32:35], v[144:147], v[168:171], v[32:35]
    ds_read_b128 v[108:111], v7 offset:2048
    v_mfma_f32_16x16x32_bf16 v[72:75], v[148:151], v[168:171], v[72:75]
    ds_read_b128 v[112:115], v7 offset:4096
    v_mfma_f32_16x16x32_bf16 v[36:39], v[144:147], v[172:175], v[36:39]
    ds_read_b128 v[116:119], v7 offset:6144
    v_mfma_f32_16x16x32_bf16 v[76:79], v[148:151], v[172:175], v[76:79]
    buffer_load_dwordx4 v4, s[8:11], s43 offen offset:3072 lds
    v_mfma_f32_16x16x32_bf16 v[40:43], v[144:147], v[176:179], v[40:43]
    ds_read_b128 v[120:123], v7 offset:8192
    v_mfma_f32_16x16x32_bf16 v[80:83], v[148:151], v[176:179], v[80:83]
    ds_read_b128 v[124:127], v7 offset:10240
    v_mfma_f32_16x16x32_bf16 v[44:47], v[144:147], v[180:183], v[44:47]
    ds_read_b128 v[128:131], v7 offset:12288
    s_add_u32 m0, s46, 73728
    v_mfma_f32_16x16x32_bf16 v[84:87], v[148:151], v[180:183], v[84:87]
    buffer_load_dwordx4 v3, s[8:11], s44 offen offset:0 lds
    v_mfma_f32_16x16x32_bf16 v[48:51], v[144:147], v[184:187], v[48:51]
    ds_read_b128 v[132:135], v7 offset:14336
    v_mfma_f32_16x16x32_bf16 v[88:91], v[148:151], v[184:187], v[88:91]
    ds_read_b128 v[136:139], v7 offset:16384
    v_mfma_f32_16x16x32_bf16 v[52:55], v[144:147], v[188:191], v[52:55]
    ds_read_b128 v[140:143], v7 offset:18432
    v_mfma_f32_16x16x32_bf16 v[92:95], v[148:151], v[188:191], v[92:95]
    v_xor_b32 v15, s28, v193
    v_bitop3_b32 v15, s29, v195, v15 bitop3:0xbe
    v_bitop3_b32 v15, s28, v197, v15 bitop3:0xbe
    v_cmp_ne_u32 vcc, 0, v15
    s_nop 1
    s_cbranch_vccnz pg1
pgd2:
    s_waitcnt lgkmcnt(6)
    v_mfma_f32_16x16x32_bf16 v[16:19], v[96:99], v[104:107], v[16:19]
    ds_read_b128 v[144:147], v6 offset:0
    ds_write_b32 v13, v196 offset:176
    v_mfma_f32_16x16x32_bf16 v[56:59], v[100:103], v[104:107], v[56:59]
    ds_read_b128 v[148:151], v6 offset:2048
    v_mul_f32 v192, s48, v192
    v_mfma_f32_16x16x32_bf16 v[20:23], v[96:99], v[108:111], v[20:23]
    v_mul_f32 v15, v192, v192
    v_fma_f32 v15, v194, s48, -v15
    v_mfma_f32_16x16x32_bf16 v[60:63], v[100:103], v[108:111], v[60:63]
    ds_read_b128 v[152:155], v8 offset:0
    v_max_f32 v15, 0, v15
    v_mfma_f32_16x16x32_bf16 v[24:27], v[96:99], v[112:115], v[24:27]
    ds_read_b128 v[156:159], v8 offset:2048
    v_add_f32 v15, 0x3727c5ac, v15
    v_mfma_f32_16x16x32_bf16 v[64:67], v[100:103], v[112:115], v[64:67]
    v_rsq_f32 v15, v15
    v_mfma_f32_16x16x32_bf16 v[28:31], v[96:99], v[116:119], v[28:31]
    ds_read_b128 v[160:163], v8 offset:4096
    v_mul_f32_e64 v192, v192, -v15
    v_mfma_f32_16x16x32_bf16 v[68:71], v[100:103], v[116:119], v[68:71]
    ds_read_b128 v[164:167], v8 offset:6144
    ds_write2st64_b32 v12, v15, v192 offset0:0 offset1:2
    s_waitcnt lgkmcnt(11)
    v_mfma_f32_16x16x32_bf16 v[32:35], v[96:99], v[120:123], v[32:35]
    ds_read_b64 v[212:213], v11 offset:160
    ds_read_b64 v[214:215], v11 offset:3104
    v_mfma_f32_16x16x32_bf16 v[72:75], v[100:103], v[120:123], v[72:75]
    ds_read_b128 v[168:171], v8 offset:8192
    s_waitcnt lgkmcnt(9)
    ds_read_b64 v[216:217], v11 offset:6048
    v_mfma_f32_16x16x32_bf16 v[36:39], v[96:99], v[124:127], v[36:39]
    ds_read_b128 v[172:175], v8 offset:10240
    ds_read_b64 v[218:219], v11 offset:8992
    v_mfma_f32_16x16x32_bf16 v[76:79], v[100:103], v[124:127], v[76:79]
    ds_read_b64 v[220:221], v11 offset:11936
    v_mfma_f32_16x16x32_bf16 v[40:43], v[96:99], v[128:131], v[40:43]
    ds_read_b128 v[176:179], v8 offset:12288
    v_mfma_f32_16x16x32_bf16 v[80:83], v[100:103], v[128:131], v[80:83]
    s_waitcnt lgkmcnt(9)
    ds_read_b128 v[180:183], v8 offset:14336
    v_mfma_f32_16x16x32_bf16 v[44:47], v[96:99], v[132:135], v[44:47]
    v_mfma_f32_16x16x32_bf16 v[84:87], v[100:103], v[132:135], v[84:87]
    ds_read_b128 v[184:187], v8 offset:16384
    v_mfma_f32_16x16x32_bf16 v[48:51], v[96:99], v[136:139], v[48:51]
    ds_read_b128 v[188:191], v8 offset:18432
    v_mfma_f32_16x16x32_bf16 v[88:91], v[100:103], v[136:139], v[88:91]
    v_mfma_f32_16x16x32_bf16 v[52:55], v[96:99], v[140:143], v[52:55]
    v_mfma_f32_16x16x32_bf16 v[92:95], v[100:103], v[140:143], v[92:95]
    s_waitcnt vmcnt(9)
    v_cmp_ne_u32 vcc, s28, v254
    s_nop 1
    s_cbranch_vccnz pb3
pbd4:
    v_mfma_f32_16x16x32_bf16 v[16:19], v[144:147], v[152:155], v[16:19]
    s_add_u32 s94, s47, 0
    buffer_load_dwordx4 a[0:3], v252, s[12:15], s94 offen sc1
    v_mfma_f32_16x16x32_bf16 v[56:59], v[148:151], v[152:155], v[56:59]
    v_mfma_f32_16x16x32_bf16 v[20:23], v[144:147], v[156:159], v[20:23]
    s_add_u32 s94, s47, 40960
    buffer_load_dwordx4 a[4:7], v252, s[12:15], s94 offen sc1
    v_mfma_f32_16x16x32_bf16 v[60:63], v[148:151], v[156:159], v[60:63]
    s_waitcnt vmcnt(2) lgkmcnt(0)
    s_barrier
    v_mfma_f32_16x16x32_bf16 v[24:27], v[144:147], v[160:163], v[24:27]
    ds_read_b128 v[96:99], v5 offset:36864
    v_mfma_f32_16x16x32_bf16 v[64:67], v[148:151], v[160:163], v[64:67]
    ds_read_b128 v[100:103], v5 offset:38912
    v_mfma_f32_16x16x32_bf16 v[28:31], v[144:147], v[164:167], v[28:31]
    ds_read_b128 v[104:107], v7 offset:36864
    v_mfma_f32_16x16x32_bf16 v[68:71], v[148:151], v[164:167], v[68:71]
    s_add_u32 s94, s47, 81920
    buffer_load_dwordx4 a[8:11], v252, s[12:15], s94 offen sc1
    v_mfma_f32_16x16x32_bf16 v[32:35], v[144:147], v[168:171], v[32:35]
    ds_read_b128 v[108:111], v7 offset:38912
    v_mfma_f32_16x16x32_bf16 v[72:75], v[148:151], v[168:171], v[72:75]
    ds_read_b128 v[112:115], v7 offset:40960
    v_mfma_f32_16x16x32_bf16 v[36:39], v[144:147], v[172:175], v[36:39]
    ds_read_b128 v[116:119], v7 offset:43008
    v_mfma_f32_16x16x32_bf16 v[76:79], v[148:151], v[172:175], v[76:79]
    s_add_u32 s94, s47, 122880
    buffer_load_dwordx4 a[12:15], v252, s[12:15], s94 offen sc1
    v_mfma_f32_16x16x32_bf16 v[40:43], v[144:147], v[176:179], v[40:43]
    ds_read_b128 v[120:123], v7 offset:45056
    v_mfma_f32_16x16x32_bf16 v[80:83], v[148:151], v[176:179], v[80:83]
    ds_read_b128 v[124:127], v7 offset:47104
    v_mfma_f32_16x16x32_bf16 v[44:47], v[144:147], v[180:183], v[44:47]
    ds_read_b128 v[128:131], v7 offset:49152
    v_mfma_f32_16x16x32_bf16 v[84:87], v[148:151], v[180:183], v[84:87]
    s_add_u32 s94, s47, 163840
    buffer_load_dwordx4 a[16:19], v252, s[12:15], s94 offen sc1
    v_mfma_f32_16x16x32_bf16 v[48:51], v[144:147], v[184:187], v[48:51]
    ds_read_b128 v[132:135], v7 offset:51200
    v_mfma_f32_16x16x32_bf16 v[88:91], v[148:151], v[184:187], v[88:91]
    ds_read_b128 v[136:139], v7 offset:53248
    v_mfma_f32_16x16x32_bf16 v[52:55], v[144:147], v[188:191], v[52:55]
    ds_read_b128 v[140:143], v7 offset:55296
    v_mfma_f32_16x16x32_bf16 v[92:95], v[148:151], v[188:191], v[92:95]
    s_waitcnt lgkmcnt(6)
    v_mfma_f32_16x16x32_bf16 v[16:19], v[96:99], v[104:107], v[16:19]
    ds_read_b128 v[144:147], v6 offset:36864
    ds_read_b64 v[192:193], v11 offset:144
    v_mfma_f32_16x16x32_bf16 v[56:59], v[100:103], v[104:107], v[56:59]
    ds_read_b128 v[148:151], v6 offset:38912
    ds_read_b64 v[194:195], v11 offset:3088
    v_mfma_f32_16x16x32_bf16 v[20:23], v[96:99], v[108:111], v[20:23]
    s_add_u32 s94, s47, 5120
    buffer_load_dwordx4 a[100:103], v252, s[12:15], s94 offen sc1
    ds_read_b64 v[196:197], v11 offset:6032
    v_mfma_f32_16x16x32_bf16 v[60:63], v[100:103], v[108:111], v[60:63]
    ds_read_b128 v[152:155], v8 offset:36864
    ds_read_b64 v[198:199], v11 offset:8976
    v_mfma_f32_16x16x32_bf16 v[24:27], v[96:99], v[112:115], v[24:27]
    ds_read_b128 v[156:159], v8 offset:38912
    s_waitcnt lgkmcnt(9)
    ds_read_b64 v[200:201], v11 offset:11920
    v_mfma_f32_16x16x32_bf16 v[64:67], v[100:103], v[112:115], v[64:67]
    s_add_u32 s94, s47, 46080
    buffer_load_dwordx4 a[104:107], v252, s[12:15], s94 offen sc1
    ds_read_b128 v[244:247], v239 offset:15248
    v_mfma_f32_16x16x32_bf16 v[28:31], v[96:99], v[116:119], v[28:31]
    ds_read_b128 v[160:163], v8 offset:40960
    ds_read_b128 v[240:243], v239 offset:15232
    v_mfma_f32_16x16x32_bf16 v[68:71], v[100:103], v[116:119], v[68:71]
    ds_read_b128 v[164:167], v8 offset:43008
    s_waitcnt lgkmcnt(9)
    ds_read_b128 v[232:235], v239 offset:14720
    v_mfma_f32_16x16x32_bf16 v[32:35], v[96:99], v[120:123], v[32:35]
    s_add_u32 s94, s47, 87040
    buffer_load_dwordx4 a[108:111], v252, s[12:15], s94 offen sc1
    ds_read_b128 v[236:239], v239 offset:14736
    v_mfma_f32_16x16x32_bf16 v[72:75], v[100:103], v[120:123], v[72:75]
    ds_read_b128 v[168:171], v8 offset:45056
    ds_read_b64 v[222:223], v11 offset:176
    v_mfma_f32_16x16x32_bf16 v[36:39], v[96:99], v[124:127], v[36:39]
    ds_read_b128 v[172:175], v8 offset:47104
    s_waitcnt lgkmcnt(9)
    ds_read_b64 v[224:225], v11 offset:3120
    v_mfma_f32_16x16x32_bf16 v[76:79], v[100:103], v[124:127], v[76:79]
    ds_read_b64 v[226:227], v11 offset:6064
    ds_read_b64 v[228:229], v11 offset:9008
    v_mfma_f32_16x16x32_bf16 v[40:43], v[96:99], v[128:131], v[40:43]
    ds_read_b128 v[176:179], v8 offset:49152
    ds_read_b64 v[230:231], v11 offset:11952
    v_mfma_f32_16x16x32_bf16 v[80:83], v[100:103], v[128:131], v[80:83]
    s_waitcnt lgkmcnt(9)
    ds_read_b128 v[180:183], v8 offset:51200
    v_mfma_f32_16x16x32_bf16 v[44:47], v[96:99], v[132:135], v[44:47]
    s_add_u32 s94, s47, 128000
    buffer_load_dwordx4 a[112:115], v252, s[12:15], s94 offen sc1
    v_mfma_f32_16x16x32_bf16 v[84:87], v[100:103], v[132:135], v[84:87]
    ds_read_b128 v[184:187], v8 offset:53248
    v_mfma_f32_16x16x32_bf16 v[48:51], v[96:99], v[136:139], v[48:51]
    ds_read_b128 v[188:191], v8 offset:55296
    v_mfma_f32_16x16x32_bf16 v[88:91], v[100:103], v[136:139], v[88:91]
    v_mfma_f32_16x16x32_bf16 v[52:55], v[96:99], v[140:143], v[52:55]
    v_mfma_f32_16x16x32_bf16 v[92:95], v[100:103], v[140:143], v[92:95]
    s_add_u32 s94, s47, 168960
    buffer_load_dwordx4 a[116:119], v252, s[12:15], s94 offen sc1
    v_mfma_f32_16x16x32_bf16 v[16:19], v[144:147], v[152:155], v[16:19]
    s_add_u32 s94, s47, 1024
    buffer_load_dwordx4 a[20:23], v252, s[12:15], s94 offen sc1
    v_mfma_f32_16x16x32_bf16 v[56:59], v[148:151], v[152:155], v[56:59]
    v_mfma_f32_16x16x32_bf16 v[20:23], v[144:147], v[156:159], v[20:23]
    s_add_u32 s94, s47, 41984
    buffer_load_dwordx4 a[24:27], v252, s[12:15], s94 offen sc1
    v_mfma_f32_16x16x32_bf16 v[60:63], v[148:151], v[156:159], v[60:63]
    s_waitcnt lgkmcnt(0)
    v_mfma_f32_16x16x32_bf16 v[24:27], v[144:147], v[160:163], v[24:27]
    v_mfma_f32_16x16x32_bf16 v[64:67], v[148:151], v[160:163], v[64:67]
    v_mfma_f32_16x16x32_bf16 v[28:31], v[144:147], v[164:167], v[28:31]
    v_mfma_f32_16x16x32_bf16 v[68:71], v[148:151], v[164:167], v[68:71]
    s_add_u32 s94, s47, 82944
    buffer_load_dwordx4 a[28:31], v252, s[12:15], s94 offen sc1
    v_mfma_f32_16x16x32_bf16 v[32:35], v[144:147], v[168:171], v[32:35]
    v_mfma_f32_16x16x32_bf16 v[72:75], v[148:151], v[168:171], v[72:75]
    v_mfma_f32_16x16x32_bf16 v[36:39], v[144:147], v[172:175], v[36:39]
    v_mfma_f32_16x16x32_bf16 v[76:79], v[148:151], v[172:175], v[76:79]
    s_add_u32 s94, s47, 123904
    buffer_load_dwordx4 a[32:35], v252, s[12:15], s94 offen sc1
    v_mfma_f32_16x16x32_bf16 v[40:43], v[144:147], v[176:179], v[40:43]
    v_mfma_f32_16x16x32_bf16 v[80:83], v[148:151], v[176:179], v[80:83]
    v_mfma_f32_16x16x32_bf16 v[44:47], v[144:147], v[180:183], v[44:47]
    v_mfma_f32_16x16x32_bf16 v[84:87], v[148:151], v[180:183], v[84:87]
    s_add_u32 s94, s47, 164864
    buffer_load_dwordx4 a[36:39], v252, s[12:15], s94 offen sc1
    v_mfma_f32_16x16x32_bf16 v[48:51], v[144:147], v[184:187], v[48:51]
    v_mfma_f32_16x16x32_bf16 v[88:91], v[148:151], v[184:187], v[88:91]
    v_mfma_f32_16x16x32_bf16 v[52:55], v[144:147], v[188:191], v[52:55]
    v_mfma_f32_16x16x32_bf16 v[92:95], v[148:151], v[188:191], v[92:95]
    v_accvgpr_read_b32 v13, a200
    v_accvgpr_read_b32 v10, a201
    v_accvgpr_read_b32 v6, a202
    v_mov_b32 v1, s28
    s_waitcnt lgkmcnt(0)
    v_pk_mul_f32 v[146:147], v[240:241], v[222:223] op_sel:[0,0] op_sel_hi:[1,0]
    v_pk_mul_f32 v[148:149], v[242:243], v[222:223] op_sel:[0,0] op_sel_hi:[1,0]
    v_pk_mul_f32 v[150:151], v[244:245], v[222:223] op_sel:[0,0] op_sel_hi:[1,0]
    v_pk_mul_f32 v[152:153], v[246:247], v[222:223] op_sel:[0,0] op_sel_hi:[1,0]
    v_pk_fma_f32 v[16:17], v[232:233], v[16:17], v[146:147]
    v_pk_fma_f32 v[18:19], v[234:235], v[18:19], v[148:149]
    v_pk_fma_f32 v[56:57], v[236:237], v[56:57], v[150:151]
    v_pk_fma_f32 v[58:59], v[238:239], v[58:59], v[152:153]
    v_pk_mul_f32 v[154:155], v[240:241], v[224:225] op_sel:[0,0] op_sel_hi:[1,0]
    v_pk_mul_f32 v[156:157], v[242:243], v[224:225] op_sel:[0,0] op_sel_hi:[1,0]
    v_pk_mul_f32 v[158:159], v[244:245], v[224:225] op_sel:[0,0] op_sel_hi:[1,0]
    v_pk_mul_f32 v[160:161], v[246:247], v[224:225] op_sel:[0,0] op_sel_hi:[1,0]
    v_pk_fma_f32 v[20:21], v[232:233], v[20:21], v[154:155]
    v_pk_fma_f32 v[22:23], v[234:235], v[22:23], v[156:157]
    s_add_u32 s94, s47, 6144
    buffer_load_dwordx4 a[120:123], v252, s[12:15], s94 offen sc1
    v_pk_fma_f32 v[60:61], v[236:237], v[60:61], v[158:159]
    v_pk_fma_f32 v[62:63], v[238:239], v[62:63], v[160:161]
    v_pk_mul_f32 v[146:147], v[240:241], v[226:227] op_sel:[0,0] op_sel_hi:[1,0]
    v_pk_mul_f32 v[148:149], v[242:243], v[226:227] op_sel:[0,0] op_sel_hi:[1,0]
    v_pk_mul_f32 v[150:151], v[244:245], v[226:227] op_sel:[0,0] op_sel_hi:[1,0]
    v_pk_mul_f32 v[152:153], v[246:247], v[226:227] op_sel:[0,0] op_sel_hi:[1,0]
    v_pk_fma_f32 v[24:25], v[232:233], v[24:25], v[146:147]
    v_pk_fma_f32 v[26:27], v[234:235], v[26:27], v[148:149]
    v_pk_fma_f32 v[64:65], v[236:237], v[64:65], v[150:151]
    v_pk_fma_f32 v[66:67], v[238:239], v[66:67], v[152:153]
    v_pk_mul_f32 v[154:155], v[240:241], v[228:229] op_sel:[0,0] op_sel_hi:[1,0]
    v_pk_mul_f32 v[156:157], v[242:243], v[228:229] op_sel:[0,0] op_sel_hi:[1,0]
    v_pk_mul_f32 v[158:159], v[244:245], v[228:229] op_sel:[0,0] op_sel_hi:[1,0]
    v_pk_mul_f32 v[160:161], v[246:247], v[228:229] op_sel:[0,0] op_sel_hi:[1,0]
    v_pk_fma_f32 v[28:29], v[232:233], v[28:29], v[154:155]
    s_add_u32 s94, s47, 47104
    buffer_load_dwordx4 a[124:127], v252, s[12:15], s94 offen sc1
    v_pk_fma_f32 v[30:31], v[234:235], v[30:31], v[156:157]
    v_pk_fma_f32 v[68:69], v[236:237], v[68:69], v[158:159]
    v_pk_fma_f32 v[70:71], v[238:239], v[70:71], v[160:161]
    v_pk_mul_f32 v[146:147], v[240:241], v[230:231] op_sel:[0,0] op_sel_hi:[1,0]
    v_pk_mul_f32 v[148:149], v[242:243], v[230:231] op_sel:[0,0] op_sel_hi:[1,0]
    v_pk_mul_f32 v[150:151], v[244:245], v[230:231] op_sel:[0,0] op_sel_hi:[1,0]
    v_pk_mul_f32 v[152:153], v[246:247], v[230:231] op_sel:[0,0] op_sel_hi:[1,0]
    v_pk_fma_f32 v[32:33], v[232:233], v[32:33], v[146:147]
    v_pk_fma_f32 v[34:35], v[234:235], v[34:35], v[148:149]
    v_pk_fma_f32 v[72:73], v[236:237], v[72:73], v[150:151]
    v_pk_fma_f32 v[74:75], v[238:239], v[74:75], v[152:153]
    v_pk_mul_f32 v[154:155], v[240:241], v[222:223] op_sel:[0,1] op_sel_hi:[1,1]
    v_pk_mul_f32 v[156:157], v[242:243], v[222:223] op_sel:[0,1] op_sel_hi:[1,1]
    v_pk_mul_f32 v[158:159], v[244:245], v[222:223] op_sel:[0,1] op_sel_hi:[1,1]
    s_add_u32 s94, s47, 88064
    buffer_load_dwordx4 a[128:131], v252, s[12:15], s94 offen sc1
    v_pk_mul_f32 v[160:161], v[246:247], v[222:223] op_sel:[0,1] op_sel_hi:[1,1]
    v_pk_fma_f32 v[36:37], v[232:233], v[36:37], v[154:155]
    v_pk_fma_f32 v[38:39], v[234:235], v[38:39], v[156:157]
    v_pk_fma_f32 v[76:77], v[236:237], v[76:77], v[158:159]
    v_pk_fma_f32 v[78:79], v[238:239], v[78:79], v[160:161]
    v_pk_mul_f32 v[146:147], v[240:241], v[224:225] op_sel:[0,1] op_sel_hi:[1,1]
    v_pk_mul_f32 v[148:149], v[242:243], v[224:225] op_sel:[0,1] op_sel_hi:[1,1]
    v_pk_mul_f32 v[150:151], v[244:245], v[224:225] op_sel:[0,1] op_sel_hi:[1,1]
    v_pk_mul_f32 v[152:153], v[246:247], v[224:225] op_sel:[0,1] op_sel_hi:[1,1]
    v_pk_fma_f32 v[40:41], v[232:233], v[40:41], v[146:147]
    v_pk_fma_f32 v[42:43], v[234:235], v[42:43], v[148:149]
    v_pk_fma_f32 v[80:81], v[236:237], v[80:81], v[150:151]
    v_pk_fma_f32 v[82:83], v[238:239], v[82:83], v[152:153]
    v_pk_mul_f32 v[154:155], v[240:241], v[226:227] op_sel:[0,1] op_sel_hi:[1,1]
    v_pk_mul_f32 v[156:157], v[242:243], v[226:227] op_sel:[0,1] op_sel_hi:[1,1]
    s_add_u32 s94, s47, 129024
    buffer_load_dwordx4 a[132:135], v252, s[12:15], s94 offen sc1
    v_pk_mul_f32 v[158:159], v[244:245], v[226:227] op_sel:[0,1] op_sel_hi:[1,1]
    v_pk_mul_f32 v[160:161], v[246:247], v[226:227] op_sel:[0,1] op_sel_hi:[1,1]
    v_pk_fma_f32 v[44:45], v[232:233], v[44:45], v[154:155]
    v_pk_fma_f32 v[46:47], v[234:235], v[46:47], v[156:157]
    v_pk_fma_f32 v[84:85], v[236:237], v[84:85], v[158:159]
    v_pk_fma_f32 v[86:87], v[238:239], v[86:87], v[160:161]
    v_pk_mul_f32 v[146:147], v[240:241], v[228:229] op_sel:[0,1] op_sel_hi:[1,1]
    v_pk_mul_f32 v[148:149], v[242:243], v[228:229] op_sel:[0,1] op_sel_hi:[1,1]
    v_pk_mul_f32 v[150:151], v[244:245], v[228:229] op_sel:[0,1] op_sel_hi:[1,1]
    v_pk_mul_f32 v[152:153], v[246:247], v[228:229] op_sel:[0,1] op_sel_hi:[1,1]
    v_pk_fma_f32 v[48:49], v[232:233], v[48:49], v[146:147]
    v_pk_fma_f32 v[50:51], v[234:235], v[50:51], v[148:149]
    v_pk_fma_f32 v[88:89], v[236:237], v[88:89], v[150:151]
    v_pk_fma_f32 v[90:91], v[238:239], v[90:91], v[152:153]
    s_add_u32 s94, s47, 169984
    buffer_load_dwordx4 a[136:139], v252, s[12:15], s94 offen sc1
    v_pk_mul_f32 v[154:155], v[240:241], v[230:231] op_sel:[0,1] op_sel_hi:[1,1]
    v_pk_mul_f32 v[156:157], v[242:243], v[230:231] op_sel:[0,1] op_sel_hi:[1,1]
    v_pk_mul_f32 v[158:159], v[244:245], v[230:231] op_sel:[0,1] op_sel_hi:[1,1]
    v_pk_mul_f32 v[160:161], v[246:247], v[230:231] op_sel:[0,1] op_sel_hi:[1,1]
    v_pk_fma_f32 v[52:53], v[232:233], v[52:53], v[154:155]
    v_pk_fma_f32 v[54:55], v[234:235], v[54:55], v[156:157]
    v_pk_fma_f32 v[92:93], v[236:237], v[92:93], v[158:159]
    v_pk_fma_f32 v[94:95], v[238:239], v[94:95], v[160:161]
    v_pk_fma_f32 v[96:97], v[16:17], v[212:213], v[56:57] op_sel:[0,0,0] op_sel_hi:[1,0,1]
    v_pk_fma_f32 v[98:99], v[18:19], v[212:213], v[58:59] op_sel:[0,0,0] op_sel_hi:[1,0,1]
    v_pk_fma_f32 v[104:105], v[20:21], v[214:215], v[60:61] op_sel:[0,0,0] op_sel_hi:[1,0,1]
    v_pk_fma_f32 v[106:107], v[22:23], v[214:215], v[62:63] op_sel:[0,0,0] op_sel_hi:[1,0,1]
    v_pk_fma_f32 v[112:113], v[24:25], v[216:217], v[64:65] op_sel:[0,0,0] op_sel_hi:[1,0,1]
    v_pk_fma_f32 v[114:115], v[26:27], v[216:217], v[66:67] op_sel:[0,0,0] op_sel_hi:[1,0,1]
    v_pk_fma_f32 v[120:121], v[28:29], v[218:219], v[68:69] op_sel:[0,0,0] op_sel_hi:[1,0,1]
    s_add_u32 s94, s47, 2048
    buffer_load_dwordx4 a[40:43], v252, s[12:15], s94 offen sc1
    v_pk_fma_f32 v[122:123], v[30:31], v[218:219], v[70:71] op_sel:[0,0,0] op_sel_hi:[1,0,1]
    v_pk_fma_f32 v[128:129], v[32:33], v[220:221], v[72:73] op_sel:[0,0,0] op_sel_hi:[1,0,1]
    v_pk_fma_f32 v[130:131], v[34:35], v[220:221], v[74:75] op_sel:[0,0,0] op_sel_hi:[1,0,1]
    v_pk_fma_f32 v[100:101], v[36:37], v[212:213], v[76:77] op_sel:[0,0,0] op_sel_hi:[1,0,1]
    v_pk_fma_f32 v[102:103], v[38:39], v[212:213], v[78:79] op_sel:[0,0,0] op_sel_hi:[1,0,1]
    v_pk_fma_f32 v[108:109], v[40:41], v[214:215], v[80:81] op_sel:[0,0,0] op_sel_hi:[1,0,1]
    v_pk_fma_f32 v[110:111], v[42:43], v[214:215], v[82:83] op_sel:[0,0,0] op_sel_hi:[1,0,1]
    v_pk_fma_f32 v[116:117], v[44:45], v[216:217], v[84:85] op_sel:[0,0,0] op_sel_hi:[1,0,1]
    v_pk_fma_f32 v[118:119], v[46:47], v[216:217], v[86:87] op_sel:[0,0,0] op_sel_hi:[1,0,1]
    v_pk_fma_f32 v[124:125], v[48:49], v[218:219], v[88:89] op_sel:[0,0,0] op_sel_hi:[1,0,1]
    v_pk_fma_f32 v[126:127], v[50:51], v[218:219], v[90:91] op_sel:[0,0,0] op_sel_hi:[1,0,1]
    v_pk_fma_f32 v[132:133], v[52:53], v[220:221], v[92:93] op_sel:[0,0,0] op_sel_hi:[1,0,1]
    v_pk_fma_f32 v[134:135], v[54:55], v[220:221], v[94:95] op_sel:[0,0,0] op_sel_hi:[1,0,1]
    v_pk_fma_f32 v[96:97], v[36:37], v[212:213], v[96:97] op_sel:[0,1,0] op_sel_hi:[1,1,1] neg_lo:[1,0,0] neg_hi:[1,0,0]
    s_add_u32 s94, s47, 43008
    buffer_load_dwordx4 a[44:47], v252, s[12:15], s94 offen sc1
    v_pk_fma_f32 v[98:99], v[38:39], v[212:213], v[98:99] op_sel:[0,1,0] op_sel_hi:[1,1,1] neg_lo:[1,0,0] neg_hi:[1,0,0]
    v_pk_fma_f32 v[104:105], v[40:41], v[214:215], v[104:105] op_sel:[0,1,0] op_sel_hi:[1,1,1] neg_lo:[1,0,0] neg_hi:[1,0,0]
    v_pk_fma_f32 v[106:107], v[42:43], v[214:215], v[106:107] op_sel:[0,1,0] op_sel_hi:[1,1,1] neg_lo:[1,0,0] neg_hi:[1,0,0]
    v_pk_fma_f32 v[112:113], v[44:45], v[216:217], v[112:113] op_sel:[0,1,0] op_sel_hi:[1,1,1] neg_lo:[1,0,0] neg_hi:[1,0,0]
    v_pk_fma_f32 v[114:115], v[46:47], v[216:217], v[114:115] op_sel:[0,1,0] op_sel_hi:[1,1,1] neg_lo:[1,0,0] neg_hi:[1,0,0]
    v_pk_fma_f32 v[120:121], v[48:49], v[218:219], v[120:121] op_sel:[0,1,0] op_sel_hi:[1,1,1] neg_lo:[1,0,0] neg_hi:[1,0,0]
    v_pk_fma_f32 v[122:123], v[50:51], v[218:219], v[122:123] op_sel:[0,1,0] op_sel_hi:[1,1,1] neg_lo:[1,0,0] neg_hi:[1,0,0]
    v_pk_fma_f32 v[128:129], v[52:53], v[220:221], v[128:129] op_sel:[0,1,0] op_sel_hi:[1,1,1] neg_lo:[1,0,0] neg_hi:[1,0,0]
    v_pk_fma_f32 v[130:131], v[54:55], v[220:221], v[130:131] op_sel:[0,1,0] op_sel_hi:[1,1,1] neg_lo:[1,0,0] neg_hi:[1,0,0]
    v_pk_fma_f32 v[100:101], v[16:17], v[212:213], v[100:101] op_sel:[0,1,0] op_sel_hi:[1,1,1]
    v_pk_fma_f32 v[102:103], v[18:19], v[212:213], v[102:103] op_sel:[0,1,0] op_sel_hi:[1,1,1]
    v_pk_fma_f32 v[108:109], v[20:21], v[214:215], v[108:109] op_sel:[0,1,0] op_sel_hi:[1,1,1]
    v_pk_fma_f32 v[110:111], v[22:23], v[214:215], v[110:111] op_sel:[0,1,0] op_sel_hi:[1,1,1]
    v_pk_fma_f32 v[116:117], v[24:25], v[216:217], v[116:117] op_sel:[0,1,0] op_sel_hi:[1,1,1]
    v_pk_fma_f32 v[118:119], v[26:27], v[216:217], v[118:119] op_sel:[0,1,0] op_sel_hi:[1,1,1]
    s_add_u32 s94, s47, 83968
    buffer_load_dwordx4 a[48:51], v252, s[12:15], s94 offen sc1
    v_pk_fma_f32 v[124:125], v[28:29], v[218:219], v[124:125] op_sel:[0,1,0] op_sel_hi:[1,1,1]
    v_pk_fma_f32 v[126:127], v[30:31], v[218:219], v[126:127] op_sel:[0,1,0] op_sel_hi:[1,1,1]
    v_pk_fma_f32 v[132:133], v[32:33], v[220:221], v[132:133] op_sel:[0,1,0] op_sel_hi:[1,1,1]
    v_pk_fma_f32 v[134:135], v[34:35], v[220:221], v[134:135] op_sel:[0,1,0] op_sel_hi:[1,1,1]
    v_pk_fma_f32 v[98:99], v[96:97], v[202:203], v[98:99] op_sel:[0,0,0] op_sel_hi:[1,0,1]
    v_pk_fma_f32 v[106:107], v[104:105], v[204:205], v[106:107] op_sel:[0,0,0] op_sel_hi:[1,0,1]
    v_pk_fma_f32 v[114:115], v[112:113], v[206:207], v[114:115] op_sel:[0,0,0] op_sel_hi:[1,0,1]
    v_pk_fma_f32 v[122:123], v[120:121], v[208:209], v[122:123] op_sel:[0,0,0] op_sel_hi:[1,0,1]
    v_pk_fma_f32 v[130:131], v[128:129], v[210:211], v[130:131] op_sel:[0,0,0] op_sel_hi:[1,0,1]
    v_pk_fma_f32 v[102:103], v[100:101], v[202:203], v[102:103] op_sel:[0,0,0] op_sel_hi:[1,0,1]
    v_pk_fma_f32 v[110:111], v[108:109], v[204:205], v[110:111] op_sel:[0,0,0] op_sel_hi:[1,0,1]
    v_pk_fma_f32 v[118:119], v[116:117], v[206:207], v[118:119] op_sel:[0,0,0] op_sel_hi:[1,0,1]
    v_pk_fma_f32 v[126:127], v[124:125], v[208:209], v[126:127] op_sel:[0,0,0] op_sel_hi:[1,0,1]
    v_pk_fma_f32 v[134:135], v[132:133], v[210:211], v[134:135] op_sel:[0,0,0] op_sel_hi:[1,0,1]
    s_add_u32 s94, s47, 124928
    buffer_load_dwordx4 a[52:55], v252, s[12:15], s94 offen sc1
    v_pk_fma_f32 v[98:99], v[100:101], v[202:203], v[98:99] op_sel:[0,1,0] op_sel_hi:[1,1,1] neg_lo:[1,0,0] neg_hi:[1,0,0]
    v_pk_fma_f32 v[106:107], v[108:109], v[204:205], v[106:107] op_sel:[0,1,0] op_sel_hi:[1,1,1] neg_lo:[1,0,0] neg_hi:[1,0,0]
    v_pk_fma_f32 v[114:115], v[116:117], v[206:207], v[114:115] op_sel:[0,1,0] op_sel_hi:[1,1,1] neg_lo:[1,0,0] neg_hi:[1,0,0]
    v_pk_fma_f32 v[122:123], v[124:125], v[208:209], v[122:123] op_sel:[0,1,0] op_sel_hi:[1,1,1] neg_lo:[1,0,0] neg_hi:[1,0,0]
    v_pk_fma_f32 v[130:131], v[132:133], v[210:211], v[130:131] op_sel:[0,1,0] op_sel_hi:[1,1,1] neg_lo:[1,0,0] neg_hi:[1,0,0]
    v_pk_fma_f32 v[102:103], v[96:97], v[202:203], v[102:103] op_sel:[0,1,0] op_sel_hi:[1,1,1]
    v_pk_fma_f32 v[110:111], v[104:105], v[204:205], v[110:111] op_sel:[0,1,0] op_sel_hi:[1,1,1]
    v_pk_fma_f32 v[118:119], v[112:113], v[206:207], v[118:119] op_sel:[0,1,0] op_sel_hi:[1,1,1]
    v_pk_fma_f32 v[126:127], v[120:121], v[208:209], v[126:127] op_sel:[0,1,0] op_sel_hi:[1,1,1]
    v_pk_fma_f32 v[134:135], v[128:129], v[210:211], v[134:135] op_sel:[0,1,0] op_sel_hi:[1,1,1]
    v_fma_f32 v136, v192, v98, v99
    v_fma_f32 v137, v192, v102, v103
    v_fma_f32 v138, v194, v106, v107
    v_fma_f32 v139, v194, v110, v111
    v_fma_f32 v140, v196, v114, v115
    s_add_u32 s94, s47, 165888
    buffer_load_dwordx4 a[56:59], v252, s[12:15], s94 offen sc1
    v_fma_f32 v141, v196, v118, v119
    v_fma_f32 v142, v198, v122, v123
    v_fma_f32 v143, v198, v126, v127
    v_fma_f32 v144, v200, v130, v131
    v_fma_f32 v145, v200, v134, v135
    v_fma_f32 v136, -v193, v102, v136
    v_fma_f32 v137, v193, v98, v137
    v_fma_f32 v138, -v195, v110, v138
    v_fma_f32 v139, v195, v106, v139
    v_fma_f32 v140, -v197, v118, v140
    v_fma_f32 v141, v197, v114, v141
    v_fma_f32 v142, -v199, v126, v142
    v_fma_f32 v143, v199, v122, v143
    v_fma_f32 v144, -v201, v134, v144
    v_fma_f32 v145, v201, v130, v145
    ds_write_b128 v13, v[136:139] offset:16384
    ds_write_b128 v13, v[140:143] offset:16400
    ds_write_b64 v13, v[144:145] offset:16416
    v_mov_b32 v129, s28
    v_mov_b32 v131, s29
    s_waitcnt lgkmcnt(0)
    s_barrier
    ds_read_b64 v[96:97], v10 offset:16384
    ds_read_b64 v[98:99], v10 offset:17152
    ds_read_b64 v[100:101], v10 offset:17920
    ds_read_b64 v[102:103], v10 offset:18688
    ds_read_b64 v[104:105], v10 offset:19456
    ds_read_b64 v[106:107], v10 offset:20224
    ds_read_b64 v[108:109], v10 offset:20992
    ds_read_b64 v[110:111], v10 offset:21760
    ds_read_b64 v[112:113], v10 offset:22528
    ds_read_b64 v[114:115], v10 offset:23296
    ds_read_b64 v[116:117], v10 offset:24064
    ds_read_b64 v[118:119], v10 offset:24832
    ds_read_b64 v[120:121], v10 offset:25600
    ds_read_b64 v[122:123], v10 offset:26368
    s_waitcnt lgkmcnt(9)
    ds_read_b64 v[124:125], v10 offset:27136
    ds_read_b64 v[126:127], v10 offset:27904
    v_fmac_f32 v98, v248, v96
    v_fmac_f32 v99, v248, v97
    v_fma_f32 v98, -v249, v97, v98
    v_fmac_f32 v99, v249, v96
    v_fmac_f32 v100, v248, v98
    v_fmac_f32 v101, v248, v99
    v_fma_f32 v100, -v249, v99, v100
    v_fmac_f32 v101, v249, v98
    v_fmac_f32 v102, v248, v100
    v_fmac_f32 v103, v248, v101
    v_fma_f32 v102, -v249, v101, v102
    v_fmac_f32 v103, v249, v100
    v_fmac_f32 v104, v248, v102
    v_fmac_f32 v105, v248, v103
    v_fma_f32 v104, -v249, v103, v104
    v_fmac_f32 v105, v249, v102
    s_waitcnt lgkmcnt(10)
    v_fmac_f32 v106, v248, v104
    v_fmac_f32 v107, v248, v105
    v_fma_f32 v106, -v249, v105, v106
    v_fmac_f32 v107, v249, v104
    s_waitcnt lgkmcnt(9)
    v_fmac_f32 v108, v248, v106
    v_fmac_f32 v109, v248, v107
    v_fma_f32 v108, -v249, v107, v108
    v_fmac_f32 v109, v249, v106
    s_waitcnt lgkmcnt(8)
    v_fmac_f32 v110, v248, v108
    v_fmac_f32 v111, v248, v109
    v_fma_f32 v110, -v249, v109, v110
    v_fmac_f32 v111, v249, v108
    s_waitcnt lgkmcnt(7)
    v_fmac_f32 v112, v248, v110
    v_fmac_f32 v113, v248, v111
    v_fma_f32 v112, -v249, v111, v112
    v_fmac_f32 v113, v249, v110
    s_waitcnt lgkmcnt(6)
    v_fmac_f32 v114, v248, v112
    v_fmac_f32 v115, v248, v113
    v_fma_f32 v114, -v249, v113, v114
    v_fmac_f32 v115, v249, v112
    s_waitcnt lgkmcnt(5)
    v_fmac_f32 v116, v248, v114
    v_fmac_f32 v117, v248, v115
    v_fma_f32 v116, -v249, v115, v116
    v_fmac_f32 v117, v249, v114
    s_waitcnt lgkmcnt(4)
    v_fmac_f32 v118, v248, v116
    v_fmac_f32 v119, v248, v117
    v_fma_f32 v118, -v249, v117, v118
    v_fmac_f32 v119, v249, v116
    s_waitcnt lgkmcnt(3)
    v_fmac_f32 v120, v248, v118
    v_fmac_f32 v121, v248, v119
    v_fma_f32 v120, -v249, v119, v120
    v_fmac_f32 v121, v249, v118
    s_waitcnt lgkmcnt(2)
    v_fmac_f32 v122, v248, v120
    v_fmac_f32 v123, v248, v121
    v_fma_f32 v122, -v249, v121, v122
    v_fmac_f32 v123, v249, v120
    s_waitcnt lgkmcnt(1)
    v_fmac_f32 v124, v248, v122
    v_fmac_f32 v125, v248, v123
    v_fma_f32 v124, -v249, v123, v124
    v_fmac_f32 v125, v249, v122
    s_waitcnt lgkmcnt(0)
    v_fmac_f32 v126, v248, v124
    v_fmac_f32 v127, v248, v125
    v_fma_f32 v128, -v249, v125, v126
    v_fma_f32 v130, v249, v124, v127
    s_mov_b64 exec, 0xfffff
    buffer_store_dwordx4 v[128:131], v6, s[12:15], s78 offen sc1
    s_mov_b64 exec, -1
    ds_write_b64 v10, v[98:99] offset:17152
    ds_write_b64 v10, v[100:101] offset:17920
    ds_write_b64 v10, v[102:103] offset:18688
    ds_write_b64 v10, v[104:105] offset:19456
    ds_write_b64 v10, v[106:107] offset:20224
    ds_write_b64 v10, v[108:109] offset:20992
    ds_write_b64 v10, v[110:111] offset:21760
    ds_write_b64 v10, v[112:113] offset:22528
    ds_write_b64 v10, v[114:115] offset:23296
    ds_write_b64 v10, v[116:117] offset:24064
    ds_write_b64 v10, v[118:119] offset:24832
    ds_write_b64 v10, v[120:121] offset:25600
    ds_write_b64 v10, v[122:123] offset:26368
    ds_write_b64 v10, v[124:125] offset:27136
    v_accvgpr_read_b32 v132, a252
    v_accvgpr_read_b32 v133, a253
    v_accvgpr_read_b32 v134, a254
    v_accvgpr_read_b32 v135, a255
    v_accvgpr_read_b32 v5, a203
    v_mul_f32 v174, v132, v132
    v_fma_f32 v174, v133, v133, v174
    v_rcp_f32 v174, v174
    v_add_f32 v134, -1.0, v134
    v_mul_f32 v166, v134, v132
    v_mul_f32 v167, v135, v132
    v_add_f32 v174, v174, v174
    s_add_u32 s94, s47, 7168
    buffer_load_dwordx4 a[140:143], v252, s[12:15], s94 offen sc1
    v_fma_f32 v166, v135, v133, v166
    v_fma_f32 v167, -v134, v133, v167
    v_mul_f32 v166, v166, v174
    v_mul_f32 v167, v167, v174
    s_waitcnt lgkmcnt(9)
    ds_write_b64 v5, v[166:167] offset:0
    v_mul_f32 v168, v248, v166
    v_mul_f32 v169, v248, v167
    v_fma_f32 v168, -v249, v167, v168
    v_fmac_f32 v169, v249, v166
    ds_write_b64 v5, v[168:169] offset:8
    v_mul_f32 v170, v248, v168
    v_mul_f32 v171, v248, v169
    v_fma_f32 v170, -v249, v169, v170
    v_fmac_f32 v171, v249, v168
    ds_write_b64 v5, v[170:171] offset:16
    v_mul_f32 v172, v248, v170
    v_mul_f32 v173, v248, v171
    v_fma_f32 v172, -v249, v171, v172
    v_fmac_f32 v173, v249, v170
    ds_write_b64 v5, v[172:173] offset:24
    v_mul_f32 v166, v248, v172
    v_mul_f32 v167, v248, v173
    v_fma_f32 v166, -v249, v173, v166
    v_fmac_f32 v167, v249, v172
    ds_write_b64 v5, v[166:167] offset:32
    v_mul_f32 v168, v248, v166
    v_mul_f32 v169, v248, v167
    s_add_u32 s94, s47, 48128
    buffer_load_dwordx4 a[144:147], v252, s[12:15], s94 offen sc1
    v_fma_f32 v168, -v249, v167, v168
    v_fmac_f32 v169, v249, v166
    s_waitcnt lgkmcnt(9)
    ds_write_b64 v5, v[168:169] offset:40
    v_mul_f32 v170, v248, v168
    v_mul_f32 v171, v248, v169
    v_fma_f32 v170, -v249, v169, v170
    v_fmac_f32 v171, v249, v168
    ds_write_b64 v5, v[170:171] offset:48
    v_mul_f32 v172, v248, v170
    v_mul_f32 v173, v248, v171
    v_fma_f32 v172, -v249, v171, v172
    v_fmac_f32 v173, v249, v170
    ds_write_b64 v5, v[172:173] offset:56
    v_mul_f32 v166, v248, v172
    v_mul_f32 v167, v248, v173
    v_fma_f32 v166, -v249, v173, v166
    v_fmac_f32 v167, v249, v172
    ds_write_b64 v5, v[166:167] offset:64
    v_mul_f32 v168, v248, v166
    v_mul_f32 v169, v248, v167
    v_fma_f32 v168, -v249, v167, v168
    v_fmac_f32 v169, v249, v166
    ds_write_b64 v5, v[168:169] offset:72
    v_mul_f32 v170, v248, v168
    v_mul_f32 v171, v248, v169
    v_fma_f32 v170, -v249, v169, v170
    s_add_u32 s94, s47, 89088
    buffer_load_dwordx4 a[148:151], v252, s[12:15], s94 offen sc1
    v_fmac_f32 v171, v249, v168
    s_waitcnt lgkmcnt(9)
    ds_write_b64 v5, v[170:171] offset:80
    v_mul_f32 v172, v248, v170
    v_mul_f32 v173, v248, v171
    v_fma_f32 v172, -v249, v171, v172
    v_fmac_f32 v173, v249, v170
    ds_write_b64 v5, v[172:173] offset:88
    v_mul_f32 v166, v248, v172
    v_mul_f32 v167, v248, v173
    v_fma_f32 v166, -v249, v173, v166
    v_fmac_f32 v167, v249, v172
    ds_write_b64 v5, v[166:167] offset:96
    v_mul_f32 v168, v248, v166
    v_mul_f32 v169, v248, v167
    v_fma_f32 v168, -v249, v167, v168
    v_fmac_f32 v169, v249, v166
    ds_write_b64 v5, v[168:169] offset:104
    v_mul_f32 v170, v248, v168
    v_mul_f32 v171, v248, v169
    v_fma_f32 v170, -v249, v169, v170
    v_fmac_f32 v171, v249, v168
    ds_write_b64 v5, v[170:171] offset:112
    v_mul_f32 v172, v248, v170
    v_mul_f32 v173, v248, v171
    v_fma_f32 v172, -v249, v171, v172
    v_fmac_f32 v173, v249, v170
    s_waitcnt lgkmcnt(9)
    ds_write_b64 v5, v[172:173] offset:120
    s_add_u32 s94, s47, 130048
    buffer_load_dwordx4 a[152:155], v252, s[12:15], s94 offen sc1
    v_accvgpr_read_b32 v6, a204
    s_add_u32 s53, s79, 3840
    s_mov_b32 s52, s79
    v_accvgpr_read_b32 v5, a205
    s_waitcnt lgkmcnt(0)
    s_barrier
    ds_read_b64 v[202:203], v11 offset:0
    ds_read_b64 v[204:205], v11 offset:2944
    ds_read_b64 v[206:207], v11 offset:5888
    ds_read_b64 v[208:209], v11 offset:8832
    ds_read_b64 v[210:211], v11 offset:11776
    ds_read_b128 v[136:139], v13 offset:15616
    ds_read_b128 v[140:143], v13 offset:15632
    ds_read_b64 v[144:145], v13 offset:15648
    ds_read_b64 v[146:147], v5 offset:0
    ds_read_b64 v[148:149], v5 offset:2944
    ds_read_b64 v[150:151], v5 offset:5888
    ds_read_b64 v[152:153], v5 offset:8832
    ds_read_b64 v[154:155], v5 offset:11776
    v_accvgpr_read_b32 v116, a250
    v_accvgpr_read_b32 v117, a251
    v_mov_b32 v123, 0x43000000
    v_accvgpr_read_b32 v10, a206
    v_mul_f32 v122, v10, v117
    v_mul_f32 v124, v123, v117
    v_mul_f32 v120, v10, v116
    s_add_u32 s94, s47, 171008
    buffer_load_dwordx4 a[156:159], v252, s[12:15], s94 offen sc1
    v_mul_f32 v118, v123, v116
    v_fract_f32 v122, v122
    v_fract_f32 v124, v124
    v_exp_f32 v120, v120
    v_exp_f32 v118, v118
    v_sin_f32 v121, v122
    v_sin_f32 v119, v124
    v_cos_f32 v122, v122
    v_cos_f32 v124, v124
    v_mul_f32 v121, v121, v120
    v_mul_f32 v119, v119, v118
    v_mul_f32 v120, v122, v120
    v_mul_f32 v118, v124, v118
    s_waitcnt lgkmcnt(8)
    v_pk_mul_f32 v[166:167], v[16:17], v[202:203] op_sel:[0,0] op_sel_hi:[1,0]
    v_pk_mul_f32 v[168:169], v[16:17], v[202:203] op_sel:[0,1] op_sel_hi:[1,1]
    v_pk_fma_f32 v[16:17], v[36:37], v[202:203], v[166:167] op_sel:[0,1,0] op_sel_hi:[1,1,1] neg_lo:[1,0,0] neg_hi:[1,0,0]
    v_pk_fma_f32 v[36:37], v[36:37], v[202:203], v[168:169] op_sel:[0,0,0] op_sel_hi:[1,0,1]
    v_pk_mul_f32 v[170:171], v[18:19], v[202:203] op_sel:[0,0] op_sel_hi:[1,0]
    v_pk_mul_f32 v[172:173], v[18:19], v[202:203] op_sel:[0,1] op_sel_hi:[1,1]
    v_pk_fma_f32 v[18:19], v[38:39], v[202:203], v[170:171] op_sel:[0,1,0] op_sel_hi:[1,1,1] neg_lo:[1,0,0] neg_hi:[1,0,0]
    v_pk_fma_f32 v[38:39], v[38:39], v[202:203], v[172:173] op_sel:[0,0,0] op_sel_hi:[1,0,1]
    v_pk_mul_f32 v[166:167], v[56:57], v[202:203] op_sel:[0,0] op_sel_hi:[1,0]
    v_pk_mul_f32 v[168:169], v[56:57], v[202:203] op_sel:[0,1] op_sel_hi:[1,1]
    v_pk_fma_f32 v[56:57], v[76:77], v[202:203], v[166:167] op_sel:[0,1,0] op_sel_hi:[1,1,1] neg_lo:[1,0,0] neg_hi:[1,0,0]
    v_pk_fma_f32 v[76:77], v[76:77], v[202:203], v[168:169] op_sel:[0,0,0] op_sel_hi:[1,0,1]
    v_pk_mul_f32 v[170:171], v[58:59], v[202:203] op_sel:[0,0] op_sel_hi:[1,0]
    s_add_u32 s94, s47, 3072
    buffer_load_dwordx4 a[60:63], v252, s[12:15], s94 offen sc1
    v_pk_mul_f32 v[172:173], v[58:59], v[202:203] op_sel:[0,1] op_sel_hi:[1,1]
    v_pk_fma_f32 v[58:59], v[78:79], v[202:203], v[170:171] op_sel:[0,1,0] op_sel_hi:[1,1,1] neg_lo:[1,0,0] neg_hi:[1,0,0]
    v_pk_fma_f32 v[78:79], v[78:79], v[202:203], v[172:173] op_sel:[0,0,0] op_sel_hi:[1,0,1]
    v_pk_mul_f32 v[166:167], v[20:21], v[204:205] op_sel:[0,0] op_sel_hi:[1,0]
    v_pk_mul_f32 v[168:169], v[20:21], v[204:205] op_sel:[0,1] op_sel_hi:[1,1]
    v_pk_fma_f32 v[20:21], v[40:41], v[204:205], v[166:167] op_sel:[0,1,0] op_sel_hi:[1,1,1] neg_lo:[1,0,0] neg_hi:[1,0,0]
    v_pk_fma_f32 v[40:41], v[40:41], v[204:205], v[168:169] op_sel:[0,0,0] op_sel_hi:[1,0,1]
    v_pk_mul_f32 v[170:171], v[22:23], v[204:205] op_sel:[0,0] op_sel_hi:[1,0]
    v_pk_mul_f32 v[172:173], v[22:23], v[204:205] op_sel:[0,1] op_sel_hi:[1,1]
    v_pk_fma_f32 v[22:23], v[42:43], v[204:205], v[170:171] op_sel:[0,1,0] op_sel_hi:[1,1,1] neg_lo:[1,0,0] neg_hi:[1,0,0]
    v_pk_fma_f32 v[42:43], v[42:43], v[204:205], v[172:173] op_sel:[0,0,0] op_sel_hi:[1,0,1]
    v_pk_mul_f32 v[166:167], v[60:61], v[204:205] op_sel:[0,0] op_sel_hi:[1,0]
    v_pk_mul_f32 v[168:169], v[60:61], v[204:205] op_sel:[0,1] op_sel_hi:[1,1]
    v_pk_fma_f32 v[60:61], v[80:81], v[204:205], v[166:167] op_sel:[0,1,0] op_sel_hi:[1,1,1] neg_lo:[1,0,0] neg_hi:[1,0,0]
    v_pk_fma_f32 v[80:81], v[80:81], v[204:205], v[168:169] op_sel:[0,0,0] op_sel_hi:[1,0,1]
    v_pk_mul_f32 v[170:171], v[62:63], v[204:205] op_sel:[0,0] op_sel_hi:[1,0]
    v_pk_mul_f32 v[172:173], v[62:63], v[204:205] op_sel:[0,1] op_sel_hi:[1,1]
    v_pk_fma_f32 v[62:63], v[82:83], v[204:205], v[170:171] op_sel:[0,1,0] op_sel_hi:[1,1,1] neg_lo:[1,0,0] neg_hi:[1,0,0]
    v_pk_fma_f32 v[82:83], v[82:83], v[204:205], v[172:173] op_sel:[0,0,0] op_sel_hi:[1,0,1]
    v_pk_mul_f32 v[166:167], v[24:25], v[206:207] op_sel:[0,0] op_sel_hi:[1,0]
    v_pk_mul_f32 v[168:169], v[24:25], v[206:207] op_sel:[0,1] op_sel_hi:[1,1]
    v_pk_fma_f32 v[24:25], v[44:45], v[206:207], v[166:167] op_sel:[0,1,0] op_sel_hi:[1,1,1] neg_lo:[1,0,0] neg_hi:[1,0,0]
    v_pk_fma_f32 v[44:45], v[44:45], v[206:207], v[168:169] op_sel:[0,0,0] op_sel_hi:[1,0,1]
    v_pk_mul_f32 v[170:171], v[26:27], v[206:207] op_sel:[0,0] op_sel_hi:[1,0]
    v_pk_mul_f32 v[172:173], v[26:27], v[206:207] op_sel:[0,1] op_sel_hi:[1,1]
    v_pk_fma_f32 v[26:27], v[46:47], v[206:207], v[170:171] op_sel:[0,1,0] op_sel_hi:[1,1,1] neg_lo:[1,0,0] neg_hi:[1,0,0]
    v_pk_fma_f32 v[46:47], v[46:47], v[206:207], v[172:173] op_sel:[0,0,0] op_sel_hi:[1,0,1]
    s_mov_b32 s20, s80
    s_and_b32 s21, s81, 0xffff
    s_mov_b32 s22, 1280
    s_mov_b32 s23, 0x20000
    s_mov_b32 s24, s90
    s_and_b32 s25, s91, 0xffff
    s_mov_b32 s26, 1280
    s_mov_b32 s27, 0x20000
    buffer_load_dwordx4 v[96:99], v6, s[12:15], s52 offen offset:0 sc1
    buffer_load_dwordx4 v[100:103], v6, s[12:15], s52 offen offset:1280 sc1
    buffer_load_dwordx4 v[104:107], v6, s[12:15], s52 offen offset:2560 sc1
    buffer_load_dwordx4 v[108:111], v6, s[12:15], s53 offen offset:0 sc1
    buffer_load_dwordx4 v[112:115], v6, s[12:15], s53 offen offset:1280 sc1
    v_pk_mul_f32 v[166:167], v[64:65], v[206:207] op_sel:[0,0] op_sel_hi:[1,0]
    v_pk_mul_f32 v[168:169], v[64:65], v[206:207] op_sel:[0,1] op_sel_hi:[1,1]
    v_pk_fma_f32 v[64:65], v[84:85], v[206:207], v[166:167] op_sel:[0,1,0] op_sel_hi:[1,1,1] neg_lo:[1,0,0] neg_hi:[1,0,0]
    v_pk_fma_f32 v[84:85], v[84:85], v[206:207], v[168:169] op_sel:[0,0,0] op_sel_hi:[1,0,1]
    v_pk_mul_f32 v[170:171], v[66:67], v[206:207] op_sel:[0,0] op_sel_hi:[1,0]
    v_accvgpr_read_b32 v1, a212
    s_add_u32 m0, s86, 0
    s_nop 0
    buffer_load_dwordx4 v1, s[4:7], s85 offen lds
    v_pk_mul_f32 v[172:173], v[66:67], v[206:207] op_sel:[0,1] op_sel_hi:[1,1]
    v_pk_fma_f32 v[66:67], v[86:87], v[206:207], v[170:171] op_sel:[0,1,0] op_sel_hi:[1,1,1] neg_lo:[1,0,0] neg_hi:[1,0,0]
    v_pk_fma_f32 v[86:87], v[86:87], v[206:207], v[172:173] op_sel:[0,0,0] op_sel_hi:[1,0,1]
    v_pk_mul_f32 v[166:167], v[28:29], v[208:209] op_sel:[0,0] op_sel_hi:[1,0]
    v_pk_mul_f32 v[168:169], v[28:29], v[208:209] op_sel:[0,1] op_sel_hi:[1,1]
    v_pk_fma_f32 v[28:29], v[48:49], v[208:209], v[166:167] op_sel:[0,1,0] op_sel_hi:[1,1,1] neg_lo:[1,0,0] neg_hi:[1,0,0]
    v_accvgpr_read_b32 v1, a213
    s_add_u32 m0, s86, 1024
    s_nop 0
    buffer_load_dwordx4 v1, s[4:7], s85 offen lds
    v_pk_fma_f32 v[48:49], v[48:49], v[208:209], v[168:169] op_sel:[0,0,0] op_sel_hi:[1,0,1]
    v_pk_mul_f32 v[170:171], v[30:31], v[208:209] op_sel:[0,0] op_sel_hi:[1,0]
    v_pk_mul_f32 v[172:173], v[30:31], v[208:209] op_sel:[0,1] op_sel_hi:[1,1]
    v_pk_fma_f32 v[30:31], v[50:51], v[208:209], v[170:171] op_sel:[0,1,0] op_sel_hi:[1,1,1] neg_lo:[1,0,0] neg_hi:[1,0,0]
    v_pk_fma_f32 v[50:51], v[50:51], v[208:209], v[172:173] op_sel:[0,0,0] op_sel_hi:[1,0,1]
    v_accvgpr_read_b32 v1, a214
    s_add_u32 m0, s86, 2048
    s_nop 0
    buffer_load_dwordx4 v1, s[4:7], s85 offen lds
    v_pk_mul_f32 v[166:167], v[68:69], v[208:209] op_sel:[0,0] op_sel_hi:[1,0]
    v_pk_mul_f32 v[168:169], v[68:69], v[208:209] op_sel:[0,1] op_sel_hi:[1,1]
    v_pk_fma_f32 v[68:69], v[88:89], v[208:209], v[166:167] op_sel:[0,1,0] op_sel_hi:[1,1,1] neg_lo:[1,0,0] neg_hi:[1,0,0]
    v_pk_fma_f32 v[88:89], v[88:89], v[208:209], v[168:169] op_sel:[0,0,0] op_sel_hi:[1,0,1]
    v_pk_mul_f32 v[170:171], v[70:71], v[208:209] op_sel:[0,0] op_sel_hi:[1,0]
    v_pk_mul_f32 v[172:173], v[70:71], v[208:209] op_sel:[0,1] op_sel_hi:[1,1]
    v_accvgpr_read_b32 v1, a215
    s_add_u32 m0, s86, 3072
    s_nop 0
    buffer_load_dwordx4 v1, s[4:7], s85 offen lds
    v_pk_fma_f32 v[70:71], v[90:91], v[208:209], v[170:171] op_sel:[0,1,0] op_sel_hi:[1,1,1] neg_lo:[1,0,0] neg_hi:[1,0,0]
    v_pk_fma_f32 v[90:91], v[90:91], v[208:209], v[172:173] op_sel:[0,0,0] op_sel_hi:[1,0,1]
    v_pk_mul_f32 v[166:167], v[32:33], v[210:211] op_sel:[0,0] op_sel_hi:[1,0]
    v_pk_mul_f32 v[168:169], v[32:33], v[210:211] op_sel:[0,1] op_sel_hi:[1,1]
    v_pk_fma_f32 v[32:33], v[52:53], v[210:211], v[166:167] op_sel:[0,1,0] op_sel_hi:[1,1,1] neg_lo:[1,0,0] neg_hi:[1,0,0]
    v_pk_fma_f32 v[52:53], v[52:53], v[210:211], v[168:169] op_sel:[0,0,0] op_sel_hi:[1,0,1]
    v_accvgpr_read_b32 v1, a216
    s_add_u32 m0, s86, 4096
    s_nop 0
    buffer_load_dwordx4 v1, s[4:7], s85 offen lds
    v_pk_mul_f32 v[170:171], v[34:35], v[210:211] op_sel:[0,0] op_sel_hi:[1,0]
    v_pk_mul_f32 v[172:173], v[34:35], v[210:211] op_sel:[0,1] op_sel_hi:[1,1]
    v_pk_fma_f32 v[34:35], v[54:55], v[210:211], v[170:171] op_sel:[0,1,0] op_sel_hi:[1,1,1] neg_lo:[1,0,0] neg_hi:[1,0,0]
    v_pk_fma_f32 v[54:55], v[54:55], v[210:211], v[172:173] op_sel:[0,0,0] op_sel_hi:[1,0,1]
    v_pk_mul_f32 v[166:167], v[72:73], v[210:211] op_sel:[0,0] op_sel_hi:[1,0]
    v_lshlrev_b32 v1, 2, v0
    s_add_u32 m0, s86, 20480
    s_nop 0
    buffer_load_dword v1, s[20:23], s87 offen lds
    s_add_u32 m0, s86, 20736
    s_nop 0
    buffer_load_dword v1, s[24:27], s87 offen lds
    v_pk_mul_f32 v[168:169], v[72:73], v[210:211] op_sel:[0,1] op_sel_hi:[1,1]
    v_pk_fma_f32 v[72:73], v[92:93], v[210:211], v[166:167] op_sel:[0,1,0] op_sel_hi:[1,1,1] neg_lo:[1,0,0] neg_hi:[1,0,0]
    v_pk_fma_f32 v[92:93], v[92:93], v[210:211], v[168:169] op_sel:[0,0,0] op_sel_hi:[1,0,1]
    v_pk_mul_f32 v[170:171], v[74:75], v[210:211] op_sel:[0,0] op_sel_hi:[1,0]
    v_pk_mul_f32 v[172:173], v[74:75], v[210:211] op_sel:[0,1] op_sel_hi:[1,1]
    v_pk_fma_f32 v[74:75], v[94:95], v[210:211], v[170:171] op_sel:[0,1,0] op_sel_hi:[1,1,1] neg_lo:[1,0,0] neg_hi:[1,0,0]
    s_add_u32 s94, s47, 44032
    buffer_load_dwordx4 a[64:67], v252, s[12:15], s94 offen sc1
    v_pk_fma_f32 v[94:95], v[94:95], v[210:211], v[172:173] op_sel:[0,0,0] op_sel_hi:[1,0,1]
    s_waitcnt lgkmcnt(0)
    s_cmp_eq_u32 s3, 0
    s_cselect_b64 exec, 0xffff, 0
    v_mov_b32 v136, 0
    v_mov_b32 v137, 0
    v_mov_b32 v138, 0
    v_mov_b32 v139, 0
    v_mov_b32 v140, 0
    v_mov_b32 v141, 0
    v_mov_b32 v142, 0
    v_mov_b32 v143, 0
    v_mov_b32 v144, 0
    v_mov_b32 v145, 0
    s_mov_b64 exec, -1
    s_add_u32 s94, s47, 84992
    buffer_load_dwordx4 a[68:71], v252, s[12:15], s94 offen sc1
    s_add_u32 s94, s47, 125952
    buffer_load_dwordx4 a[72:75], v252, s[12:15], s94 offen sc1
    v_mul_f32 v156, v202, v136
    v_mul_f32 v161, v202, v137
    v_mul_f32 v157, v204, v138
    s_add_u32 s94, s47, 166912
    buffer_load_dwordx4 a[76:79], v252, s[12:15], s94 offen sc1
    v_mul_f32 v162, v204, v139
    v_mul_f32 v158, v206, v140
    v_mul_f32 v163, v206, v141
    v_mul_f32 v159, v208, v142
    v_mul_f32 v164, v208, v143
    s_add_u32 s94, s47, 8192
    buffer_load_dwordx4 a[160:163], v252, s[12:15], s94 offen sc1
    v_mul_f32 v160, v210, v144
    v_mul_f32 v165, v210, v145
    v_fma_f32 v156, -v203, v137, v156
    v_fma_f32 v161, v203, v136, v161
    v_fma_f32 v157, -v205, v139, v157
    v_fma_f32 v162, v205, v138, v162
    s_add_u32 s94, s47, 49152
    buffer_load_dwordx4 a[164:167], v252, s[12:15], s94 offen sc1
    v_fma_f32 v158, -v207, v141, v158
    v_fma_f32 v163, v207, v140, v163
    v_fma_f32 v159, -v209, v143, v159
    v_fma_f32 v164, v209, v142, v164
    v_fma_f32 v160, -v211, v145, v160
    s_add_u32 s94, s47, 90112
    buffer_load_dwordx4 a[168:171], v252, s[12:15], s94 offen sc1
    v_fma_f32 v165, v211, v144, v165
    v_accvgpr_read_b32 v5, a207
    v_accvgpr_read_b32 v12, a208
    v_accvgpr_read_b32 v13, a209
    v_accvgpr_read_b32 v4, a210
    v_accvgpr_read_b32 v3, a211
    s_add_u32 s94, s47, 131072
    buffer_load_dwordx4 a[172:175], v252, s[12:15], s94 offen sc1
    v_mov_b32 v116, 0
    v_mov_b32 v117, 0
    s_mov_b32 s56, s84
    s_add_u32 s57, s84, 4096
    s_add_u32 s58, s84, 40960
    s_add_u32 s59, s84, 45056
    s_waitcnt vmcnt(15)
    v_xor_b32 v10, s28, v97
    v_bitop3_b32 v10, s29, v99, v10 bitop3:0xbe
    v_cmp_ne_u32 s[50:51], 0, v10
    s_nop 0
    s_and_b64 vcc, s[50:51], s[68:69]
    v_xor_b32 v10, s28, v101
    v_bitop3_b32 v10, s29, v103, v10 bitop3:0xbe
    v_cmp_ne_u32 s[50:51], 0, v10
    s_nop 0
    s_and_b64 s[50:51], s[50:51], s[70:71]
    s_or_b64 vcc, vcc, s[50:51]
    v_xor_b32 v10, s28, v105
    v_bitop3_b32 v10, s29, v107, v10 bitop3:0xbe
    v_cmp_ne_u32 s[50:51], 0, v10
    s_nop 0
    s_and_b64 s[50:51], s[50:51], s[72:73]
    s_or_b64 vcc, vcc, s[50:51]
    v_xor_b32 v10, s28, v109
    v_bitop3_b32 v10, s29, v111, v10 bitop3:0xbe
    v_cmp_ne_u32 s[50:51], 0, v10
    s_nop 0
    s_and_b64 s[50:51], s[50:51], s[74:75]
    s_or_b64 vcc, vcc, s[50:51]
    v_xor_b32 v10, s28, v113
    v_bitop3_b32 v10, s29, v115, v10 bitop3:0xbe
    v_cmp_ne_u32 s[50:51], 0, v10
    s_nop 0
    s_and_b64 s[50:51], s[50:51], s[76:77]
    s_or_b64 vcc, vcc, s[50:51]
    s_cbranch_vccnz pc5
pcd6:
    s_mov_b64 exec, s[68:69]
    v_fmac_f32 v96, v118, v116
    v_fmac_f32 v98, v118, v117
    v_fmac_f32 v98, v119, v116
    v_fma_f32 v116, -v119, v117, v96
    v_mov_b32 v117, v98
    s_mov_b64 exec, s[70:71]
    v_fmac_f32 v100, v118, v116
    v_fmac_f32 v102, v118, v117
    v_fmac_f32 v102, v119, v116
    v_fma_f32 v116, -v119, v117, v100
    v_mov_b32 v117, v102
    s_mov_b64 exec, s[72:73]
    v_fmac_f32 v104, v118, v116
    v_fmac_f32 v106, v118, v117
    v_fmac_f32 v106, v119, v116
    v_fma_f32 v116, -v119, v117, v104
    v_mov_b32 v117, v106
    s_mov_b64 exec, s[74:75]
    v_fmac_f32 v108, v118, v116
    v_fmac_f32 v110, v118, v117
    v_fmac_f32 v110, v119, v116
    v_fma_f32 v116, -v119, v117, v108
    v_mov_b32 v117, v110
    s_mov_b64 exec, s[76:77]
    v_fmac_f32 v112, v118, v116
    v_fmac_f32 v114, v118, v117
    v_fmac_f32 v114, v119, v116
    v_fma_f32 v116, -v119, v117, v112
    v_mov_b32 v117, v114
    s_mov_b64 exec, -1
    v_mul_f32 v126, v120, v116
    v_mul_f32 v127, v120, v117
    v_fma_f32 v126, -v121, v117, v126
    v_fmac_f32 v127, v121, v116
    ds_write_b64 v5, v[126:127]
    s_waitcnt lgkmcnt(0)
    s_barrier
    ds_read_b128 v[96:99], v12 offset:0
    ds_read_b64 v[100:101], v12 offset:16
    ds_read_b128 v[102:105], v12 offset:32
    ds_read_b64 v[106:107], v12 offset:48
    ds_read_b128 v[108:111], v12 offset:64
    ds_read_b64 v[112:113], v12 offset:80
    ds_read_b128 v[114:117], v12 offset:96
    ds_read_b64 v[118:119], v12 offset:112
    ds_read_b128 v[120:123], v12 offset:128
    ds_read_b64 v[124:125], v12 offset:144
    s_waitcnt lgkmcnt(8)
    v_pk_add_f32 v[96:97], v[96:97], v[98:99]
    s_waitcnt lgkmcnt(6)
    v_pk_add_f32 v[102:103], v[102:103], v[104:105]
    s_waitcnt lgkmcnt(4)
    v_pk_add_f32 v[108:109], v[108:109], v[110:111]
    s_waitcnt lgkmcnt(2)
    v_pk_add_f32 v[114:115], v[114:115], v[116:117]
    s_waitcnt lgkmcnt(0)
    v_pk_add_f32 v[120:121], v[120:121], v[122:123]
    v_pk_add_f32 v[96:97], v[96:97], v[100:101]
    v_pk_add_f32 v[102:103], v[102:103], v[106:107]
    v_pk_add_f32 v[108:109], v[108:109], v[112:113]
    v_pk_add_f32 v[114:115], v[114:115], v[118:119]
    v_pk_add_f32 v[120:121], v[120:121], v[124:125]
    v_fma_f32 v156, v146, v96, v156
    v_fma_f32 v161, v146, v97, v161
    v_fma_f32 v157, v148, v102, v157
    v_fma_f32 v162, v148, v103, v162
    v_fma_f32 v158, v150, v108, v158
    v_fma_f32 v163, v150, v109, v163
    s_add_u32 s94, s47, 172032
    buffer_load_dwordx4 a[176:179], v252, s[12:15], s94 offen sc1
    v_fma_f32 v159, v152, v114, v159
    v_fma_f32 v164, v152, v115, v164
    v_fma_f32 v160, v154, v120, v160
    v_fma_f32 v165, v154, v121, v165
    v_fma_f32 v156, -v147, v97, v156
    v_fma_f32 v161, v147, v96, v161
    v_fma_f32 v157, -v149, v103, v157
    s_add_u32 s94, s47, 4096
    buffer_load_dwordx4 a[80:83], v252, s[12:15], s94 offen sc1
    v_fma_f32 v162, v149, v102, v162
    v_fma_f32 v158, -v151, v109, v158
    v_fma_f32 v163, v151, v108, v163
    v_fma_f32 v159, -v153, v115, v159
    v_fma_f32 v164, v153, v114, v164
    v_fma_f32 v160, -v155, v121, v160
    v_fma_f32 v165, v155, v120, v165
    v_fmac_f32 v16, v192, v156
    v_fmac_f32 v36, v192, v161
    v_fmac_f32 v20, v194, v157
    v_fmac_f32 v40, v194, v162
    v_fma_f32 v16, -v193, v161, v16
    v_fmac_f32 v36, v193, v156
    v_fma_f32 v20, -v195, v162, v20
    v_fmac_f32 v40, v195, v157
    v_fmac_f32 v17, v192, v16
    v_fmac_f32 v37, v192, v36
    v_fmac_f32 v21, v194, v20
    v_fmac_f32 v41, v194, v40
    v_fma_f32 v17, -v193, v36, v17
    v_fmac_f32 v37, v193, v16
    v_fma_f32 v21, -v195, v40, v21
    v_fmac_f32 v41, v195, v20
    v_fmac_f32 v18, v192, v17
    v_fmac_f32 v38, v192, v37
    v_fmac_f32 v22, v194, v21
    v_fmac_f32 v42, v194, v41
    s_add_u32 s94, s47, 45056
    buffer_load_dwordx4 a[84:87], v252, s[12:15], s94 offen sc1
    v_fma_f32 v18, -v193, v37, v18
    v_fmac_f32 v38, v193, v17
    v_fma_f32 v22, -v195, v41, v22
    v_fmac_f32 v42, v195, v21
    v_fmac_f32 v19, v192, v18
    v_fmac_f32 v39, v192, v38
    v_fmac_f32 v23, v194, v22
    v_fmac_f32 v43, v194, v42
    v_fma_f32 v19, -v193, v38, v19
    v_fmac_f32 v39, v193, v18
    v_fma_f32 v23, -v195, v42, v23
    v_fmac_f32 v43, v195, v22
    v_fmac_f32 v56, v192, v19
    v_fmac_f32 v76, v192, v39
    v_fmac_f32 v60, v194, v23
    v_fmac_f32 v80, v194, v43
    v_fma_f32 v56, -v193, v39, v56
    v_fmac_f32 v76, v193, v19
    v_fma_f32 v60, -v195, v43, v60
    v_fmac_f32 v80, v195, v23
    s_add_u32 s94, s47, 86016
    buffer_load_dwordx4 a[88:91], v252, s[12:15], s94 offen sc1
    v_fmac_f32 v57, v192, v56
    v_fmac_f32 v77, v192, v76
    v_fmac_f32 v61, v194, v60
    v_fmac_f32 v81, v194, v80
    v_fma_f32 v57, -v193, v76, v57
    v_fmac_f32 v77, v193, v56
    v_fma_f32 v61, -v195, v80, v61
    v_fmac_f32 v81, v195, v60
    v_fmac_f32 v58, v192, v57
    v_fmac_f32 v78, v192, v77
    v_fmac_f32 v62, v194, v61
    v_fmac_f32 v82, v194, v81
    v_fma_f32 v58, -v193, v77, v58
    v_fmac_f32 v78, v193, v57
    v_fma_f32 v62, -v195, v81, v62
    v_fmac_f32 v82, v195, v61
    v_fmac_f32 v59, v192, v58
    v_fmac_f32 v79, v192, v78
    v_fmac_f32 v63, v194, v62
    v_fmac_f32 v83, v194, v82
    s_add_u32 s94, s47, 126976
    buffer_load_dwordx4 a[92:95], v252, s[12:15], s94 offen sc1
    v_fma_f32 v59, -v193, v78, v59
    v_fmac_f32 v79, v193, v58
    v_fma_f32 v63, -v195, v82, v63
    v_fmac_f32 v83, v195, v62
    v_cvt_pk_bf16_f32 v96, v16, v17
    v_cvt_pk_bf16_f32 v97, v18, v19
    v_cvt_pk_bf16_f32 v98, v56, v57
    v_cvt_pk_bf16_f32 v99, v58, v59
    v_and_or_b32 v96, v96, s83, v3
    v_and_or_b32 v97, v97, s83, v3
    v_and_or_b32 v98, v98, s83, v3
    v_and_or_b32 v99, v99, s83, v3
    ds_write_b128 v13, v[96:99] offset:0
    v_cvt_pk_bf16_f32 v100, -v36, -v37
    v_cvt_pk_bf16_f32 v101, -v38, -v39
    v_cvt_pk_bf16_f32 v102, -v76, -v77
    v_cvt_pk_bf16_f32 v103, -v78, -v79
    v_and_or_b32 v100, v100, s83, v3
    v_and_or_b32 v101, v101, s83, v3
    v_and_or_b32 v102, v102, s83, v3
    s_add_u32 s94, s47, 167936
    buffer_load_dwordx4 a[96:99], v252, s[12:15], s94 offen sc1
    v_and_or_b32 v103, v103, s83, v3
    ds_write_b128 v13, v[100:103] offset:1280
    v_cvt_pk_bf16_f32 v104, v20, v21
    v_cvt_pk_bf16_f32 v105, v22, v23
    v_cvt_pk_bf16_f32 v106, v60, v61
    v_cvt_pk_bf16_f32 v107, v62, v63
    v_and_or_b32 v104, v104, s83, v3
    v_and_or_b32 v105, v105, s83, v3
    v_and_or_b32 v106, v106, s83, v3
    v_and_or_b32 v107, v107, s83, v3
    ds_write_b128 v13, v[104:107] offset:2560
    v_cvt_pk_bf16_f32 v108, -v40, -v41
    v_cvt_pk_bf16_f32 v109, -v42, -v43
    v_cvt_pk_bf16_f32 v110, -v80, -v81
    v_cvt_pk_bf16_f32 v111, -v82, -v83
    v_and_or_b32 v108, v108, s83, v3
    v_and_or_b32 v109, v109, s83, v3
    v_and_or_b32 v110, v110, s83, v3
    v_and_or_b32 v111, v111, s83, v3
    ds_write_b128 v13, v[108:111] offset:3840
    v_fmac_f32 v24, v196, v158
    v_fmac_f32 v44, v196, v163
    v_fmac_f32 v28, v198, v159
    v_fmac_f32 v48, v198, v164
    v_fma_f32 v24, -v197, v163, v24
    v_fmac_f32 v44, v197, v158
    v_fma_f32 v28, -v199, v164, v28
    v_fmac_f32 v48, v199, v159
    v_fmac_f32 v25, v196, v24
    v_fmac_f32 v45, v196, v44
    v_fmac_f32 v29, v198, v28
    v_fmac_f32 v49, v198, v48
    v_fma_f32 v25, -v197, v44, v25
    v_fmac_f32 v45, v197, v24
    v_fma_f32 v29, -v199, v48, v29
    v_fmac_f32 v49, v199, v28
    v_fmac_f32 v26, v196, v25
    s_waitcnt lgkmcnt(2)
    ds_read_b64_tr_b16 v[136:137], v4 offset:0
    ds_read_b64_tr_b16 v[138:139], v4 offset:320
    ds_read_b64_tr_b16 v[140:141], v4 offset:32
    ds_read_b64_tr_b16 v[142:143], v4 offset:352
    v_fmac_f32 v46, v196, v45
    v_fmac_f32 v30, v198, v29
    v_fmac_f32 v50, v198, v49
    v_fma_f32 v26, -v197, v45, v26
    v_fmac_f32 v46, v197, v25
    v_fma_f32 v30, -v199, v49, v30
    v_fmac_f32 v50, v199, v29
    v_fmac_f32 v27, v196, v26
    v_fmac_f32 v47, v196, v46
    v_fmac_f32 v31, v198, v30
    v_fmac_f32 v51, v198, v50
    v_fma_f32 v27, -v197, v46, v27
    v_fmac_f32 v47, v197, v26
    v_fma_f32 v31, -v199, v50, v31
    s_waitcnt lgkmcnt(4)
    ds_read_b64_tr_b16 v[144:145], v4 offset:2560
    ds_read_b64_tr_b16 v[146:147], v4 offset:2880
    ds_read_b64_tr_b16 v[148:149], v4 offset:2592
    ds_read_b64_tr_b16 v[150:151], v4 offset:2912
    v_fmac_f32 v51, v199, v30
    v_fmac_f32 v64, v196, v27
    v_fmac_f32 v84, v196, v47
    v_fmac_f32 v68, v198, v31
    v_fmac_f32 v88, v198, v51
    v_fma_f32 v64, -v197, v47, v64
    v_fmac_f32 v84, v197, v27
    v_fma_f32 v68, -v199, v51, v68
    v_fmac_f32 v88, v199, v31
    v_fmac_f32 v65, v196, v64
    v_fmac_f32 v85, v196, v84
    v_fmac_f32 v69, v198, v68
    v_fmac_f32 v89, v198, v88
    v_fma_f32 v65, -v197, v84, v65
    s_waitcnt lgkmcnt(6)
    buffer_store_dwordx4 v[136:139], v252, s[12:15], s56 offen offset:0 sc1
    v_fmac_f32 v85, v197, v64
    v_fma_f32 v69, -v199, v88, v69
    v_fmac_f32 v89, v199, v68
    v_fmac_f32 v66, v196, v65
    v_fmac_f32 v86, v196, v85
    v_fmac_f32 v70, v198, v69
    v_fmac_f32 v90, v198, v89
    v_fma_f32 v66, -v197, v85, v66
    v_fmac_f32 v86, v197, v65
    v_fma_f32 v70, -v199, v89, v70
    v_fmac_f32 v90, v199, v69
    v_fmac_f32 v67, v196, v66
    v_fmac_f32 v87, v196, v86
    s_waitcnt lgkmcnt(4)
    buffer_store_dwordx4 v[140:143], v252, s[12:15], s58 offen offset:0 sc1
    v_fmac_f32 v71, v198, v70
    v_fmac_f32 v91, v198, v90
    v_fma_f32 v67, -v197, v86, v67
    v_fmac_f32 v87, v197, v66
    v_fma_f32 v71, -v199, v90, v71
    v_fmac_f32 v91, v199, v70
    v_cvt_pk_bf16_f32 v112, v24, v25
    v_cvt_pk_bf16_f32 v113, v26, v27
    v_cvt_pk_bf16_f32 v114, v64, v65
    v_cvt_pk_bf16_f32 v115, v66, v67
    v_and_or_b32 v112, v112, s83, v3
    v_and_or_b32 v113, v113, s83, v3
    v_and_or_b32 v114, v114, s83, v3
    v_and_or_b32 v115, v115, s83, v3
    s_waitcnt lgkmcnt(2)
    buffer_store_dwordx4 v[144:147], v252, s[12:15], s56 offen offset:1024 sc1
    ds_write_b128 v13, v[112:115] offset:5120
    v_cvt_pk_bf16_f32 v116, -v44, -v45
    v_cvt_pk_bf16_f32 v117, -v46, -v47
    v_cvt_pk_bf16_f32 v118, -v84, -v85
    v_cvt_pk_bf16_f32 v119, -v86, -v87
    v_and_or_b32 v116, v116, s83, v3
    v_and_or_b32 v117, v117, s83, v3
    v_and_or_b32 v118, v118, s83, v3
    v_and_or_b32 v119, v119, s83, v3
    ds_write_b128 v13, v[116:119] offset:6400
    v_cvt_pk_bf16_f32 v120, v28, v29
    v_cvt_pk_bf16_f32 v121, v30, v31
    v_cvt_pk_bf16_f32 v122, v68, v69
    v_cvt_pk_bf16_f32 v123, v70, v71
    s_waitcnt lgkmcnt(2)
    buffer_store_dwordx4 v[148:151], v252, s[12:15], s58 offen offset:1024 sc1
    v_and_or_b32 v120, v120, s83, v3
    v_and_or_b32 v121, v121, s83, v3
    v_and_or_b32 v122, v122, s83, v3
    v_and_or_b32 v123, v123, s83, v3
    ds_write_b128 v13, v[120:123] offset:7680
    v_cvt_pk_bf16_f32 v124, -v48, -v49
    v_cvt_pk_bf16_f32 v125, -v50, -v51
    v_cvt_pk_bf16_f32 v126, -v88, -v89
    v_cvt_pk_bf16_f32 v127, -v90, -v91
    v_and_or_b32 v124, v124, s83, v3
    v_and_or_b32 v125, v125, s83, v3
    v_and_or_b32 v126, v126, s83, v3
    v_and_or_b32 v127, v127, s83, v3
    ds_write_b128 v13, v[124:127] offset:8960
    v_fmac_f32 v32, v200, v160
    v_fmac_f32 v52, v200, v165
    v_fma_f32 v32, -v201, v165, v32
    v_fmac_f32 v52, v201, v160
    v_fmac_f32 v33, v200, v32
    v_fmac_f32 v53, v200, v52
    v_fma_f32 v33, -v201, v52, v33
    v_fmac_f32 v53, v201, v32
    v_fmac_f32 v34, v200, v33
    v_fmac_f32 v54, v200, v53
    s_waitcnt lgkmcnt(2)
    ds_read_b64_tr_b16 v[152:153], v4 offset:5120
    ds_read_b64_tr_b16 v[154:155], v4 offset:5440
    ds_read_b64_tr_b16 v[202:203], v4 offset:5152
    ds_read_b64_tr_b16 v[204:205], v4 offset:5472
    v_fma_f32 v34, -v201, v53, v34
    v_fmac_f32 v54, v201, v33
    v_fmac_f32 v35, v200, v34
    v_fmac_f32 v55, v200, v54
    v_fma_f32 v35, -v201, v54, v35
    v_fmac_f32 v55, v201, v34
    v_fmac_f32 v72, v200, v35
    s_waitcnt lgkmcnt(4)
    ds_read_b64_tr_b16 v[206:207], v4 offset:7680
    ds_read_b64_tr_b16 v[208:209], v4 offset:8000
    ds_read_b64_tr_b16 v[210:211], v4 offset:7712
    ds_read_b64_tr_b16 v[212:213], v4 offset:8032
    v_fmac_f32 v92, v200, v55
    v_fma_f32 v72, -v201, v55, v72
    v_fmac_f32 v92, v201, v35
    v_fmac_f32 v73, v200, v72
    v_fmac_f32 v93, v200, v92
    v_fma_f32 v73, -v201, v92, v73
    s_waitcnt lgkmcnt(6)
    buffer_store_dwordx4 v[152:155], v252, s[12:15], s56 offen offset:2048 sc1
    v_fmac_f32 v93, v201, v72
    v_fmac_f32 v74, v200, v73
    v_fmac_f32 v94, v200, v93
    v_fma_f32 v74, -v201, v93, v74
    v_fmac_f32 v94, v201, v73
    v_fmac_f32 v75, v200, v74
    v_fmac_f32 v95, v200, v94
    s_waitcnt lgkmcnt(4)
    buffer_store_dwordx4 v[202:205], v252, s[12:15], s58 offen offset:2048 sc1
    v_fma_f32 v75, -v201, v94, v75
    v_fmac_f32 v95, v201, v74
    v_cvt_pk_bf16_f32 v128, v32, v33
    v_cvt_pk_bf16_f32 v129, v34, v35
    v_cvt_pk_bf16_f32 v130, v72, v73
    v_cvt_pk_bf16_f32 v131, v74, v75
    s_waitcnt lgkmcnt(2)
    buffer_store_dwordx4 v[206:209], v252, s[12:15], s56 offen offset:3072 sc1
    v_and_or_b32 v128, v128, s83, v3
    v_and_or_b32 v129, v129, s83, v3
    v_and_or_b32 v130, v130, s83, v3
    v_and_or_b32 v131, v131, s83, v3
    ds_write_b128 v13, v[128:131] offset:10240
    v_cvt_pk_bf16_f32 v132, -v52, -v53
    v_cvt_pk_bf16_f32 v133, -v54, -v55
    s_waitcnt lgkmcnt(1)
    buffer_store_dwordx4 v[210:213], v252, s[12:15], s58 offen offset:3072 sc1
    v_cvt_pk_bf16_f32 v134, -v92, -v93
    v_cvt_pk_bf16_f32 v135, -v94, -v95
    v_and_or_b32 v132, v132, s83, v3
    v_and_or_b32 v133, v133, s83, v3
    v_and_or_b32 v134, v134, s83, v3
    v_and_or_b32 v135, v135, s83, v3
    ds_write_b128 v13, v[132:135] offset:11520
    s_waitcnt lgkmcnt(0)
    ds_read_b64_tr_b16 v[214:215], v4 offset:10240
    ds_read_b64_tr_b16 v[216:217], v4 offset:10560
    ds_read_b64_tr_b16 v[218:219], v4 offset:10272
    ds_read_b64_tr_b16 v[220:221], v4 offset:10592
    s_waitcnt lgkmcnt(2)
    buffer_store_dwordx4 v[214:217], v252, s[12:15], s57 offen offset:0 sc1
    s_waitcnt lgkmcnt(0)
    buffer_store_dwordx4 v[218:221], v252, s[12:15], s59 offen offset:0 sc1
    s_mul_i32 s45, s30, 320
    s_mul_i32 s46, s3, 10
    s_add_u32 s45, s45, s46
    s_lshl_b32 s45, s45, 10
    s_add_u32 s45, s45, 4194304
    s_add_u32 s36, s45, 0
    s_add_u32 s40, s45, 163840
    s_add_u32 s37, s45, 40960
    s_add_u32 s41, s45, 204800
    s_add_u32 s38, s45, 81920
    s_add_u32 s42, s45, 245760
    s_add_u32 s39, s45, 122880
    s_add_u32 s43, s45, 286720
    s_waitcnt vmcnt(24)
    s_lshl_b32 s52, s3, 6
    s_add_u32 s52, s52, 14720
    s_movk_i32 s53, 160
    v_accvgpr_read_b32 v11, a236
    v_accvgpr_read_b32 v6, a241
    v_lshl_add_u32 v1, v11, 2, s52
    v_lshl_add_u32 v3, v6, 3, s86
    v_mad_u32_u24 v2, v11, s53, v3
    ds_read2st64_b32 v[16:17], v1 offset0:0 offset1:2
    ds_read2st64_b32 v[26:27], v1 offset0:1 offset1:3
    ds_read_b64 v[36:37], v2
    ds_read_b64 v[46:47], v2 offset:2560
    ds_read_b64 v[56:57], v3 offset:20480
    ds_read_b64 v[66:67], v3 offset:20736
    v_accvgpr_read_b32 v12, a237
    v_accvgpr_read_b32 v7, a242
    buffer_load_dwordx4 v[172:175], v252, s[12:15], s36 offen offset:0 sc1
    v_lshl_add_u32 v1, v12, 2, s52
    v_lshl_add_u32 v3, v7, 3, s86
    v_mad_u32_u24 v2, v12, s53, v3
    ds_read2st64_b32 v[18:19], v1 offset0:0 offset1:2
    ds_read2st64_b32 v[28:29], v1 offset0:1 offset1:3
    ds_read_b64 v[38:39], v2
    ds_read_b64 v[48:49], v2 offset:2560
    ds_read_b64 v[58:59], v3 offset:20480
    ds_read_b64 v[68:69], v3 offset:20736
    v_accvgpr_read_b32 v13, a238
    v_accvgpr_read_b32 v8, a243
    v_lshl_add_u32 v1, v13, 2, s52
    v_lshl_add_u32 v3, v8, 3, s86
    v_mad_u32_u24 v2, v13, s53, v3
    ds_read2st64_b32 v[20:21], v1 offset0:0 offset1:2
    ds_read2st64_b32 v[30:31], v1 offset0:1 offset1:3
    buffer_load_dwordx4 v[176:179], v252, s[12:15], s37 offen offset:0 sc1
    s_waitcnt lgkmcnt(9)
    ds_read_b64 v[40:41], v2
    ds_read_b64 v[50:51], v2 offset:2560
    ds_read_b64 v[60:61], v3 offset:20480
    ds_read_b64 v[70:71], v3 offset:20736
    v_accvgpr_read_b32 v14, a239
    v_accvgpr_read_b32 v9, a244
    v_lshl_add_u32 v1, v14, 2, s52
    v_lshl_add_u32 v3, v9, 3, s86
    v_mad_u32_u24 v2, v14, s53, v3
    ds_read2st64_b32 v[22:23], v1 offset0:0 offset1:2
    s_waitcnt lgkmcnt(9)
    ds_read2st64_b32 v[32:33], v1 offset0:1 offset1:3
    ds_read_b64 v[42:43], v2
    ds_read_b64 v[52:53], v2 offset:2560
    ds_read_b64 v[62:63], v3 offset:20480
    ds_read_b64 v[72:73], v3 offset:20736
    v_accvgpr_read_b32 v15, a240
    buffer_load_dwordx4 v[180:183], v252, s[12:15], s38 offen offset:0 sc1
    v_accvgpr_read_b32 v10, a245
    v_lshl_add_u32 v1, v15, 2, s52
    v_lshl_add_u32 v3, v10, 3, s86
    v_mad_u32_u24 v2, v15, s53, v3
    s_waitcnt lgkmcnt(9)
    ds_read2st64_b32 v[24:25], v1 offset0:0 offset1:2
    ds_read2st64_b32 v[34:35], v1 offset0:1 offset1:3
    ds_read_b64 v[44:45], v2
    ds_read_b64 v[54:55], v2 offset:2560
    ds_read_b64 v[64:65], v3 offset:20480
    s_waitcnt lgkmcnt(9)
    ds_read_b64 v[74:75], v3 offset:20736
    v_add_u32 v4, s86, v252
    s_waitcnt lgkmcnt(0)
    v_lshlrev_b32 v76, 16, v56
    v_and_b32 v77, 0xffff0000, v56
    v_lshlrev_b32 v78, 16, v57
    v_and_b32 v79, 0xffff0000, v57
    buffer_load_dwordx4 v[184:187], v252, s[12:15], s39 offen offset:0 sc1
    v_lshlrev_b32 v80, 16, v66
    v_and_b32 v81, 0xffff0000, v66
    v_lshlrev_b32 v82, 16, v67
    v_and_b32 v83, 0xffff0000, v67
    v_lshlrev_b32 v84, 16, v36
    v_and_b32 v85, 0xffff0000, v36
    v_lshlrev_b32 v86, 16, v37
    v_and_b32 v87, 0xffff0000, v37
    v_lshlrev_b32 v92, 16, v46
    v_and_b32 v93, 0xffff0000, v46
    v_lshlrev_b32 v94, 16, v47
    v_and_b32 v95, 0xffff0000, v47
    v_pk_add_f32 v[88:89], v[80:81], v[84:85]
    v_pk_fma_f32 v[84:85], v[84:85], v[16:17], v[16:17] op_sel:[0,0,1] op_sel_hi:[1,0,1]
    v_pk_add_f32 v[90:91], v[82:83], v[86:87]
    v_pk_fma_f32 v[86:87], v[86:87], v[16:17], v[16:17] op_sel:[0,0,1] op_sel_hi:[1,0,1]
    s_add_u32 s45, s36, 4096
    buffer_load_dwordx4 v[188:191], v252, s[12:15], s45 offen offset:1024 sc1
    v_pk_add_f32 v[96:97], v[80:81], v[92:93]
    v_pk_fma_f32 v[92:93], v[92:93], v[26:27], v[26:27] op_sel:[0,0,1] op_sel_hi:[1,0,1]
    v_pk_add_f32 v[98:99], v[82:83], v[94:95]
    v_pk_fma_f32 v[94:95], v[94:95], v[26:27], v[26:27] op_sel:[0,0,1] op_sel_hi:[1,0,1]
    v_pk_fma_f32 v[88:89], v[84:85], v[76:77], v[88:89]
    v_pk_fma_f32 v[90:91], v[86:87], v[78:79], v[90:91]
    ds_write_b128 v4, v[88:91] offset:0
    v_pk_fma_f32 v[96:97], v[92:93], v[76:77], v[96:97]
    v_pk_fma_f32 v[98:99], v[94:95], v[78:79], v[98:99]
    ds_write_b128 v4, v[96:99] offset:20480
    v_lshlrev_b32 v100, 16, v58
    v_and_b32 v101, 0xffff0000, v58
    v_lshlrev_b32 v102, 16, v59
    v_and_b32 v103, 0xffff0000, v59
    v_lshlrev_b32 v104, 16, v68
    v_and_b32 v105, 0xffff0000, v68
    s_add_u32 s45, s37, 4096
    buffer_load_dwordx4 v[192:195], v252, s[12:15], s45 offen offset:1024 sc1
    v_lshlrev_b32 v106, 16, v69
    v_and_b32 v107, 0xffff0000, v69
    v_lshlrev_b32 v108, 16, v38
    v_and_b32 v109, 0xffff0000, v38
    v_lshlrev_b32 v110, 16, v39
    v_and_b32 v111, 0xffff0000, v39
    v_lshlrev_b32 v116, 16, v48
    v_and_b32 v117, 0xffff0000, v48
    v_lshlrev_b32 v118, 16, v49
    v_and_b32 v119, 0xffff0000, v49
    v_pk_add_f32 v[112:113], v[104:105], v[108:109]
    v_pk_fma_f32 v[108:109], v[108:109], v[18:19], v[18:19] op_sel:[0,0,1] op_sel_hi:[1,0,1]
    v_pk_add_f32 v[114:115], v[106:107], v[110:111]
    v_pk_fma_f32 v[110:111], v[110:111], v[18:19], v[18:19] op_sel:[0,0,1] op_sel_hi:[1,0,1]
    v_pk_add_f32 v[120:121], v[104:105], v[116:117]
    v_pk_fma_f32 v[116:117], v[116:117], v[28:29], v[28:29] op_sel:[0,0,1] op_sel_hi:[1,0,1]
    v_pk_add_f32 v[122:123], v[106:107], v[118:119]
    s_add_u32 s45, s38, 4096
    buffer_load_dwordx4 v[196:199], v252, s[12:15], s45 offen offset:1024 sc1
    v_pk_fma_f32 v[118:119], v[118:119], v[28:29], v[28:29] op_sel:[0,0,1] op_sel_hi:[1,0,1]
    v_pk_fma_f32 v[112:113], v[108:109], v[100:101], v[112:113]
    v_pk_fma_f32 v[114:115], v[110:111], v[102:103], v[114:115]
    ds_write_b128 v4, v[112:115] offset:1024
    v_pk_fma_f32 v[120:121], v[116:117], v[100:101], v[120:121]
    v_pk_fma_f32 v[122:123], v[118:119], v[102:103], v[122:123]
    ds_write_b128 v4, v[120:123] offset:21504
    v_lshlrev_b32 v76, 16, v60
    v_and_b32 v77, 0xffff0000, v60
    v_lshlrev_b32 v78, 16, v61
    v_and_b32 v79, 0xffff0000, v61
    v_lshlrev_b32 v80, 16, v70
    v_and_b32 v81, 0xffff0000, v70
    v_lshlrev_b32 v82, 16, v71
    v_and_b32 v83, 0xffff0000, v71
    v_lshlrev_b32 v84, 16, v40
    s_add_u32 s45, s39, 4096
    buffer_load_dwordx4 v[200:203], v252, s[12:15], s45 offen offset:1024 sc1
    v_and_b32 v85, 0xffff0000, v40
    v_lshlrev_b32 v86, 16, v41
    v_and_b32 v87, 0xffff0000, v41
    v_lshlrev_b32 v92, 16, v50
    v_and_b32 v93, 0xffff0000, v50
    v_lshlrev_b32 v94, 16, v51
    v_and_b32 v95, 0xffff0000, v51
    v_pk_add_f32 v[88:89], v[80:81], v[84:85]
    v_pk_fma_f32 v[84:85], v[84:85], v[20:21], v[20:21] op_sel:[0,0,1] op_sel_hi:[1,0,1]
    v_pk_add_f32 v[90:91], v[82:83], v[86:87]
    v_pk_fma_f32 v[86:87], v[86:87], v[20:21], v[20:21] op_sel:[0,0,1] op_sel_hi:[1,0,1]
    v_pk_add_f32 v[96:97], v[80:81], v[92:93]
    v_pk_fma_f32 v[92:93], v[92:93], v[30:31], v[30:31] op_sel:[0,0,1] op_sel_hi:[1,0,1]
    v_pk_add_f32 v[98:99], v[82:83], v[94:95]
    v_pk_fma_f32 v[94:95], v[94:95], v[30:31], v[30:31] op_sel:[0,0,1] op_sel_hi:[1,0,1]
    v_pk_fma_f32 v[88:89], v[84:85], v[76:77], v[88:89]
    buffer_load_dwordx4 v[224:227], v252, s[12:15], s36 offen offset:1024 sc1
    v_pk_fma_f32 v[90:91], v[86:87], v[78:79], v[90:91]
    ds_write_b128 v4, v[88:91] offset:2048
    v_pk_fma_f32 v[96:97], v[92:93], v[76:77], v[96:97]
    v_pk_fma_f32 v[98:99], v[94:95], v[78:79], v[98:99]
    ds_write_b128 v4, v[96:99] offset:22528
    v_lshlrev_b32 v100, 16, v62
    v_and_b32 v101, 0xffff0000, v62
    v_lshlrev_b32 v102, 16, v63
    v_and_b32 v103, 0xffff0000, v63
    v_lshlrev_b32 v104, 16, v72
    v_and_b32 v105, 0xffff0000, v72
    v_lshlrev_b32 v106, 16, v73
    v_and_b32 v107, 0xffff0000, v73
    v_lshlrev_b32 v108, 16, v42
    v_and_b32 v109, 0xffff0000, v42
    v_lshlrev_b32 v110, 16, v43
    buffer_load_dwordx4 v[228:231], v252, s[12:15], s37 offen offset:1024 sc1
    v_and_b32 v111, 0xffff0000, v43
    v_lshlrev_b32 v116, 16, v52
    v_and_b32 v117, 0xffff0000, v52
    v_lshlrev_b32 v118, 16, v53
    v_and_b32 v119, 0xffff0000, v53
    v_pk_add_f32 v[112:113], v[104:105], v[108:109]
    v_pk_fma_f32 v[108:109], v[108:109], v[22:23], v[22:23] op_sel:[0,0,1] op_sel_hi:[1,0,1]
    v_pk_add_f32 v[114:115], v[106:107], v[110:111]
    v_pk_fma_f32 v[110:111], v[110:111], v[22:23], v[22:23] op_sel:[0,0,1] op_sel_hi:[1,0,1]
    v_pk_add_f32 v[120:121], v[104:105], v[116:117]
    v_pk_fma_f32 v[116:117], v[116:117], v[32:33], v[32:33] op_sel:[0,0,1] op_sel_hi:[1,0,1]
    v_pk_add_f32 v[122:123], v[106:107], v[118:119]
    v_pk_fma_f32 v[118:119], v[118:119], v[32:33], v[32:33] op_sel:[0,0,1] op_sel_hi:[1,0,1]
    v_pk_fma_f32 v[112:113], v[108:109], v[100:101], v[112:113]
    v_pk_fma_f32 v[114:115], v[110:111], v[102:103], v[114:115]
    ds_write_b128 v4, v[112:115] offset:3072
    buffer_load_dwordx4 v[232:235], v252, s[12:15], s38 offen offset:1024 sc1
    v_pk_fma_f32 v[120:121], v[116:117], v[100:101], v[120:121]
    v_pk_fma_f32 v[122:123], v[118:119], v[102:103], v[122:123]
    ds_write_b128 v4, v[120:123] offset:23552
    v_lshlrev_b32 v76, 16, v64
    v_and_b32 v77, 0xffff0000, v64
    v_lshlrev_b32 v78, 16, v65
    v_and_b32 v79, 0xffff0000, v65
    v_lshlrev_b32 v80, 16, v74
    v_and_b32 v81, 0xffff0000, v74
    v_lshlrev_b32 v82, 16, v75
    v_and_b32 v83, 0xffff0000, v75
    v_lshlrev_b32 v84, 16, v44
    v_and_b32 v85, 0xffff0000, v44
    v_lshlrev_b32 v86, 16, v45
    v_and_b32 v87, 0xffff0000, v45
    v_lshlrev_b32 v92, 16, v54
    buffer_load_dwordx4 v[236:239], v252, s[12:15], s39 offen offset:1024 sc1
    v_and_b32 v93, 0xffff0000, v54
    v_lshlrev_b32 v94, 16, v55
    v_and_b32 v95, 0xffff0000, v55
    v_pk_add_f32 v[88:89], v[80:81], v[84:85]
    v_pk_fma_f32 v[84:85], v[84:85], v[24:25], v[24:25] op_sel:[0,0,1] op_sel_hi:[1,0,1]
    v_pk_add_f32 v[90:91], v[82:83], v[86:87]
    v_pk_fma_f32 v[86:87], v[86:87], v[24:25], v[24:25] op_sel:[0,0,1] op_sel_hi:[1,0,1]
    v_pk_add_f32 v[96:97], v[80:81], v[92:93]
    v_pk_fma_f32 v[92:93], v[92:93], v[34:35], v[34:35] op_sel:[0,0,1] op_sel_hi:[1,0,1]
    v_pk_add_f32 v[98:99], v[82:83], v[94:95]
    v_pk_fma_f32 v[94:95], v[94:95], v[34:35], v[34:35] op_sel:[0,0,1] op_sel_hi:[1,0,1]
    v_pk_fma_f32 v[88:89], v[84:85], v[76:77], v[88:89]
    v_pk_fma_f32 v[90:91], v[86:87], v[78:79], v[90:91]
    ds_write_b128 v4, v[88:91] offset:4096
    v_pk_fma_f32 v[96:97], v[92:93], v[76:77], v[96:97]
    v_pk_fma_f32 v[98:99], v[94:95], v[78:79], v[98:99]
    ds_write_b128 v4, v[96:99] offset:24576
    s_add_u32 s45, s36, 4096
    buffer_load_dwordx4 v[240:243], v252, s[12:15], s45 offen offset:2048 sc1
    s_add_u32 s45, s37, 4096
    buffer_load_dwordx4 v[244:247], v252, s[12:15], s45 offen offset:2048 sc1
    s_add_u32 s45, s38, 4096
    buffer_load_dwordx4 v[248:251], v252, s[12:15], s45 offen offset:2048 sc1
    s_add_u32 s45, s39, 4096
    buffer_load_dwordx4 v[204:207], v252, s[12:15], s45 offen offset:2048 sc1
    v_and_b32 v2, 7, v0
    v_lshlrev_b32 v2, 6, v2
    v_mov_b32 v3, s82
    s_mov_b32 s83, -4
    v_accvgpr_read_b32 v5, a246
    s_movk_i32 s49, 336
    s_movk_i32 s50, 2560
    s_mul_i32 s48, s3, 5376
    s_add_u32 s48, s48, 16384
    v_lshlrev_b32 v253, 4, v6
    v_mad_u32_u24 v6, v11, s49, v253
    v_add_u32 v6, s48, v6
    v_mad_u32_u24 v11, v11, s50, v253
    v_lshlrev_b32 v253, 4, v7
    v_mad_u32_u24 v7, v12, s49, v253
    v_add_u32 v7, s48, v7
    v_mad_u32_u24 v12, v12, s50, v253
    v_lshlrev_b32 v253, 4, v8
    v_mad_u32_u24 v8, v13, s49, v253
    v_add_u32 v8, s48, v8
    v_mad_u32_u24 v13, v13, s50, v253
    v_lshlrev_b32 v253, 4, v9
    v_mad_u32_u24 v9, v14, s49, v253
    v_add_u32 v9, s48, v9
    v_mad_u32_u24 v14, v14, s50, v253
    v_lshlrev_b32 v253, 4, v10
    v_mad_u32_u24 v10, v15, s49, v253
    v_add_u32 v10, s48, v10
    v_mad_u32_u24 v15, v15, s50, v253
    s_waitcnt vmcnt(12)
    v_xor_b32 v172, s32, v172
    v_xor_b32 v173, s32, v173
    v_or_b32 v1, v172, v173
    v_xor_b32 v174, s32, v174
    v_xor_b32 v175, s32, v175
    v_or3_b32 v1, v174, v175, v1
    v_xor_b32 v176, s32, v176
    v_xor_b32 v177, s32, v177
    v_or3_b32 v1, v176, v177, v1
    v_xor_b32 v178, s32, v178
    v_xor_b32 v179, s32, v179
    v_or3_b32 v1, v178, v179, v1
    v_xor_b32 v180, s32, v180
    v_xor_b32 v181, s32, v181
    v_or3_b32 v1, v180, v181, v1
    v_xor_b32 v182, s32, v182
    v_xor_b32 v183, s32, v183
    v_or3_b32 v1, v182, v183, v1
    v_xor_b32 v184, s32, v184
    v_xor_b32 v185, s32, v185
    v_or3_b32 v1, v184, v185, v1
    v_xor_b32 v186, s32, v186
    v_xor_b32 v187, s32, v187
    v_or3_b32 v1, v186, v187, v1
    v_and_b32 v1, 0x10001, v1
    v_cmp_ne_u32 vcc, 0, v1
    s_nop 1
    s_cbranch_vccnz va7
vad8:
    v_add_u32 v254, s86, v252
    v_mfma_f32_16x16x32_bf16 v[92:95], a[0:3], v[172:175], 0
    buffer_load_dwordx4 v[208:211], v252, s[12:15], s36 offen offset:2048 sc1
    v_mfma_f32_16x16x32_bf16 v[96:99], a[4:7], v[172:175], 0
    s_waitcnt vmcnt(12)
    v_xor_b32 v188, s32, v188
    v_xor_b32 v189, s32, v189
    v_mfma_f32_16x16x32_bf16 v[100:103], a[8:11], v[172:175], 0
    v_or_b32 v1, v188, v189
    v_xor_b32 v190, s32, v190
    v_mfma_f32_16x16x32_bf16 v[104:107], a[12:15], v[172:175], 0
    buffer_load_dwordx4 v[212:215], v252, s[12:15], s37 offen offset:2048 sc1
    v_mfma_f32_16x16x32_bf16 v[108:111], a[16:19], v[172:175], 0
    v_xor_b32 v191, s32, v191
    v_or3_b32 v1, v190, v191, v1
    v_mfma_f32_16x16x32_bf16 v[112:115], a[0:3], v[176:179], 0
    s_add_u32 s58, s34, 69632
    v_mov_b32 v4, s28
    s_mov_b64 exec, 1
    buffer_store_dword v4, off, s[12:15], s58 offset:0 sc1
    s_mov_b64 exec, -1
    v_mfma_f32_16x16x32_bf16 v[116:119], a[4:7], v[176:179], 0
    buffer_load_dwordx4 v[216:219], v252, s[12:15], s38 offen offset:2048 sc1
    v_mfma_f32_16x16x32_bf16 v[120:123], a[8:11], v[176:179], 0
    s_waitcnt vmcnt(14)
    v_xor_b32 v192, s32, v192
    v_xor_b32 v193, s32, v193
    v_mfma_f32_16x16x32_bf16 v[124:127], a[12:15], v[176:179], 0
    v_or3_b32 v1, v192, v193, v1
    v_xor_b32 v194, s32, v194
    v_mfma_f32_16x16x32_bf16 v[128:131], a[16:19], v[176:179], 0
    buffer_load_dwordx4 v[220:223], v252, s[12:15], s39 offen offset:2048 sc1
    v_mfma_f32_16x16x32_bf16 v[132:135], a[0:3], v[180:183], 0
    v_xor_b32 v195, s32, v195
    v_or3_b32 v1, v194, v195, v1
    v_mfma_f32_16x16x32_bf16 v[136:139], a[4:7], v[180:183], 0
    s_waitcnt vmcnt(14)
    v_xor_b32 v196, s32, v196
    v_xor_b32 v197, s32, v197
    v_mfma_f32_16x16x32_bf16 v[140:143], a[8:11], v[180:183], 0
    s_add_u32 s45, s36, 4096
    buffer_load_dwordx4 v[172:175], v252, s[12:15], s45 offen offset:3072 sc1
    v_mfma_f32_16x16x32_bf16 v[144:147], a[12:15], v[180:183], 0
    v_or3_b32 v1, v196, v197, v1
    v_xor_b32 v198, s32, v198
    v_mfma_f32_16x16x32_bf16 v[148:151], a[16:19], v[180:183], 0
    v_xor_b32 v199, s32, v199
    v_or3_b32 v1, v198, v199, v1
    v_mfma_f32_16x16x32_bf16 v[152:155], a[0:3], v[184:187], 0
    s_add_u32 s45, s37, 4096
    buffer_load_dwordx4 v[176:179], v252, s[12:15], s45 offen offset:3072 sc1
    v_mfma_f32_16x16x32_bf16 v[156:159], a[4:7], v[184:187], 0
    s_waitcnt vmcnt(15)
    v_xor_b32 v200, s32, v200
    v_xor_b32 v201, s32, v201
    v_mfma_f32_16x16x32_bf16 v[160:163], a[8:11], v[184:187], 0
    v_or3_b32 v1, v200, v201, v1
    v_xor_b32 v202, s32, v202
    v_mfma_f32_16x16x32_bf16 v[164:167], a[12:15], v[184:187], 0
    s_add_u32 s45, s38, 4096
    buffer_load_dwordx4 v[180:183], v252, s[12:15], s45 offen offset:3072 sc1
    v_mfma_f32_16x16x32_bf16 v[168:171], a[16:19], v[184:187], 0
    v_xor_b32 v203, s32, v203
    v_or3_b32 v1, v202, v203, v1
    v_and_b32 v1, 0x10001, v1
    v_cmp_ne_u32 vcc, 0, v1
    s_nop 1
    s_cbranch_vccnz va9
vad10:
    v_mfma_f32_16x16x32_bf16 v[92:95], a[100:103], v[188:191], v[92:95]
    s_add_u32 s45, s39, 4096
    buffer_load_dwordx4 v[184:187], v252, s[12:15], s45 offen offset:3072 sc1
    v_mfma_f32_16x16x32_bf16 v[96:99], a[104:107], v[188:191], v[96:99]
    s_add_u32 s94, s47, 9216
    buffer_load_dwordx4 a[180:183], v252, s[12:15], s94 offen sc1
    v_mfma_f32_16x16x32_bf16 v[100:103], a[108:111], v[188:191], v[100:103]
    s_waitcnt vmcnt(17)
    v_xor_b32 v224, s32, v224
    v_xor_b32 v225, s32, v225
    v_mfma_f32_16x16x32_bf16 v[104:107], a[112:115], v[188:191], v[104:107]
    buffer_load_dwordx4 v[16:19], v252, s[12:15], s36 offen offset:3072 sc1
    v_mfma_f32_16x16x32_bf16 v[108:111], a[116:119], v[188:191], v[108:111]
    v_or_b32 v1, v224, v225
    v_xor_b32 v226, s32, v226
    v_mfma_f32_16x16x32_bf16 v[112:115], a[100:103], v[192:195], v[112:115]
    v_xor_b32 v227, s32, v227
    v_or3_b32 v1, v226, v227, v1
    v_mfma_f32_16x16x32_bf16 v[116:119], a[104:107], v[192:195], v[116:119]
    buffer_load_dwordx4 v[188:191], v252, s[12:15], s37 offen offset:3072 sc1
    v_mfma_f32_16x16x32_bf16 v[120:123], a[108:111], v[192:195], v[120:123]
    s_waitcnt vmcnt(18)
    v_xor_b32 v228, s32, v228
    v_xor_b32 v229, s32, v229
    v_mfma_f32_16x16x32_bf16 v[124:127], a[112:115], v[192:195], v[124:127]
    v_or3_b32 v1, v228, v229, v1
    v_xor_b32 v230, s32, v230
    v_mfma_f32_16x16x32_bf16 v[128:131], a[116:119], v[192:195], v[128:131]
    buffer_load_dwordx4 v[20:23], v252, s[12:15], s38 offen offset:3072 sc1
    v_mfma_f32_16x16x32_bf16 v[132:135], a[100:103], v[196:199], v[132:135]
    s_add_u32 s94, s47, 50176
    buffer_load_dwordx4 a[184:187], v252, s[12:15], s94 offen sc1
    v_mfma_f32_16x16x32_bf16 v[136:139], a[104:107], v[196:199], v[136:139]
    v_xor_b32 v231, s32, v231
    v_or3_b32 v1, v230, v231, v1
    v_mfma_f32_16x16x32_bf16 v[140:143], a[108:111], v[196:199], v[140:143]
    buffer_load_dwordx4 v[192:195], v252, s[12:15], s39 offen offset:3072 sc1
    v_mfma_f32_16x16x32_bf16 v[144:147], a[112:115], v[196:199], v[144:147]
    s_waitcnt vmcnt(20)
    v_xor_b32 v232, s32, v232
    v_xor_b32 v233, s32, v233
    v_mfma_f32_16x16x32_bf16 v[148:151], a[116:119], v[196:199], v[148:151]
    v_or3_b32 v1, v232, v233, v1
    v_xor_b32 v234, s32, v234
    v_mfma_f32_16x16x32_bf16 v[152:155], a[100:103], v[200:203], v[152:155]
    s_add_u32 s45, s36, 8192
    buffer_load_dwordx4 v[196:199], v252, s[12:15], s45 offen offset:0 sc1
    v_mfma_f32_16x16x32_bf16 v[156:159], a[104:107], v[200:203], v[156:159]
    v_xor_b32 v235, s32, v235
    v_or3_b32 v1, v234, v235, v1
    v_mfma_f32_16x16x32_bf16 v[160:163], a[108:111], v[200:203], v[160:163]
    s_waitcnt vmcnt(20)
    v_xor_b32 v236, s32, v236
    v_xor_b32 v237, s32, v237
    v_mfma_f32_16x16x32_bf16 v[164:167], a[112:115], v[200:203], v[164:167]
    v_or3_b32 v1, v236, v237, v1
    v_xor_b32 v238, s32, v238
    v_mfma_f32_16x16x32_bf16 v[168:171], a[116:119], v[200:203], v[168:171]
    v_xor_b32 v239, s32, v239
    v_or3_b32 v1, v238, v239, v1
    v_and_b32 v1, 0x10001, v1
    v_cmp_ne_u32 vcc, 0, v1
    s_nop 1
    s_cbranch_vccnz va11
vad12:
    v_mfma_f32_16x16x32_bf16 v[92:95], a[20:23], v[224:227], v[92:95]
    s_add_u32 s45, s37, 8192
    buffer_load_dwordx4 v[200:203], v252, s[12:15], s45 offen offset:0 sc1
    v_mfma_f32_16x16x32_bf16 v[96:99], a[24:27], v[224:227], v[96:99]
    s_add_u32 s94, s47, 91136
    buffer_load_dwordx4 a[188:191], v252, s[12:15], s94 offen sc1
    v_mfma_f32_16x16x32_bf16 v[100:103], a[28:31], v[224:227], v[100:103]
    s_waitcnt vmcnt(21)
    v_xor_b32 v240, s32, v240
    v_xor_b32 v241, s32, v241
    v_mfma_f32_16x16x32_bf16 v[104:107], a[32:35], v[224:227], v[104:107]
    v_or_b32 v1, v240, v241
    v_xor_b32 v242, s32, v242
    v_mfma_f32_16x16x32_bf16 v[108:111], a[36:39], v[224:227], v[108:111]
    v_xor_b32 v243, s32, v243
    v_or3_b32 v1, v242, v243, v1
    v_mfma_f32_16x16x32_bf16 v[112:115], a[20:23], v[228:231], v[112:115]
    v_mfma_f32_16x16x32_bf16 v[116:119], a[24:27], v[228:231], v[116:119]
    s_add_u32 s45, s38, 8192
    buffer_load_dwordx4 v[224:227], v252, s[12:15], s45 offen offset:0 sc1
    v_mfma_f32_16x16x32_bf16 v[120:123], a[28:31], v[228:231], v[120:123]
    s_waitcnt vmcnt(21)
    v_xor_b32 v244, s32, v244
    v_xor_b32 v245, s32, v245
    v_mfma_f32_16x16x32_bf16 v[124:127], a[32:35], v[228:231], v[124:127]
    v_or3_b32 v1, v244, v245, v1
    v_xor_b32 v246, s32, v246
    v_mfma_f32_16x16x32_bf16 v[128:131], a[36:39], v[228:231], v[128:131]
    v_xor_b32 v247, s32, v247
    v_or3_b32 v1, v246, v247, v1
    v_mfma_f32_16x16x32_bf16 v[132:135], a[20:23], v[232:235], v[132:135]
    s_add_u32 s94, s47, 132096
    buffer_load_dwordx4 a[192:195], v252, s[12:15], s94 offen sc1
    v_mfma_f32_16x16x32_bf16 v[136:139], a[24:27], v[232:235], v[136:139]
    s_waitcnt vmcnt(21)
    v_xor_b32 v248, s32, v248
    v_xor_b32 v249, s32, v249
    v_mfma_f32_16x16x32_bf16 v[140:143], a[28:31], v[232:235], v[140:143]
    s_add_u32 s45, s39, 8192
    buffer_load_dwordx4 v[228:231], v252, s[12:15], s45 offen offset:0 sc1
    v_mfma_f32_16x16x32_bf16 v[144:147], a[32:35], v[232:235], v[144:147]
    v_or3_b32 v1, v248, v249, v1
    v_xor_b32 v250, s32, v250
    v_mfma_f32_16x16x32_bf16 v[148:151], a[36:39], v[232:235], v[148:151]
    v_xor_b32 v251, s32, v251
    v_or3_b32 v1, v250, v251, v1
    v_mfma_f32_16x16x32_bf16 v[152:155], a[20:23], v[236:239], v[152:155]
    s_add_u32 s45, s36, 4096
    buffer_load_dwordx4 v[24:27], v252, s[12:15], s45 offen offset:0 sc1
    v_mfma_f32_16x16x32_bf16 v[156:159], a[24:27], v[236:239], v[156:159]
    s_waitcnt vmcnt(22)
    v_xor_b32 v204, s32, v204
    v_xor_b32 v205, s32, v205
    v_mfma_f32_16x16x32_bf16 v[160:163], a[28:31], v[236:239], v[160:163]
    v_or3_b32 v1, v204, v205, v1
    v_xor_b32 v206, s32, v206
    v_mfma_f32_16x16x32_bf16 v[164:167], a[32:35], v[236:239], v[164:167]
    v_xor_b32 v207, s32, v207
    v_or3_b32 v1, v206, v207, v1
    v_mfma_f32_16x16x32_bf16 v[168:171], a[36:39], v[236:239], v[168:171]
    v_and_b32 v1, 0x10001, v1
    v_cmp_ne_u32 vcc, 0, v1
    s_nop 1
    s_cbranch_vccnz va13
vad14:
    v_mfma_f32_16x16x32_bf16 v[92:95], a[120:123], v[240:243], v[92:95]
    s_add_u32 s45, s37, 4096
    buffer_load_dwordx4 v[28:31], v252, s[12:15], s45 offen offset:0 sc1
    v_mfma_f32_16x16x32_bf16 v[96:99], a[124:127], v[240:243], v[96:99]
    s_add_u32 s94, s47, 173056
    buffer_load_dwordx4 a[196:199], v252, s[12:15], s94 offen sc1
    v_mfma_f32_16x16x32_bf16 v[100:103], a[128:131], v[240:243], v[100:103]
    s_waitcnt vmcnt(23)
    v_xor_b32 v208, s32, v208
    v_xor_b32 v209, s32, v209
    v_mfma_f32_16x16x32_bf16 v[104:107], a[132:135], v[240:243], v[104:107]
    v_or_b32 v1, v208, v209
    v_xor_b32 v210, s32, v210
    v_mfma_f32_16x16x32_bf16 v[108:111], a[136:139], v[240:243], v[108:111]
    v_xor_b32 v211, s32, v211
    v_or3_b32 v1, v210, v211, v1
    v_mfma_f32_16x16x32_bf16 v[112:115], a[120:123], v[244:247], v[112:115]
    v_mfma_f32_16x16x32_bf16 v[116:119], a[124:127], v[244:247], v[116:119]
    s_add_u32 s45, s38, 4096
    buffer_load_dwordx4 v[32:35], v252, s[12:15], s45 offen offset:0 sc1
    v_mfma_f32_16x16x32_bf16 v[120:123], a[128:131], v[244:247], v[120:123]
    s_waitcnt vmcnt(23)
    v_xor_b32 v212, s32, v212
    v_xor_b32 v213, s32, v213
    v_mfma_f32_16x16x32_bf16 v[124:127], a[132:135], v[244:247], v[124:127]
    v_or3_b32 v1, v212, v213, v1
    v_xor_b32 v214, s32, v214
    v_mfma_f32_16x16x32_bf16 v[128:131], a[136:139], v[244:247], v[128:131]
    v_xor_b32 v215, s32, v215
    v_or3_b32 v1, v214, v215, v1
    v_mfma_f32_16x16x32_bf16 v[132:135], a[120:123], v[248:251], v[132:135]
    v_mfma_f32_16x16x32_bf16 v[136:139], a[124:127], v[248:251], v[136:139]
    s_waitcnt vmcnt(21)
    v_xor_b32 v216, s32, v216
    v_xor_b32 v217, s32, v217
    v_mfma_f32_16x16x32_bf16 v[140:143], a[128:131], v[248:251], v[140:143]
    s_add_u32 s45, s39, 4096
    buffer_load_dwordx4 v[36:39], v252, s[12:15], s45 offen offset:0 sc1
    v_mfma_f32_16x16x32_bf16 v[144:147], a[132:135], v[248:251], v[144:147]
    v_or3_b32 v1, v216, v217, v1
    v_xor_b32 v218, s32, v218
    v_mfma_f32_16x16x32_bf16 v[148:151], a[136:139], v[248:251], v[148:151]
    v_xor_b32 v219, s32, v219
    v_or3_b32 v1, v218, v219, v1
    v_mfma_f32_16x16x32_bf16 v[152:155], a[120:123], v[204:207], v[152:155]
    s_add_u32 s45, s36, 8192
    buffer_load_dwordx4 v[40:43], v252, s[12:15], s45 offen offset:1024 sc1
    v_mfma_f32_16x16x32_bf16 v[156:159], a[124:127], v[204:207], v[156:159]
    s_waitcnt vmcnt(22)
    v_xor_b32 v220, s32, v220
    v_xor_b32 v221, s32, v221
    v_mfma_f32_16x16x32_bf16 v[160:163], a[128:131], v[204:207], v[160:163]
    v_or3_b32 v1, v220, v221, v1
    v_xor_b32 v222, s32, v222
    v_mfma_f32_16x16x32_bf16 v[164:167], a[132:135], v[204:207], v[164:167]
    v_xor_b32 v223, s32, v223
    v_or3_b32 v1, v222, v223, v1
    v_mfma_f32_16x16x32_bf16 v[168:171], a[136:139], v[204:207], v[168:171]
    v_and_b32 v1, 0x10001, v1
    v_cmp_ne_u32 vcc, 0, v1
    s_nop 1
    s_cbranch_vccnz va15
vad16:
    v_mfma_f32_16x16x32_bf16 v[92:95], a[40:43], v[208:211], v[92:95]
    s_add_u32 s45, s37, 8192
    buffer_load_dwordx4 v[44:47], v252, s[12:15], s45 offen offset:1024 sc1
    v_mfma_f32_16x16x32_bf16 v[96:99], a[44:47], v[208:211], v[96:99]
    s_waitcnt vmcnt(22)
    v_xor_b32 v172, s32, v172
    v_xor_b32 v173, s32, v173
    v_mfma_f32_16x16x32_bf16 v[100:103], a[48:51], v[208:211], v[100:103]
    v_or_b32 v1, v172, v173
    v_xor_b32 v174, s32, v174
    v_mfma_f32_16x16x32_bf16 v[104:107], a[52:55], v[208:211], v[104:107]
    v_xor_b32 v175, s32, v175
    v_or3_b32 v1, v174, v175, v1
    v_mfma_f32_16x16x32_bf16 v[108:111], a[56:59], v[208:211], v[108:111]
    v_mfma_f32_16x16x32_bf16 v[112:115], a[40:43], v[212:215], v[112:115]
    v_mfma_f32_16x16x32_bf16 v[116:119], a[44:47], v[212:215], v[116:119]
    s_add_u32 s45, s38, 8192
    buffer_load_dwordx4 v[48:51], v252, s[12:15], s45 offen offset:1024 sc1
    v_mfma_f32_16x16x32_bf16 v[120:123], a[48:51], v[212:215], v[120:123]
    s_waitcnt vmcnt(22)
    v_xor_b32 v176, s32, v176
    v_xor_b32 v177, s32, v177
    v_mfma_f32_16x16x32_bf16 v[124:127], a[52:55], v[212:215], v[124:127]
    v_or3_b32 v1, v176, v177, v1
    v_xor_b32 v178, s32, v178
    v_mfma_f32_16x16x32_bf16 v[128:131], a[56:59], v[212:215], v[128:131]
    v_xor_b32 v179, s32, v179
    v_or3_b32 v1, v178, v179, v1
    v_mfma_f32_16x16x32_bf16 v[132:135], a[40:43], v[216:219], v[132:135]
    v_mfma_f32_16x16x32_bf16 v[136:139], a[44:47], v[216:219], v[136:139]
    s_waitcnt vmcnt(21)
    v_xor_b32 v180, s32, v180
    v_xor_b32 v181, s32, v181
    v_mfma_f32_16x16x32_bf16 v[140:143], a[48:51], v[216:219], v[140:143]
    s_add_u32 s45, s39, 8192
    buffer_load_dwordx4 v[52:55], v252, s[12:15], s45 offen offset:1024 sc1
    v_mfma_f32_16x16x32_bf16 v[144:147], a[52:55], v[216:219], v[144:147]
    v_or3_b32 v1, v180, v181, v1
    v_xor_b32 v182, s32, v182
    v_mfma_f32_16x16x32_bf16 v[148:151], a[56:59], v[216:219], v[148:151]
    v_xor_b32 v183, s32, v183
    v_or3_b32 v1, v182, v183, v1
    v_mfma_f32_16x16x32_bf16 v[152:155], a[40:43], v[220:223], v[152:155]
    s_waitcnt vmcnt(21)
    v_xor_b32 v184, s32, v184
    v_xor_b32 v185, s32, v185
    v_mfma_f32_16x16x32_bf16 v[156:159], a[44:47], v[220:223], v[156:159]
    v_or3_b32 v1, v184, v185, v1
    v_xor_b32 v186, s32, v186
    v_mfma_f32_16x16x32_bf16 v[160:163], a[48:51], v[220:223], v[160:163]
    v_xor_b32 v187, s32, v187
    v_or3_b32 v1, v186, v187, v1
    v_mfma_f32_16x16x32_bf16 v[164:167], a[52:55], v[220:223], v[164:167]
    v_and_b32 v1, 0x10001, v1
    v_cmp_ne_u32 vcc, 0, v1
    v_mfma_f32_16x16x32_bf16 v[168:171], a[56:59], v[220:223], v[168:171]
    s_nop 0
    s_cbranch_vccnz va17
vad18:
    v_mfma_f32_16x16x32_bf16 v[92:95], a[140:143], v[172:175], v[92:95]
    buffer_load_dword v4, v2, s[12:15], s95 offen sc1
    v_mfma_f32_16x16x32_bf16 v[96:99], a[144:147], v[172:175], v[96:99]
    s_waitcnt vmcnt(20)
    v_xor_b32 v16, s32, v16
    v_xor_b32 v17, s32, v17
    v_mfma_f32_16x16x32_bf16 v[100:103], a[148:151], v[172:175], v[100:103]
    v_or_b32 v1, v16, v17
    v_xor_b32 v18, s32, v18
    v_mfma_f32_16x16x32_bf16 v[104:107], a[152:155], v[172:175], v[104:107]
    v_xor_b32 v19, s32, v19
    v_or3_b32 v1, v18, v19, v1
    v_mfma_f32_16x16x32_bf16 v[108:111], a[156:159], v[172:175], v[108:111]
    v_mfma_f32_16x16x32_bf16 v[112:115], a[140:143], v[176:179], v[112:115]
    v_mfma_f32_16x16x32_bf16 v[116:119], a[144:147], v[176:179], v[116:119]
    s_waitcnt vmcnt(19)
    v_xor_b32 v188, s32, v188
    v_xor_b32 v189, s32, v189
    v_mfma_f32_16x16x32_bf16 v[120:123], a[148:151], v[176:179], v[120:123]
    v_or3_b32 v1, v188, v189, v1
    v_xor_b32 v190, s32, v190
    v_mfma_f32_16x16x32_bf16 v[124:127], a[152:155], v[176:179], v[124:127]
    v_xor_b32 v191, s32, v191
    v_or3_b32 v1, v190, v191, v1
    v_mfma_f32_16x16x32_bf16 v[128:131], a[156:159], v[176:179], v[128:131]
    v_mfma_f32_16x16x32_bf16 v[132:135], a[140:143], v[180:183], v[132:135]
    v_mfma_f32_16x16x32_bf16 v[136:139], a[144:147], v[180:183], v[136:139]
    s_waitcnt vmcnt(18)
    v_xor_b32 v20, s32, v20
    v_xor_b32 v21, s32, v21
    v_mfma_f32_16x16x32_bf16 v[140:143], a[148:151], v[180:183], v[140:143]
    v_or3_b32 v1, v20, v21, v1
    v_xor_b32 v22, s32, v22
    v_mfma_f32_16x16x32_bf16 v[144:147], a[152:155], v[180:183], v[144:147]
    v_xor_b32 v23, s32, v23
    v_or3_b32 v1, v22, v23, v1
    v_mfma_f32_16x16x32_bf16 v[148:151], a[156:159], v[180:183], v[148:151]
    s_waitcnt vmcnt(16)
    v_xor_b32 v192, s32, v192
    v_xor_b32 v193, s32, v193
    v_mfma_f32_16x16x32_bf16 v[152:155], a[140:143], v[184:187], v[152:155]
    v_or3_b32 v1, v192, v193, v1
    v_xor_b32 v194, s32, v194
    v_mfma_f32_16x16x32_bf16 v[156:159], a[144:147], v[184:187], v[156:159]
    v_xor_b32 v195, s32, v195
    v_or3_b32 v1, v194, v195, v1
    v_mfma_f32_16x16x32_bf16 v[160:163], a[148:151], v[184:187], v[160:163]
    v_and_b32 v1, 0x10001, v1
    v_cmp_ne_u32 vcc, 0, v1
    v_mfma_f32_16x16x32_bf16 v[164:167], a[152:155], v[184:187], v[164:167]
    v_mfma_f32_16x16x32_bf16 v[168:171], a[156:159], v[184:187], v[168:171]
    s_cbranch_vccnz va19
vad20:
    v_mfma_f32_16x16x32_bf16 v[92:95], a[60:63], v[16:19], v[92:95]
    v_mfma_f32_16x16x32_bf16 v[96:99], a[64:67], v[16:19], v[96:99]
    s_waitcnt vmcnt(15)
    v_xor_b32 v196, s32, v196
    v_xor_b32 v197, s32, v197
    v_mfma_f32_16x16x32_bf16 v[100:103], a[68:71], v[16:19], v[100:103]
    v_or_b32 v1, v196, v197
    v_xor_b32 v198, s32, v198
    v_mfma_f32_16x16x32_bf16 v[104:107], a[72:75], v[16:19], v[104:107]
    v_xor_b32 v199, s32, v199
    v_or3_b32 v1, v198, v199, v1
    v_mfma_f32_16x16x32_bf16 v[108:111], a[76:79], v[16:19], v[108:111]
    v_mfma_f32_16x16x32_bf16 v[112:115], a[60:63], v[188:191], v[112:115]
    v_mfma_f32_16x16x32_bf16 v[116:119], a[64:67], v[188:191], v[116:119]
    s_waitcnt vmcnt(14)
    v_xor_b32 v200, s32, v200
    v_xor_b32 v201, s32, v201
    v_mfma_f32_16x16x32_bf16 v[120:123], a[68:71], v[188:191], v[120:123]
    v_or3_b32 v1, v200, v201, v1
    v_xor_b32 v202, s32, v202
    v_mfma_f32_16x16x32_bf16 v[124:127], a[72:75], v[188:191], v[124:127]
    v_xor_b32 v203, s32, v203
    v_or3_b32 v1, v202, v203, v1
    v_mfma_f32_16x16x32_bf16 v[128:131], a[76:79], v[188:191], v[128:131]
    v_mfma_f32_16x16x32_bf16 v[132:135], a[60:63], v[20:23], v[132:135]
    v_mfma_f32_16x16x32_bf16 v[136:139], a[64:67], v[20:23], v[136:139]
    s_waitcnt vmcnt(12)
    v_xor_b32 v224, s32, v224
    v_xor_b32 v225, s32, v225
    v_mfma_f32_16x16x32_bf16 v[140:143], a[68:71], v[20:23], v[140:143]
    v_or3_b32 v1, v224, v225, v1
    v_xor_b32 v226, s32, v226
    v_mfma_f32_16x16x32_bf16 v[144:147], a[72:75], v[20:23], v[144:147]
    v_xor_b32 v227, s32, v227
    v_or3_b32 v1, v226, v227, v1
    v_mfma_f32_16x16x32_bf16 v[148:151], a[76:79], v[20:23], v[148:151]
    s_waitcnt vmcnt(10)
    v_xor_b32 v228, s32, v228
    v_xor_b32 v229, s32, v229
    v_mfma_f32_16x16x32_bf16 v[152:155], a[60:63], v[192:195], v[152:155]
    v_or3_b32 v1, v228, v229, v1
    v_xor_b32 v230, s32, v230
    v_mfma_f32_16x16x32_bf16 v[156:159], a[64:67], v[192:195], v[156:159]
    v_xor_b32 v231, s32, v231
    v_or3_b32 v1, v230, v231, v1
    v_mfma_f32_16x16x32_bf16 v[160:163], a[68:71], v[192:195], v[160:163]
    v_and_b32 v1, 0x10001, v1
    v_cmp_ne_u32 vcc, 0, v1
    v_mfma_f32_16x16x32_bf16 v[164:167], a[72:75], v[192:195], v[164:167]
    v_mfma_f32_16x16x32_bf16 v[168:171], a[76:79], v[192:195], v[168:171]
    s_cbranch_vccnz va21
vad22:
    s_waitcnt vmcnt(0)
    v_cmp_ne_u32 vcc, s28, v4
    s_nop 1
    s_cbranch_vccnz fa23
fad24:
    v_mfma_f32_16x16x32_bf16 v[92:95], a[160:163], v[196:199], v[92:95]
    buffer_load_dwordx4 v[56:59], v252, s[12:15], s40 offen offset:0 sc1
    v_mfma_f32_16x16x32_bf16 v[96:99], a[164:167], v[196:199], v[96:99]
    v_xor_b32 v24, s32, v24
    v_xor_b32 v25, s32, v25
    v_mfma_f32_16x16x32_bf16 v[100:103], a[168:171], v[196:199], v[100:103]
    v_or_b32 v1, v24, v25
    v_xor_b32 v26, s32, v26
    v_mfma_f32_16x16x32_bf16 v[104:107], a[172:175], v[196:199], v[104:107]
    buffer_load_dwordx4 v[60:63], v252, s[12:15], s40 offen offset:1024 sc1
    v_mfma_f32_16x16x32_bf16 v[108:111], a[176:179], v[196:199], v[108:111]
    v_xor_b32 v27, s32, v27
    v_or3_b32 v1, v26, v27, v1
    v_mfma_f32_16x16x32_bf16 v[112:115], a[160:163], v[200:203], v[112:115]
    v_mfma_f32_16x16x32_bf16 v[116:119], a[164:167], v[200:203], v[116:119]
    buffer_load_dwordx4 v[64:67], v252, s[12:15], s40 offen offset:2048 sc1
    v_mfma_f32_16x16x32_bf16 v[120:123], a[168:171], v[200:203], v[120:123]
    v_xor_b32 v28, s32, v28
    v_xor_b32 v29, s32, v29
    v_mfma_f32_16x16x32_bf16 v[124:127], a[172:175], v[200:203], v[124:127]
    v_or3_b32 v1, v28, v29, v1
    v_xor_b32 v30, s32, v30
    v_mfma_f32_16x16x32_bf16 v[128:131], a[176:179], v[200:203], v[128:131]
    buffer_load_dwordx4 v[68:71], v252, s[12:15], s40 offen offset:3072 sc1
    v_mfma_f32_16x16x32_bf16 v[132:135], a[160:163], v[224:227], v[132:135]
    v_xor_b32 v31, s32, v31
    v_or3_b32 v1, v30, v31, v1
    v_mfma_f32_16x16x32_bf16 v[136:139], a[164:167], v[224:227], v[136:139]
    v_xor_b32 v32, s32, v32
    v_xor_b32 v33, s32, v33
    v_mfma_f32_16x16x32_bf16 v[140:143], a[168:171], v[224:227], v[140:143]
    s_add_u32 s45, s40, 4096
    buffer_load_dwordx4 v[72:75], v252, s[12:15], s45 offen offset:0 sc1
    v_mfma_f32_16x16x32_bf16 v[144:147], a[172:175], v[224:227], v[144:147]
    v_or3_b32 v1, v32, v33, v1
    v_xor_b32 v34, s32, v34
    v_mfma_f32_16x16x32_bf16 v[148:151], a[176:179], v[224:227], v[148:151]
    v_xor_b32 v35, s32, v35
    v_or3_b32 v1, v34, v35, v1
    v_mfma_f32_16x16x32_bf16 v[152:155], a[160:163], v[228:231], v[152:155]
    s_add_u32 s45, s40, 4096
    buffer_load_dwordx4 v[76:79], v252, s[12:15], s45 offen offset:1024 sc1
    v_mfma_f32_16x16x32_bf16 v[156:159], a[164:167], v[228:231], v[156:159]
    v_xor_b32 v36, s32, v36
    v_xor_b32 v37, s32, v37
    v_mfma_f32_16x16x32_bf16 v[160:163], a[168:171], v[228:231], v[160:163]
    v_or3_b32 v1, v36, v37, v1
    v_xor_b32 v38, s32, v38
    v_mfma_f32_16x16x32_bf16 v[164:167], a[172:175], v[228:231], v[164:167]
    s_add_u32 s45, s40, 4096
    buffer_load_dwordx4 v[80:83], v252, s[12:15], s45 offen offset:2048 sc1
    v_mfma_f32_16x16x32_bf16 v[168:171], a[176:179], v[228:231], v[168:171]
    v_xor_b32 v39, s32, v39
    v_or3_b32 v1, v38, v39, v1
    v_and_b32 v1, 0x10001, v1
    v_cmp_ne_u32 vcc, 0, v1
    s_nop 1
    s_cbranch_vccnz va25
vad26:
    v_mfma_f32_16x16x32_bf16 v[92:95], a[80:83], v[24:27], v[92:95]
    s_add_u32 s45, s40, 4096
    buffer_load_dwordx4 v[84:87], v252, s[12:15], s45 offen offset:3072 sc1
    v_mfma_f32_16x16x32_bf16 v[96:99], a[84:87], v[24:27], v[96:99]
    v_xor_b32 v40, s32, v40
    v_xor_b32 v41, s32, v41
    v_mfma_f32_16x16x32_bf16 v[100:103], a[88:91], v[24:27], v[100:103]
    v_or_b32 v1, v40, v41
    v_xor_b32 v42, s32, v42
    v_mfma_f32_16x16x32_bf16 v[104:107], a[92:95], v[24:27], v[104:107]
    s_add_u32 s45, s40, 8192
    buffer_load_dwordx4 v[88:91], v252, s[12:15], s45 offen offset:0 sc1
    v_mfma_f32_16x16x32_bf16 v[108:111], a[96:99], v[24:27], v[108:111]
    v_xor_b32 v43, s32, v43
    v_or3_b32 v1, v42, v43, v1
    v_mfma_f32_16x16x32_bf16 v[112:115], a[80:83], v[28:31], v[112:115]
    v_mfma_f32_16x16x32_bf16 v[116:119], a[84:87], v[28:31], v[116:119]
    s_add_u32 s45, s40, 8192
    buffer_load_dwordx4 v[16:19], v252, s[12:15], s45 offen offset:1024 sc1
    v_mfma_f32_16x16x32_bf16 v[120:123], a[88:91], v[28:31], v[120:123]
    v_xor_b32 v44, s32, v44
    v_xor_b32 v45, s32, v45
    v_mfma_f32_16x16x32_bf16 v[124:127], a[92:95], v[28:31], v[124:127]
    v_or3_b32 v1, v44, v45, v1
    v_xor_b32 v46, s32, v46
    v_mfma_f32_16x16x32_bf16 v[128:131], a[96:99], v[28:31], v[128:131]
    buffer_load_dwordx4 v[20:23], v252, s[12:15], s41 offen offset:0 sc1
    v_mfma_f32_16x16x32_bf16 v[132:135], a[80:83], v[32:35], v[132:135]
    v_xor_b32 v47, s32, v47
    v_or3_b32 v1, v46, v47, v1
    v_mfma_f32_16x16x32_bf16 v[136:139], a[84:87], v[32:35], v[136:139]
    v_xor_b32 v48, s32, v48
    v_xor_b32 v49, s32, v49
    v_mfma_f32_16x16x32_bf16 v[140:143], a[88:91], v[32:35], v[140:143]
    buffer_load_dwordx4 v[24:27], v252, s[12:15], s41 offen offset:1024 sc1
    v_mfma_f32_16x16x32_bf16 v[144:147], a[92:95], v[32:35], v[144:147]
    v_or3_b32 v1, v48, v49, v1
    v_xor_b32 v50, s32, v50
    v_mfma_f32_16x16x32_bf16 v[148:151], a[96:99], v[32:35], v[148:151]
    v_xor_b32 v51, s32, v51
    v_or3_b32 v1, v50, v51, v1
    v_mfma_f32_16x16x32_bf16 v[152:155], a[80:83], v[36:39], v[152:155]
    buffer_load_dwordx4 v[28:31], v252, s[12:15], s41 offen offset:2048 sc1
    v_mfma_f32_16x16x32_bf16 v[156:159], a[84:87], v[36:39], v[156:159]
    v_xor_b32 v52, s32, v52
    v_xor_b32 v53, s32, v53
    v_mfma_f32_16x16x32_bf16 v[160:163], a[88:91], v[36:39], v[160:163]
    v_or3_b32 v1, v52, v53, v1
    v_xor_b32 v54, s32, v54
    v_mfma_f32_16x16x32_bf16 v[164:167], a[92:95], v[36:39], v[164:167]
    buffer_load_dwordx4 v[32:35], v252, s[12:15], s41 offen offset:3072 sc1
    v_mfma_f32_16x16x32_bf16 v[168:171], a[96:99], v[36:39], v[168:171]
    v_xor_b32 v55, s32, v55
    v_or3_b32 v1, v54, v55, v1
    v_and_b32 v1, 0x10001, v1
    v_cmp_ne_u32 vcc, 0, v1
    s_nop 1
    s_cbranch_vccnz va27
vad28:
    v_mfma_f32_16x16x32_bf16 v[92:95], a[180:183], v[40:43], v[92:95]
    s_add_u32 s45, s41, 4096
    buffer_load_dwordx4 v[36:39], v252, s[12:15], s45 offen offset:0 sc1
    v_mfma_f32_16x16x32_bf16 v[96:99], a[184:187], v[40:43], v[96:99]
    v_mfma_f32_16x16x32_bf16 v[100:103], a[188:191], v[40:43], v[100:103]
    v_mfma_f32_16x16x32_bf16 v[104:107], a[192:195], v[40:43], v[104:107]
    v_mfma_f32_16x16x32_bf16 v[108:111], a[196:199], v[40:43], v[108:111]
    v_mfma_f32_16x16x32_bf16 v[112:115], a[180:183], v[44:47], v[112:115]
    v_mfma_f32_16x16x32_bf16 v[116:119], a[184:187], v[44:47], v[116:119]
    s_add_u32 s45, s41, 4096
    buffer_load_dwordx4 v[40:43], v252, s[12:15], s45 offen offset:1024 sc1
    v_mfma_f32_16x16x32_bf16 v[120:123], a[188:191], v[44:47], v[120:123]
    v_mfma_f32_16x16x32_bf16 v[124:127], a[192:195], v[44:47], v[124:127]
    ds_write_b128 v5, v[92:95] offset:0
    v_mfma_f32_16x16x32_bf16 v[128:131], a[196:199], v[44:47], v[128:131]
    v_mfma_f32_16x16x32_bf16 v[132:135], a[180:183], v[48:51], v[132:135]
    ds_write_b128 v5, v[96:99] offset:64
    v_mfma_f32_16x16x32_bf16 v[136:139], a[184:187], v[48:51], v[136:139]
    v_mfma_f32_16x16x32_bf16 v[140:143], a[188:191], v[48:51], v[140:143]
    s_add_u32 s45, s41, 4096
    buffer_load_dwordx4 v[44:47], v252, s[12:15], s45 offen offset:2048 sc1
    v_mfma_f32_16x16x32_bf16 v[144:147], a[192:195], v[48:51], v[144:147]
    ds_write_b128 v5, v[100:103] offset:128
    v_mfma_f32_16x16x32_bf16 v[148:151], a[196:199], v[48:51], v[148:151]
    v_mfma_f32_16x16x32_bf16 v[152:155], a[180:183], v[52:55], v[152:155]
    s_add_u32 s45, s41, 4096
    buffer_load_dwordx4 v[48:51], v252, s[12:15], s45 offen offset:3072 sc1
    v_mfma_f32_16x16x32_bf16 v[156:159], a[184:187], v[52:55], v[156:159]
    ds_write_b128 v5, v[104:107] offset:192
    v_mfma_f32_16x16x32_bf16 v[160:163], a[188:191], v[52:55], v[160:163]
    v_mfma_f32_16x16x32_bf16 v[164:167], a[192:195], v[52:55], v[164:167]
    s_waitcnt lgkmcnt(9)
    ds_write_b128 v5, v[108:111] offset:256
    v_mfma_f32_16x16x32_bf16 v[168:171], a[196:199], v[52:55], v[168:171]
    s_waitcnt vmcnt(17)
    v_mfma_f32_16x16x32_bf16 v[172:175], a[0:3], v[56:59], 0
    s_add_u32 s45, s41, 8192
    buffer_load_dwordx4 v[52:55], v252, s[12:15], s45 offen offset:0 sc1
    v_mfma_f32_16x16x32_bf16 v[176:179], a[4:7], v[56:59], 0
    ds_write_b128 v5, v[112:115] offset:5376
    v_mfma_f32_16x16x32_bf16 v[180:183], a[8:11], v[56:59], 0
    v_mfma_f32_16x16x32_bf16 v[184:187], a[12:15], v[56:59], 0
    ds_write_b128 v5, v[116:119] offset:5440
    v_mfma_f32_16x16x32_bf16 v[188:191], a[16:19], v[56:59], 0
    s_waitcnt vmcnt(17)
    v_mfma_f32_16x16x32_bf16 v[172:175], a[20:23], v[60:63], v[172:175]
    s_add_u32 s45, s41, 8192
    buffer_load_dwordx4 v[56:59], v252, s[12:15], s45 offen offset:1024 sc1
    v_mfma_f32_16x16x32_bf16 v[176:179], a[24:27], v[60:63], v[176:179]
    ds_write_b128 v5, v[120:123] offset:5504
    v_mfma_f32_16x16x32_bf16 v[180:183], a[28:31], v[60:63], v[180:183]
    v_mfma_f32_16x16x32_bf16 v[184:187], a[32:35], v[60:63], v[184:187]
    ds_write_b128 v5, v[124:127] offset:5568
    v_mfma_f32_16x16x32_bf16 v[188:191], a[36:39], v[60:63], v[188:191]
    s_waitcnt vmcnt(17)
    v_mfma_f32_16x16x32_bf16 v[172:175], a[40:43], v[64:67], v[172:175]
    buffer_load_dwordx4 v[60:63], v252, s[12:15], s42 offen offset:0 sc1
    v_mfma_f32_16x16x32_bf16 v[176:179], a[44:47], v[64:67], v[176:179]
    s_waitcnt lgkmcnt(9)
    ds_write_b128 v5, v[128:131] offset:5632
    v_mfma_f32_16x16x32_bf16 v[180:183], a[48:51], v[64:67], v[180:183]
    v_mfma_f32_16x16x32_bf16 v[184:187], a[52:55], v[64:67], v[184:187]
    ds_write_b128 v5, v[132:135] offset:10752
    v_mfma_f32_16x16x32_bf16 v[188:191], a[56:59], v[64:67], v[188:191]
    s_waitcnt vmcnt(17)
    v_mfma_f32_16x16x32_bf16 v[172:175], a[60:63], v[68:71], v[172:175]
    buffer_load_dwordx4 v[64:67], v252, s[12:15], s42 offen offset:1024 sc1
    v_mfma_f32_16x16x32_bf16 v[176:179], a[64:67], v[68:71], v[176:179]
    ds_write_b128 v5, v[136:139] offset:10816
    v_mfma_f32_16x16x32_bf16 v[180:183], a[68:71], v[68:71], v[180:183]
    v_mfma_f32_16x16x32_bf16 v[184:187], a[72:75], v[68:71], v[184:187]
    ds_write_b128 v5, v[140:143] offset:10880
    v_mfma_f32_16x16x32_bf16 v[188:191], a[76:79], v[68:71], v[188:191]
    s_waitcnt vmcnt(17)
    v_mfma_f32_16x16x32_bf16 v[172:175], a[80:83], v[72:75], v[172:175]
    buffer_load_dwordx4 v[68:71], v252, s[12:15], s42 offen offset:2048 sc1
    v_mfma_f32_16x16x32_bf16 v[176:179], a[84:87], v[72:75], v[176:179]
    ds_write_b128 v5, v[144:147] offset:10944
    v_mfma_f32_16x16x32_bf16 v[180:183], a[88:91], v[72:75], v[180:183]
    v_mfma_f32_16x16x32_bf16 v[184:187], a[92:95], v[72:75], v[184:187]
    s_waitcnt lgkmcnt(9)
    ds_write_b128 v5, v[148:151] offset:11008
    v_mfma_f32_16x16x32_bf16 v[188:191], a[96:99], v[72:75], v[188:191]
    s_waitcnt vmcnt(17)
    v_mfma_f32_16x16x32_bf16 v[172:175], a[100:103], v[76:79], v[172:175]
    buffer_load_dwordx4 v[72:75], v252, s[12:15], s42 offen offset:3072 sc1
    v_mfma_f32_16x16x32_bf16 v[176:179], a[104:107], v[76:79], v[176:179]
    v_mfma_f32_16x16x32_bf16 v[180:183], a[108:111], v[76:79], v[180:183]
    ds_write_b128 v5, v[152:155] offset:16128
    v_mfma_f32_16x16x32_bf16 v[184:187], a[112:115], v[76:79], v[184:187]
    v_mfma_f32_16x16x32_bf16 v[188:191], a[116:119], v[76:79], v[188:191]
    ds_write_b128 v5, v[156:159] offset:16192
    s_waitcnt vmcnt(17)
    v_mfma_f32_16x16x32_bf16 v[172:175], a[120:123], v[80:83], v[172:175]
    s_add_u32 s45, s42, 4096
    buffer_load_dwordx4 v[76:79], v252, s[12:15], s45 offen offset:0 sc1
    v_mfma_f32_16x16x32_bf16 v[176:179], a[124:127], v[80:83], v[176:179]
    v_mfma_f32_16x16x32_bf16 v[180:183], a[128:131], v[80:83], v[180:183]
    ds_write_b128 v5, v[160:163] offset:16256
    v_mfma_f32_16x16x32_bf16 v[184:187], a[132:135], v[80:83], v[184:187]
    v_mfma_f32_16x16x32_bf16 v[188:191], a[136:139], v[80:83], v[188:191]
    ds_write_b128 v5, v[164:167] offset:16320
    s_waitcnt vmcnt(17)
    v_mfma_f32_16x16x32_bf16 v[172:175], a[140:143], v[84:87], v[172:175]
    s_add_u32 s45, s42, 4096
    buffer_load_dwordx4 v[80:83], v252, s[12:15], s45 offen offset:1024 sc1
    v_mfma_f32_16x16x32_bf16 v[176:179], a[144:147], v[84:87], v[176:179]
    v_mfma_f32_16x16x32_bf16 v[180:183], a[148:151], v[84:87], v[180:183]
    s_waitcnt lgkmcnt(9)
    ds_write_b128 v5, v[168:171] offset:16384
    v_mfma_f32_16x16x32_bf16 v[184:187], a[152:155], v[84:87], v[184:187]
    v_mfma_f32_16x16x32_bf16 v[188:191], a[156:159], v[84:87], v[188:191]
    s_waitcnt vmcnt(17)
    v_mfma_f32_16x16x32_bf16 v[172:175], a[160:163], v[88:91], v[172:175]
    s_add_u32 s45, s42, 4096
    buffer_load_dwordx4 v[84:87], v252, s[12:15], s45 offen offset:2048 sc1
    v_mfma_f32_16x16x32_bf16 v[176:179], a[164:167], v[88:91], v[176:179]
    v_mfma_f32_16x16x32_bf16 v[180:183], a[168:171], v[88:91], v[180:183]
    s_waitcnt lgkmcnt(0)
    s_barrier
    v_mfma_f32_16x16x32_bf16 v[184:187], a[172:175], v[88:91], v[184:187]
    ds_read_b128 v[92:95], v6 offset:0
    v_mfma_f32_16x16x32_bf16 v[188:191], a[176:179], v[88:91], v[188:191]
    ds_read_b128 v[96:99], v6 offset:21504
    s_waitcnt vmcnt(17)
    v_mfma_f32_16x16x32_bf16 v[172:175], a[180:183], v[16:19], v[172:175]
    s_add_u32 s45, s42, 4096
    buffer_load_dwordx4 v[88:91], v252, s[12:15], s45 offen offset:3072 sc1
    v_mfma_f32_16x16x32_bf16 v[176:179], a[184:187], v[16:19], v[176:179]
    ds_read_b128 v[100:103], v6 offset:43008
    v_mfma_f32_16x16x32_bf16 v[180:183], a[188:191], v[16:19], v[180:183]
    ds_read_b128 v[104:107], v6 offset:64512
    v_mfma_f32_16x16x32_bf16 v[184:187], a[192:195], v[16:19], v[184:187]
    ds_read_b128 v[108:111], v7 offset:0
    v_mfma_f32_16x16x32_bf16 v[188:191], a[196:199], v[16:19], v[188:191]
    ds_read_b128 v[112:115], v7 offset:21504
    s_waitcnt vmcnt(17)
    v_mfma_f32_16x16x32_bf16 v[192:195], a[0:3], v[20:23], 0
    s_add_u32 s45, s42, 8192
    buffer_load_dwordx4 v[16:19], v252, s[12:15], s45 offen offset:0 sc1
    v_mfma_f32_16x16x32_bf16 v[196:199], a[4:7], v[20:23], 0
    ds_read_b128 v[116:119], v7 offset:43008
    v_mfma_f32_16x16x32_bf16 v[200:203], a[8:11], v[20:23], 0
    ds_read_b128 v[120:123], v7 offset:64512
    v_mfma_f32_16x16x32_bf16 v[204:207], a[12:15], v[20:23], 0
    s_waitcnt lgkmcnt(4)
    ds_read_b128 v[124:127], v8 offset:0
    v_mfma_f32_16x16x32_bf16 v[208:211], a[16:19], v[20:23], 0
    v_add_f32 v92, v92, v96
    v_add_f32 v93, v93, v97
    s_waitcnt vmcnt(17)
    v_mfma_f32_16x16x32_bf16 v[192:195], a[20:23], v[24:27], v[192:195]
    s_add_u32 s45, s42, 8192
    buffer_load_dwordx4 v[20:23], v252, s[12:15], s45 offen offset:1024 sc1
    v_mfma_f32_16x16x32_bf16 v[196:199], a[24:27], v[24:27], v[196:199]
    v_add_f32 v94, v94, v98
    ds_read_b128 v[128:131], v8 offset:21504
    v_mfma_f32_16x16x32_bf16 v[200:203], a[28:31], v[24:27], v[200:203]
    v_add_f32 v95, v95, v99
    ds_read_b128 v[96:99], v254 offset:0
    v_mfma_f32_16x16x32_bf16 v[204:207], a[32:35], v[24:27], v[204:207]
    v_add_f32 v100, v100, v104
    ds_read_b128 v[132:135], v8 offset:43008
    v_mfma_f32_16x16x32_bf16 v[208:211], a[36:39], v[24:27], v[208:211]
    v_add_f32 v101, v101, v105
    v_add_f32 v102, v102, v106
    s_waitcnt vmcnt(17)
    v_mfma_f32_16x16x32_bf16 v[192:195], a[40:43], v[28:31], v[192:195]
    buffer_load_dwordx4 v[24:27], v252, s[12:15], s43 offen offset:0 sc1
    v_add_f32 v103, v103, v107
    v_mfma_f32_16x16x32_bf16 v[196:199], a[44:47], v[28:31], v[196:199]
    ds_read_b128 v[136:139], v8 offset:64512
    v_add_f32 v92, v92, v100
    v_mfma_f32_16x16x32_bf16 v[200:203], a[48:51], v[28:31], v[200:203]
    v_add_f32 v93, v93, v101
    v_add_f32 v94, v94, v102
    v_mfma_f32_16x16x32_bf16 v[204:207], a[52:55], v[28:31], v[204:207]
    v_add_f32 v95, v95, v103
    s_waitcnt lgkmcnt(5)
    v_mfma_f32_16x16x32_bf16 v[208:211], a[56:59], v[28:31], v[208:211]
    ds_read_b128 v[140:143], v9 offset:0
    v_add_f32 v108, v108, v112
    s_waitcnt vmcnt(17)
    v_mfma_f32_16x16x32_bf16 v[192:195], a[60:63], v[32:35], v[192:195]
    buffer_load_dwordx4 v[28:31], v252, s[12:15], s43 offen offset:1024 sc1
    v_add_f32 v109, v109, v113
    v_mfma_f32_16x16x32_bf16 v[196:199], a[64:67], v[32:35], v[196:199]
    v_add_f32 v110, v110, v114
    ds_read_b128 v[144:147], v9 offset:21504
    v_mfma_f32_16x16x32_bf16 v[200:203], a[68:71], v[32:35], v[200:203]
    v_add_f32 v111, v111, v115
    ds_read_b128 v[112:115], v254 offset:1024
    v_mfma_f32_16x16x32_bf16 v[204:207], a[72:75], v[32:35], v[204:207]
    v_add_f32 v116, v116, v120
    ds_read_b128 v[148:151], v9 offset:43008
    v_mfma_f32_16x16x32_bf16 v[208:211], a[76:79], v[32:35], v[208:211]
    v_add_f32 v117, v117, v121
    v_add_f32 v118, v118, v122
    s_waitcnt vmcnt(17)
    v_mfma_f32_16x16x32_bf16 v[192:195], a[80:83], v[36:39], v[192:195]
    buffer_load_dwordx4 v[32:35], v252, s[12:15], s43 offen offset:2048 sc1
    v_add_f32 v119, v119, v123
    v_mfma_f32_16x16x32_bf16 v[196:199], a[84:87], v[36:39], v[196:199]
    ds_read_b128 v[152:155], v9 offset:64512
    v_add_f32 v108, v108, v116
    v_mfma_f32_16x16x32_bf16 v[200:203], a[88:91], v[36:39], v[200:203]
    v_add_f32 v109, v109, v117
    v_add_f32 v110, v110, v118
    v_mfma_f32_16x16x32_bf16 v[204:207], a[92:95], v[36:39], v[204:207]
    v_add_f32 v111, v111, v119
    s_waitcnt lgkmcnt(7)
    v_mfma_f32_16x16x32_bf16 v[208:211], a[96:99], v[36:39], v[208:211]
    v_add_f32 v92, v92, v96
    v_add_f32 v93, v93, v97
    s_waitcnt vmcnt(17)
    v_mfma_f32_16x16x32_bf16 v[192:195], a[100:103], v[40:43], v[192:195]
    buffer_load_dwordx4 v[36:39], v252, s[12:15], s43 offen offset:3072 sc1
    v_add_f32 v94, v94, v98
    v_mfma_f32_16x16x32_bf16 v[196:199], a[104:107], v[40:43], v[196:199]
    v_add_f32 v95, v95, v99
    v_and_or_b32 v92, v92, s83, v3
    v_mfma_f32_16x16x32_bf16 v[200:203], a[108:111], v[40:43], v[200:203]
    v_and_or_b32 v93, v93, s83, v3
    v_and_or_b32 v94, v94, s83, v3
    v_mfma_f32_16x16x32_bf16 v[204:207], a[112:115], v[40:43], v[204:207]
    v_and_or_b32 v95, v95, s83, v3
    buffer_store_dwordx4 v[92:95], v252, s[12:15], s96 offen offset:0 sc1
    v_mfma_f32_16x16x32_bf16 v[208:211], a[116:119], v[40:43], v[208:211]
    s_waitcnt lgkmcnt(5)
    ds_read_b128 v[156:159], v10 offset:0
    s_waitcnt vmcnt(18)
    v_mfma_f32_16x16x32_bf16 v[192:195], a[120:123], v[44:47], v[192:195]
    s_add_u32 s45, s43, 4096
    buffer_load_dwordx4 v[40:43], v252, s[12:15], s45 offen offset:0 sc1
    v_mfma_f32_16x16x32_bf16 v[196:199], a[124:127], v[44:47], v[196:199]
    v_add_f32 v124, v124, v128
    v_add_f32 v125, v125, v129
    v_mfma_f32_16x16x32_bf16 v[200:203], a[128:131], v[44:47], v[200:203]
    v_add_f32 v126, v126, v130
    ds_read_b128 v[160:163], v10 offset:21504
    v_mfma_f32_16x16x32_bf16 v[204:207], a[132:135], v[44:47], v[204:207]
    v_add_f32 v127, v127, v131
    ds_read_b128 v[128:131], v254 offset:2048
    v_mfma_f32_16x16x32_bf16 v[208:211], a[136:139], v[44:47], v[208:211]
    v_add_f32 v132, v132, v136
    ds_read_b128 v[164:167], v10 offset:43008
    s_waitcnt vmcnt(18)
    v_mfma_f32_16x16x32_bf16 v[192:195], a[140:143], v[48:51], v[192:195]
    s_add_u32 s45, s43, 4096
    buffer_load_dwordx4 v[44:47], v252, s[12:15], s45 offen offset:1024 sc1
    v_mfma_f32_16x16x32_bf16 v[196:199], a[144:147], v[48:51], v[196:199]
    v_add_f32 v133, v133, v137
    v_add_f32 v134, v134, v138
    v_mfma_f32_16x16x32_bf16 v[200:203], a[148:151], v[48:51], v[200:203]
    v_add_f32 v135, v135, v139
    ds_read_b128 v[168:171], v10 offset:64512
    v_mfma_f32_16x16x32_bf16 v[204:207], a[152:155], v[48:51], v[204:207]
    v_add_f32 v124, v124, v132
    v_add_f32 v125, v125, v133
    v_mfma_f32_16x16x32_bf16 v[208:211], a[156:159], v[48:51], v[208:211]
    v_add_f32 v126, v126, v134
    v_add_f32 v127, v127, v135
    s_waitcnt vmcnt(18)
    v_mfma_f32_16x16x32_bf16 v[192:195], a[160:163], v[52:55], v[192:195]
    s_add_u32 s45, s43, 4096
    buffer_load_dwordx4 v[48:51], v252, s[12:15], s45 offen offset:2048 sc1
    v_mfma_f32_16x16x32_bf16 v[196:199], a[164:167], v[52:55], v[196:199]
    s_waitcnt lgkmcnt(7)
    v_add_f32 v108, v108, v112
    v_mfma_f32_16x16x32_bf16 v[200:203], a[168:171], v[52:55], v[200:203]
    v_add_f32 v109, v109, v113
    v_add_f32 v110, v110, v114
    v_mfma_f32_16x16x32_bf16 v[204:207], a[172:175], v[52:55], v[204:207]
    v_add_f32 v111, v111, v115
    v_and_or_b32 v108, v108, s83, v3
    v_mfma_f32_16x16x32_bf16 v[208:211], a[176:179], v[52:55], v[208:211]
    v_and_or_b32 v109, v109, s83, v3
    v_and_or_b32 v110, v110, s83, v3
    s_waitcnt vmcnt(18)
    v_mfma_f32_16x16x32_bf16 v[192:195], a[180:183], v[56:59], v[192:195]
    s_add_u32 s45, s43, 4096
    buffer_load_dwordx4 v[52:55], v252, s[12:15], s45 offen offset:3072 sc1
    v_mfma_f32_16x16x32_bf16 v[196:199], a[184:187], v[56:59], v[196:199]
    v_and_or_b32 v111, v111, s83, v3
    buffer_store_dwordx4 v[108:111], v252, s[12:15], s96 offen offset:1024 sc1
    v_mfma_f32_16x16x32_bf16 v[200:203], a[188:191], v[56:59], v[200:203]
    s_waitcnt lgkmcnt(5)
    v_add_f32 v140, v140, v144
    v_mfma_f32_16x16x32_bf16 v[204:207], a[192:195], v[56:59], v[204:207]
    v_add_f32 v141, v141, v145
    v_add_f32 v142, v142, v146
    v_mfma_f32_16x16x32_bf16 v[208:211], a[196:199], v[56:59], v[208:211]
    v_add_f32 v143, v143, v147
    ds_read_b128 v[144:147], v254 offset:3072
    s_waitcnt vmcnt(19)
    v_mfma_f32_16x16x32_bf16 v[212:215], a[0:3], v[60:63], 0
    s_add_u32 s45, s43, 8192
    buffer_load_dwordx4 v[56:59], v252, s[12:15], s45 offen offset:0 sc1
    v_mfma_f32_16x16x32_bf16 v[216:219], a[4:7], v[60:63], 0
    v_add_f32 v148, v148, v152
    v_add_f32 v149, v149, v153
    v_mfma_f32_16x16x32_bf16 v[220:223], a[8:11], v[60:63], 0
    v_add_f32 v150, v150, v154
    v_add_f32 v151, v151, v155
    v_mfma_f32_16x16x32_bf16 v[224:227], a[12:15], v[60:63], 0
    v_add_f32 v140, v140, v148
    v_add_f32 v141, v141, v149
    v_mfma_f32_16x16x32_bf16 v[228:231], a[16:19], v[60:63], 0
    v_add_f32 v142, v142, v150
    v_add_f32 v143, v143, v151
    s_waitcnt vmcnt(19)
    v_mfma_f32_16x16x32_bf16 v[212:215], a[20:23], v[64:67], v[212:215]
    s_add_u32 s45, s43, 8192
    buffer_load_dwordx4 v[60:63], v252, s[12:15], s45 offen offset:1024 sc1
    v_mfma_f32_16x16x32_bf16 v[216:219], a[24:27], v[64:67], v[216:219]
    s_waitcnt lgkmcnt(3)
    v_add_f32 v124, v124, v128
    v_mfma_f32_16x16x32_bf16 v[220:223], a[28:31], v[64:67], v[220:223]
    v_add_f32 v125, v125, v129
    v_add_f32 v126, v126, v130
    v_mfma_f32_16x16x32_bf16 v[224:227], a[32:35], v[64:67], v[224:227]
    v_add_f32 v127, v127, v131
    v_and_or_b32 v124, v124, s83, v3
    v_mfma_f32_16x16x32_bf16 v[228:231], a[36:39], v[64:67], v[228:231]
    v_and_or_b32 v125, v125, s83, v3
    v_and_or_b32 v126, v126, s83, v3
    s_waitcnt vmcnt(19)
    v_mfma_f32_16x16x32_bf16 v[212:215], a[40:43], v[68:71], v[212:215]
    v_and_or_b32 v127, v127, s83, v3
    buffer_store_dwordx4 v[124:127], v252, s[12:15], s96 offen offset:2048 sc1
    v_mfma_f32_16x16x32_bf16 v[216:219], a[44:47], v[68:71], v[216:219]
    s_waitcnt lgkmcnt(1)
    v_add_f32 v156, v156, v160
    v_mfma_f32_16x16x32_bf16 v[220:223], a[48:51], v[68:71], v[220:223]
    v_add_f32 v157, v157, v161
    v_add_f32 v158, v158, v162
    v_mfma_f32_16x16x32_bf16 v[224:227], a[52:55], v[68:71], v[224:227]
    v_add_f32 v159, v159, v163
    ds_read_b128 v[160:163], v254 offset:4096
    v_mfma_f32_16x16x32_bf16 v[228:231], a[56:59], v[68:71], v[228:231]
    v_add_f32 v164, v164, v168
    v_add_f32 v165, v165, v169
    s_waitcnt vmcnt(19)
    v_mfma_f32_16x16x32_bf16 v[212:215], a[60:63], v[72:75], v[212:215]
    v_add_f32 v166, v166, v170
    v_add_f32 v167, v167, v171
    v_mfma_f32_16x16x32_bf16 v[216:219], a[64:67], v[72:75], v[216:219]
    v_add_f32 v156, v156, v164
    v_add_f32 v157, v157, v165
    v_mfma_f32_16x16x32_bf16 v[220:223], a[68:71], v[72:75], v[220:223]
    v_add_f32 v158, v158, v166
    v_add_f32 v159, v159, v167
    v_mfma_f32_16x16x32_bf16 v[224:227], a[72:75], v[72:75], v[224:227]
    s_waitcnt lgkmcnt(1)
    v_add_f32 v140, v140, v144
    v_mfma_f32_16x16x32_bf16 v[228:231], a[76:79], v[72:75], v[228:231]
    v_add_f32 v141, v141, v145
    v_add_f32 v142, v142, v146
    s_waitcnt vmcnt(18)
    v_mfma_f32_16x16x32_bf16 v[212:215], a[80:83], v[76:79], v[212:215]
    v_add_f32 v143, v143, v147
    v_and_or_b32 v140, v140, s83, v3
    v_mfma_f32_16x16x32_bf16 v[216:219], a[84:87], v[76:79], v[216:219]
    v_and_or_b32 v141, v141, s83, v3
    v_and_or_b32 v142, v142, s83, v3
    v_mfma_f32_16x16x32_bf16 v[220:223], a[88:91], v[76:79], v[220:223]
    v_and_or_b32 v143, v143, s83, v3
    buffer_store_dwordx4 v[140:143], v252, s[12:15], s96 offen offset:3072 sc1
    v_mfma_f32_16x16x32_bf16 v[224:227], a[92:95], v[76:79], v[224:227]
    s_waitcnt lgkmcnt(0)
    v_add_f32 v156, v156, v160
    v_mfma_f32_16x16x32_bf16 v[228:231], a[96:99], v[76:79], v[228:231]
    v_add_f32 v157, v157, v161
    v_add_f32 v158, v158, v162
    s_waitcnt vmcnt(18)
    v_mfma_f32_16x16x32_bf16 v[212:215], a[100:103], v[80:83], v[212:215]
    v_add_f32 v159, v159, v163
    v_and_or_b32 v156, v156, s83, v3
    v_mfma_f32_16x16x32_bf16 v[216:219], a[104:107], v[80:83], v[216:219]
    v_and_or_b32 v157, v157, s83, v3
    v_and_or_b32 v158, v158, s83, v3
    v_mfma_f32_16x16x32_bf16 v[220:223], a[108:111], v[80:83], v[220:223]
    v_and_or_b32 v159, v159, s83, v3
    buffer_store_dwordx4 v[156:159], v252, s[12:15], s97 offen offset:0 sc1
    v_mfma_f32_16x16x32_bf16 v[224:227], a[112:115], v[80:83], v[224:227]
    s_barrier
    v_mfma_f32_16x16x32_bf16 v[228:231], a[116:119], v[80:83], v[228:231]
    ds_write_b128 v5, v[172:175] offset:0
    s_waitcnt vmcnt(18)
    v_mfma_f32_16x16x32_bf16 v[212:215], a[120:123], v[84:87], v[212:215]
    v_mfma_f32_16x16x32_bf16 v[216:219], a[124:127], v[84:87], v[216:219]
    ds_write_b128 v5, v[176:179] offset:64
    v_mfma_f32_16x16x32_bf16 v[220:223], a[128:131], v[84:87], v[220:223]
    v_mfma_f32_16x16x32_bf16 v[224:227], a[132:135], v[84:87], v[224:227]
    ds_write_b128 v5, v[180:183] offset:128
    v_mfma_f32_16x16x32_bf16 v[228:231], a[136:139], v[84:87], v[228:231]
    s_waitcnt vmcnt(17)
    v_mfma_f32_16x16x32_bf16 v[212:215], a[140:143], v[88:91], v[212:215]
    ds_write_b128 v5, v[184:187] offset:192
    v_mfma_f32_16x16x32_bf16 v[216:219], a[144:147], v[88:91], v[216:219]
    v_mfma_f32_16x16x32_bf16 v[220:223], a[148:151], v[88:91], v[220:223]
    ds_write_b128 v5, v[188:191] offset:256
    v_mfma_f32_16x16x32_bf16 v[224:227], a[152:155], v[88:91], v[224:227]
    v_mfma_f32_16x16x32_bf16 v[228:231], a[156:159], v[88:91], v[228:231]
    ds_write_b128 v5, v[192:195] offset:5376
    s_waitcnt vmcnt(16)
    v_mfma_f32_16x16x32_bf16 v[212:215], a[160:163], v[16:19], v[212:215]
    v_mfma_f32_16x16x32_bf16 v[216:219], a[164:167], v[16:19], v[216:219]
    ds_write_b128 v5, v[196:199] offset:5440
    v_mfma_f32_16x16x32_bf16 v[220:223], a[168:171], v[16:19], v[220:223]
    v_mfma_f32_16x16x32_bf16 v[224:227], a[172:175], v[16:19], v[224:227]
    ds_write_b128 v5, v[200:203] offset:5504
    v_mfma_f32_16x16x32_bf16 v[228:231], a[176:179], v[16:19], v[228:231]
    s_waitcnt vmcnt(15)
    v_mfma_f32_16x16x32_bf16 v[212:215], a[180:183], v[20:23], v[212:215]
    ds_write_b128 v5, v[204:207] offset:5568
    v_mfma_f32_16x16x32_bf16 v[216:219], a[184:187], v[20:23], v[216:219]
    v_mfma_f32_16x16x32_bf16 v[220:223], a[188:191], v[20:23], v[220:223]
    ds_write_b128 v5, v[208:211] offset:5632
    v_mfma_f32_16x16x32_bf16 v[224:227], a[192:195], v[20:23], v[224:227]
    v_mfma_f32_16x16x32_bf16 v[228:231], a[196:199], v[20:23], v[228:231]
    s_waitcnt vmcnt(14)
    v_mfma_f32_16x16x32_bf16 v[232:235], a[0:3], v[24:27], 0
    v_mfma_f32_16x16x32_bf16 v[236:239], a[4:7], v[24:27], 0
    v_mfma_f32_16x16x32_bf16 v[240:243], a[8:11], v[24:27], 0
    v_mfma_f32_16x16x32_bf16 v[244:247], a[12:15], v[24:27], 0
    v_mfma_f32_16x16x32_bf16 v[248:251], a[16:19], v[24:27], 0
    s_waitcnt vmcnt(13)
    v_mfma_f32_16x16x32_bf16 v[232:235], a[20:23], v[28:31], v[232:235]
    ds_write_b128 v5, v[212:215] offset:10752
    v_mfma_f32_16x16x32_bf16 v[236:239], a[24:27], v[28:31], v[236:239]
    v_mfma_f32_16x16x32_bf16 v[240:243], a[28:31], v[28:31], v[240:243]
    ds_write_b128 v5, v[216:219] offset:10816
    v_mfma_f32_16x16x32_bf16 v[244:247], a[32:35], v[28:31], v[244:247]
    v_mfma_f32_16x16x32_bf16 v[248:251], a[36:39], v[28:31], v[248:251]
    ds_write_b128 v5, v[220:223] offset:10880
    s_waitcnt vmcnt(12)
    v_mfma_f32_16x16x32_bf16 v[232:235], a[40:43], v[32:35], v[232:235]
    v_mfma_f32_16x16x32_bf16 v[236:239], a[44:47], v[32:35], v[236:239]
    ds_write_b128 v5, v[224:227] offset:10944
    v_mfma_f32_16x16x32_bf16 v[240:243], a[48:51], v[32:35], v[240:243]
    v_mfma_f32_16x16x32_bf16 v[244:247], a[52:55], v[32:35], v[244:247]
    s_waitcnt lgkmcnt(9)
    ds_write_b128 v5, v[228:231] offset:11008
    v_mfma_f32_16x16x32_bf16 v[248:251], a[56:59], v[32:35], v[248:251]
    s_waitcnt vmcnt(11)
    v_mfma_f32_16x16x32_bf16 v[232:235], a[60:63], v[36:39], v[232:235]
    v_mfma_f32_16x16x32_bf16 v[236:239], a[64:67], v[36:39], v[236:239]
    v_mfma_f32_16x16x32_bf16 v[240:243], a[68:71], v[36:39], v[240:243]
    v_mfma_f32_16x16x32_bf16 v[244:247], a[72:75], v[36:39], v[244:247]
    v_mfma_f32_16x16x32_bf16 v[248:251], a[76:79], v[36:39], v[248:251]
    s_waitcnt vmcnt(9)
    v_mfma_f32_16x16x32_bf16 v[232:235], a[80:83], v[40:43], v[232:235]
    v_mfma_f32_16x16x32_bf16 v[236:239], a[84:87], v[40:43], v[236:239]
    v_mfma_f32_16x16x32_bf16 v[240:243], a[88:91], v[40:43], v[240:243]
    v_mfma_f32_16x16x32_bf16 v[244:247], a[92:95], v[40:43], v[244:247]
    v_mfma_f32_16x16x32_bf16 v[248:251], a[96:99], v[40:43], v[248:251]
    s_cmp_eq_u32 s33, 0
    s_cbranch_scc1 L_ep0
L_ep1:
    s_waitcnt vmcnt(8)
    v_mfma_f32_16x16x32_bf16 v[232:235], a[100:103], v[44:47], v[232:235]
    v_mfma_f32_16x16x32_bf16 v[236:239], a[104:107], v[44:47], v[236:239]
    v_mfma_f32_16x16x32_bf16 v[240:243], a[108:111], v[44:47], v[240:243]
    v_mfma_f32_16x16x32_bf16 v[244:247], a[112:115], v[44:47], v[244:247]
    v_mfma_f32_16x16x32_bf16 v[248:251], a[116:119], v[44:47], v[248:251]
    s_waitcnt vmcnt(7)
    v_mfma_f32_16x16x32_bf16 v[232:235], a[120:123], v[48:51], v[232:235]
    v_mfma_f32_16x16x32_bf16 v[236:239], a[124:127], v[48:51], v[236:239]
    v_mfma_f32_16x16x32_bf16 v[240:243], a[128:131], v[48:51], v[240:243]
    v_mfma_f32_16x16x32_bf16 v[244:247], a[132:135], v[48:51], v[244:247]
    v_mfma_f32_16x16x32_bf16 v[248:251], a[136:139], v[48:51], v[248:251]
    s_waitcnt vmcnt(6)
    v_mfma_f32_16x16x32_bf16 v[232:235], a[140:143], v[52:55], v[232:235]
    v_mfma_f32_16x16x32_bf16 v[236:239], a[144:147], v[52:55], v[236:239]
    v_mfma_f32_16x16x32_bf16 v[240:243], a[148:151], v[52:55], v[240:243]
    v_mfma_f32_16x16x32_bf16 v[244:247], a[152:155], v[52:55], v[244:247]
    v_mfma_f32_16x16x32_bf16 v[248:251], a[156:159], v[52:55], v[248:251]
    buffer_load_dwordx4 v[104:107], v252, s[12:15], s88 offen offset:0 sc1
    buffer_load_dwordx4 v[120:123], v252, s[12:15], s88 offen offset:1024 sc1
    buffer_load_dwordx4 v[136:139], v252, s[12:15], s88 offen offset:2048 sc1
    buffer_load_dwordx4 v[152:155], v252, s[12:15], s88 offen offset:3072 sc1
    buffer_load_dwordx4 v[168:171], v252, s[12:15], s89 offen offset:0 sc1
    s_waitcnt vmcnt(9)
    v_mfma_f32_16x16x32_bf16 v[232:235], a[160:163], v[56:59], v[232:235]
    v_mfma_f32_16x16x32_bf16 v[236:239], a[164:167], v[56:59], v[236:239]
    v_mfma_f32_16x16x32_bf16 v[240:243], a[168:171], v[56:59], v[240:243]
    v_mfma_f32_16x16x32_bf16 v[244:247], a[172:175], v[56:59], v[244:247]
    v_mfma_f32_16x16x32_bf16 v[248:251], a[176:179], v[56:59], v[248:251]
    s_waitcnt vmcnt(8)
    v_mfma_f32_16x16x32_bf16 v[232:235], a[180:183], v[60:63], v[232:235]
    v_mfma_f32_16x16x32_bf16 v[236:239], a[184:187], v[60:63], v[236:239]
    v_mfma_f32_16x16x32_bf16 v[240:243], a[188:191], v[60:63], v[240:243]
    v_mfma_f32_16x16x32_bf16 v[244:247], a[192:195], v[60:63], v[244:247]
    v_mfma_f32_16x16x32_bf16 v[248:251], a[196:199], v[60:63], v[248:251]
    ds_read_b128 v[96:99], v254 offset:20480
    ds_read_b128 v[112:115], v254 offset:21504
    ds_read_b128 v[128:131], v254 offset:22528
    ds_read_b128 v[144:147], v254 offset:23552
    s_waitcnt lgkmcnt(9)
    ds_read_b128 v[160:163], v254 offset:24576
    ds_write_b128 v5, v[232:235] offset:16128
    ds_write_b128 v5, v[236:239] offset:16192
    ds_write_b128 v5, v[240:243] offset:16256
    ds_write_b128 v5, v[244:247] offset:16320
    s_waitcnt lgkmcnt(9)
    ds_write_b128 v5, v[248:251] offset:16384
    s_waitcnt lgkmcnt(0)
    s_barrier
    ds_read_b128 v[172:175], v6 offset:0
    ds_read_b128 v[176:179], v6 offset:21504
    ds_read_b128 v[180:183], v6 offset:43008
    ds_read_b128 v[184:187], v6 offset:64512
    ds_read_b128 v[188:191], v7 offset:0
    ds_read_b128 v[192:195], v7 offset:21504
    ds_read_b128 v[196:199], v7 offset:43008
    ds_read_b128 v[200:203], v7 offset:64512
    ds_read_b128 v[204:207], v8 offset:0
    ds_read_b128 v[208:211], v8 offset:21504
    ds_read_b128 v[212:215], v8 offset:43008
    ds_read_b128 v[216:219], v8 offset:64512
    ds_read_b128 v[220:223], v9 offset:0
    ds_read_b128 v[224:227], v9 offset:21504
    s_waitcnt lgkmcnt(9)
    ds_read_b128 v[228:231], v9 offset:43008
    ds_read_b128 v[232:235], v9 offset:64512
    ds_read_b128 v[236:239], v10 offset:0
    ds_read_b128 v[240:243], v10 offset:21504
    ds_read_b128 v[244:247], v10 offset:43008
    s_waitcnt lgkmcnt(9)
    ds_read_b128 v[248:251], v10 offset:64512
    s_waitcnt vmcnt(0)
    v_xor_b32 v104, s82, v104
    v_xor_b32 v105, s82, v105
    v_or_b32 v1, v104, v105
    v_xor_b32 v106, s82, v106
    v_xor_b32 v107, s82, v107
    v_or3_b32 v1, v106, v107, v1
    v_xor_b32 v120, s82, v120
    v_xor_b32 v121, s82, v121
    v_or3_b32 v1, v120, v121, v1
    v_xor_b32 v122, s82, v122
    v_xor_b32 v123, s82, v123
    v_or3_b32 v1, v122, v123, v1
    v_xor_b32 v136, s82, v136
    v_xor_b32 v137, s82, v137
    v_or3_b32 v1, v136, v137, v1
    v_xor_b32 v138, s82, v138
    v_xor_b32 v139, s82, v139
    v_or3_b32 v1, v138, v139, v1
    v_xor_b32 v152, s82, v152
    v_xor_b32 v153, s82, v153
    v_or3_b32 v1, v152, v153, v1
    v_xor_b32 v154, s82, v154
    v_xor_b32 v155, s82, v155
    v_or3_b32 v1, v154, v155, v1
    v_xor_b32 v168, s82, v168
    v_xor_b32 v169, s82, v169
    v_or3_b32 v1, v168, v169, v1
    v_xor_b32 v170, s82, v170
    v_xor_b32 v171, s82, v171
    v_or3_b32 v1, v170, v171, v1
    v_and_b32 v1, 3, v1
    v_cmp_ne_u32 vcc, 0, v1
    s_nop 1
    s_cbranch_vccnz pp29
ppd30:
    v_pk_add_f32 v[104:105], v[104:105], v[96:97]
    v_pk_add_f32 v[106:107], v[106:107], v[98:99]
    v_pk_add_f32 v[120:121], v[120:121], v[112:113]
    v_pk_add_f32 v[122:123], v[122:123], v[114:115]
    v_pk_add_f32 v[136:137], v[136:137], v[128:129]
    v_pk_add_f32 v[138:139], v[138:139], v[130:131]
    v_pk_add_f32 v[152:153], v[152:153], v[144:145]
    v_pk_add_f32 v[154:155], v[154:155], v[146:147]
    v_pk_add_f32 v[168:169], v[168:169], v[160:161]
    v_pk_add_f32 v[170:171], v[170:171], v[162:163]
    v_pk_add_f32 v[172:173], v[172:173], v[176:177]
    v_pk_add_f32 v[180:181], v[180:181], v[184:185]
    v_pk_add_f32 v[174:175], v[174:175], v[178:179]
    v_pk_add_f32 v[182:183], v[182:183], v[186:187]
    v_pk_add_f32 v[172:173], v[172:173], v[104:105]
    v_pk_add_f32 v[174:175], v[174:175], v[106:107]
    v_pk_add_f32 v[172:173], v[172:173], v[180:181]
    v_pk_add_f32 v[174:175], v[174:175], v[182:183]
    buffer_store_dwordx4 v[172:175], v11, s[16:19], s35 offen sc1
    v_pk_add_f32 v[188:189], v[188:189], v[192:193]
    v_pk_add_f32 v[196:197], v[196:197], v[200:201]
    v_pk_add_f32 v[190:191], v[190:191], v[194:195]
    v_pk_add_f32 v[198:199], v[198:199], v[202:203]
    v_pk_add_f32 v[188:189], v[188:189], v[120:121]
    v_pk_add_f32 v[190:191], v[190:191], v[122:123]
    v_pk_add_f32 v[188:189], v[188:189], v[196:197]
    v_pk_add_f32 v[190:191], v[190:191], v[198:199]
    buffer_store_dwordx4 v[188:191], v12, s[16:19], s35 offen sc1
    s_waitcnt lgkmcnt(8)
    v_pk_add_f32 v[204:205], v[204:205], v[208:209]
    v_pk_add_f32 v[212:213], v[212:213], v[216:217]
    v_pk_add_f32 v[206:207], v[206:207], v[210:211]
    v_pk_add_f32 v[214:215], v[214:215], v[218:219]
    v_pk_add_f32 v[204:205], v[204:205], v[136:137]
    v_pk_add_f32 v[206:207], v[206:207], v[138:139]
    v_pk_add_f32 v[204:205], v[204:205], v[212:213]
    v_pk_add_f32 v[206:207], v[206:207], v[214:215]
    buffer_store_dwordx4 v[204:207], v13, s[16:19], s35 offen sc1
    s_waitcnt lgkmcnt(4)
    v_pk_add_f32 v[220:221], v[220:221], v[224:225]
    v_pk_add_f32 v[228:229], v[228:229], v[232:233]
    v_pk_add_f32 v[222:223], v[222:223], v[226:227]
    v_pk_add_f32 v[230:231], v[230:231], v[234:235]
    v_pk_add_f32 v[220:221], v[220:221], v[152:153]
    v_pk_add_f32 v[222:223], v[222:223], v[154:155]
    v_pk_add_f32 v[220:221], v[220:221], v[228:229]
    v_pk_add_f32 v[222:223], v[222:223], v[230:231]
    buffer_store_dwordx4 v[220:223], v14, s[16:19], s35 offen sc1
    s_waitcnt lgkmcnt(0)
    v_pk_add_f32 v[236:237], v[236:237], v[240:241]
    v_pk_add_f32 v[244:245], v[244:245], v[248:249]
    v_pk_add_f32 v[238:239], v[238:239], v[242:243]
    v_pk_add_f32 v[246:247], v[246:247], v[250:251]
    v_pk_add_f32 v[236:237], v[236:237], v[168:169]
    v_pk_add_f32 v[238:239], v[238:239], v[170:171]
    v_pk_add_f32 v[236:237], v[236:237], v[244:245]
    v_pk_add_f32 v[238:239], v[238:239], v[246:247]
    buffer_store_dwordx4 v[236:239], v15, s[16:19], s35 offen sc1
    s_cmp_lg_u32 s33, 0
    s_cbranch_scc1 L_fin0
    v_xor_b32 v14, s28, v64
    v_bitop3_b32 v14, s28, v65, v14 bitop3:0xbe
    v_bitop3_b32 v14, s28, v66, v14 bitop3:0xbe
    v_bitop3_b32 v14, s28, v67, v14 bitop3:0xbe
    v_cmp_ne_u32 vcc, 0, v14
    s_nop 1
    s_cbranch_vccnz pe31
ped32:
    s_mov_b32 s48, 0
    v_mov_b32 v14, s28
    s_mov_b64 exec, 1
    buffer_store_dword v14, off, s[12:15], s48 offset:0 sc1
    s_mov_b64 exec, -1
L_fin0:
    s_endpgm
L_ep0:
    v_lshlrev_b32 v68, 8, v0
    s_mov_b32 s49, 69632
    buffer_load_dword v64, v68, s[12:15], s49 offen sc1
    s_mov_b32 s49, 86016
    buffer_load_dword v65, v68, s[12:15], s49 offen sc1
    s_mov_b32 s49, 102400
    buffer_load_dword v66, v68, s[12:15], s49 offen sc1
    s_mov_b32 s49, 118784
    buffer_load_dword v67, v68, s[12:15], s49 offen sc1
    s_branch L_ep1
pg1:
    s_mov_b32 s63, 100000
pg1t33:
    buffer_load_dwordx4 v[192:195], v216, s[12:15], s57 offen sc1
    buffer_load_dwordx2 v[196:197], v217, s[12:15], s56 offen sc1
    s_waitcnt vmcnt(0)
    v_xor_b32 v15, s28, v193
    v_bitop3_b32 v15, s29, v195, v15 bitop3:0xbe
    v_bitop3_b32 v15, s28, v197, v15 bitop3:0xbe
    v_cmp_ne_u32 vcc, 0, v15
    s_nop 1
    s_cbranch_vccz pgd2
    s_sub_u32 s63, s63, 1
    s_cmp_lg_u32 s63, 0
    s_cbranch_scc1 pg1t33
    s_branch pgd2
pb3:
    s_mov_b32 s63, 100000
pb3t34:
    buffer_load_dword v254, v253, s[12:15], s60 offen sc1
    s_waitcnt vmcnt(0)
    v_cmp_ne_u32 vcc, s28, v254
    s_nop 1
    s_cbranch_vccz pbd4
    s_sub_u32 s63, s63, 1
    s_cmp_lg_u32 s63, 0
    s_cbranch_scc1 pb3t34
    s_branch pbd4
pc5:
    s_mov_b32 s63, 100000
pc5t35:
    buffer_load_dwordx4 v[96:99], v6, s[12:15], s52 offen offset:0 sc1
    buffer_load_dwordx4 v[100:103], v6, s[12:15], s52 offen offset:1280 sc1
    buffer_load_dwordx4 v[104:107], v6, s[12:15], s52 offen offset:2560 sc1
    buffer_load_dwordx4 v[108:111], v6, s[12:15], s53 offen offset:0 sc1
    buffer_load_dwordx4 v[112:115], v6, s[12:15], s53 offen offset:1280 sc1
    s_waitcnt vmcnt(0)
    v_xor_b32 v10, s28, v97
    v_bitop3_b32 v10, s29, v99, v10 bitop3:0xbe
    v_cmp_ne_u32 s[50:51], 0, v10
    s_nop 0
    s_and_b64 vcc, s[50:51], s[68:69]
    v_xor_b32 v10, s28, v101
    v_bitop3_b32 v10, s29, v103, v10 bitop3:0xbe
    v_cmp_ne_u32 s[50:51], 0, v10
    s_nop 0
    s_and_b64 s[50:51], s[50:51], s[70:71]
    s_or_b64 vcc, vcc, s[50:51]
    v_xor_b32 v10, s28, v105
    v_bitop3_b32 v10, s29, v107, v10 bitop3:0xbe
    v_cmp_ne_u32 s[50:51], 0, v10
    s_nop 0
    s_and_b64 s[50:51], s[50:51], s[72:73]
    s_or_b64 vcc, vcc, s[50:51]
    v_xor_b32 v10, s28, v109
    v_bitop3_b32 v10, s29, v111, v10 bitop3:0xbe
    v_cmp_ne_u32 s[50:51], 0, v10
    s_nop 0
    s_and_b64 s[50:51], s[50:51], s[74:75]
    s_or_b64 vcc, vcc, s[50:51]
    v_xor_b32 v10, s28, v113
    v_bitop3_b32 v10, s29, v115, v10 bitop3:0xbe
    v_cmp_ne_u32 s[50:51], 0, v10
    s_nop 0
    s_and_b64 s[50:51], s[50:51], s[76:77]
    s_or_b64 vcc, vcc, s[50:51]
    s_cbranch_vccz pcd6
    s_sub_u32 s63, s63, 1
    s_cmp_lg_u32 s63, 0
    s_cbranch_scc1 pc5t35
    s_branch pcd6
va7:
    s_mov_b32 s63, 100000
va7t36:
    buffer_load_dwordx4 v[172:175], v252, s[12:15], s36 offen offset:0 sc1
    buffer_load_dwordx4 v[176:179], v252, s[12:15], s37 offen offset:0 sc1
    buffer_load_dwordx4 v[180:183], v252, s[12:15], s38 offen offset:0 sc1
    buffer_load_dwordx4 v[184:187], v252, s[12:15], s39 offen offset:0 sc1
    s_add_u32 s45, s36, 4096
    buffer_load_dwordx4 v[188:191], v252, s[12:15], s45 offen offset:1024 sc1
    s_add_u32 s45, s37, 4096
    buffer_load_dwordx4 v[192:195], v252, s[12:15], s45 offen offset:1024 sc1
    s_add_u32 s45, s38, 4096
    buffer_load_dwordx4 v[196:199], v252, s[12:15], s45 offen offset:1024 sc1
    s_add_u32 s45, s39, 4096
    buffer_load_dwordx4 v[200:203], v252, s[12:15], s45 offen offset:1024 sc1
    buffer_load_dwordx4 v[224:227], v252, s[12:15], s36 offen offset:1024 sc1
    buffer_load_dwordx4 v[228:231], v252, s[12:15], s37 offen offset:1024 sc1
    buffer_load_dwordx4 v[232:235], v252, s[12:15], s38 offen offset:1024 sc1
    buffer_load_dwordx4 v[236:239], v252, s[12:15], s39 offen offset:1024 sc1
    s_add_u32 s45, s36, 4096
    buffer_load_dwordx4 v[240:243], v252, s[12:15], s45 offen offset:2048 sc1
    s_add_u32 s45, s37, 4096
    buffer_load_dwordx4 v[244:247], v252, s[12:15], s45 offen offset:2048 sc1
    s_add_u32 s45, s38, 4096
    buffer_load_dwordx4 v[248:251], v252, s[12:15], s45 offen offset:2048 sc1
    s_add_u32 s45, s39, 4096
    buffer_load_dwordx4 v[204:207], v252, s[12:15], s45 offen offset:2048 sc1
    s_waitcnt vmcnt(0)
    v_xor_b32 v172, s32, v172
    v_xor_b32 v173, s32, v173
    v_or_b32 v1, v172, v173
    v_xor_b32 v174, s32, v174
    v_xor_b32 v175, s32, v175
    v_or3_b32 v1, v174, v175, v1
    v_xor_b32 v176, s32, v176
    v_xor_b32 v177, s32, v177
    v_or3_b32 v1, v176, v177, v1
    v_xor_b32 v178, s32, v178
    v_xor_b32 v179, s32, v179
    v_or3_b32 v1, v178, v179, v1
    v_xor_b32 v180, s32, v180
    v_xor_b32 v181, s32, v181
    v_or3_b32 v1, v180, v181, v1
    v_xor_b32 v182, s32, v182
    v_xor_b32 v183, s32, v183
    v_or3_b32 v1, v182, v183, v1
    v_xor_b32 v184, s32, v184
    v_xor_b32 v185, s32, v185
    v_or3_b32 v1, v184, v185, v1
    v_xor_b32 v186, s32, v186
    v_xor_b32 v187, s32, v187
    v_or3_b32 v1, v186, v187, v1
    v_and_b32 v1, 0x10001, v1
    v_cmp_ne_u32 vcc, 0, v1
    s_nop 1
    s_cbranch_vccz vad8
    s_sub_u32 s63, s63, 1
    s_cmp_lg_u32 s63, 0
    s_cbranch_scc1 va7t36
    s_branch vad8
va9:
    s_mov_b32 s63, 100000
va9t37:
    s_add_u32 s45, s36, 4096
    buffer_load_dwordx4 v[188:191], v252, s[12:15], s45 offen offset:1024 sc1
    s_add_u32 s45, s37, 4096
    buffer_load_dwordx4 v[192:195], v252, s[12:15], s45 offen offset:1024 sc1
    s_add_u32 s45, s38, 4096
    buffer_load_dwordx4 v[196:199], v252, s[12:15], s45 offen offset:1024 sc1
    s_add_u32 s45, s39, 4096
    buffer_load_dwordx4 v[200:203], v252, s[12:15], s45 offen offset:1024 sc1
    buffer_load_dwordx4 v[224:227], v252, s[12:15], s36 offen offset:1024 sc1
    buffer_load_dwordx4 v[228:231], v252, s[12:15], s37 offen offset:1024 sc1
    buffer_load_dwordx4 v[232:235], v252, s[12:15], s38 offen offset:1024 sc1
    buffer_load_dwordx4 v[236:239], v252, s[12:15], s39 offen offset:1024 sc1
    s_add_u32 s45, s36, 4096
    buffer_load_dwordx4 v[240:243], v252, s[12:15], s45 offen offset:2048 sc1
    s_add_u32 s45, s37, 4096
    buffer_load_dwordx4 v[244:247], v252, s[12:15], s45 offen offset:2048 sc1
    s_add_u32 s45, s38, 4096
    buffer_load_dwordx4 v[248:251], v252, s[12:15], s45 offen offset:2048 sc1
    s_add_u32 s45, s39, 4096
    buffer_load_dwordx4 v[204:207], v252, s[12:15], s45 offen offset:2048 sc1
    buffer_load_dwordx4 v[208:211], v252, s[12:15], s36 offen offset:2048 sc1
    buffer_load_dwordx4 v[212:215], v252, s[12:15], s37 offen offset:2048 sc1
    buffer_load_dwordx4 v[216:219], v252, s[12:15], s38 offen offset:2048 sc1
    buffer_load_dwordx4 v[220:223], v252, s[12:15], s39 offen offset:2048 sc1
    s_add_u32 s45, s36, 4096
    buffer_load_dwordx4 v[172:175], v252, s[12:15], s45 offen offset:3072 sc1
    s_add_u32 s45, s37, 4096
    buffer_load_dwordx4 v[176:179], v252, s[12:15], s45 offen offset:3072 sc1
    s_add_u32 s45, s38, 4096
    buffer_load_dwordx4 v[180:183], v252, s[12:15], s45 offen offset:3072 sc1
    s_waitcnt vmcnt(0)
    v_xor_b32 v188, s32, v188
    v_xor_b32 v189, s32, v189
    v_or_b32 v1, v188, v189
    v_xor_b32 v190, s32, v190
    v_xor_b32 v191, s32, v191
    v_or3_b32 v1, v190, v191, v1
    v_xor_b32 v192, s32, v192
    v_xor_b32 v193, s32, v193
    v_or3_b32 v1, v192, v193, v1
    v_xor_b32 v194, s32, v194
    v_xor_b32 v195, s32, v195
    v_or3_b32 v1, v194, v195, v1
    v_xor_b32 v196, s32, v196
    v_xor_b32 v197, s32, v197
    v_or3_b32 v1, v196, v197, v1
    v_xor_b32 v198, s32, v198
    v_xor_b32 v199, s32, v199
    v_or3_b32 v1, v198, v199, v1
    v_xor_b32 v200, s32, v200
    v_xor_b32 v201, s32, v201
    v_or3_b32 v1, v200, v201, v1
    v_xor_b32 v202, s32, v202
    v_xor_b32 v203, s32, v203
    v_or3_b32 v1, v202, v203, v1
    v_and_b32 v1, 0x10001, v1
    v_cmp_ne_u32 vcc, 0, v1
    s_nop 1
    s_cbranch_vccz vad10
    s_sub_u32 s63, s63, 1
    s_cmp_lg_u32 s63, 0
    s_cbranch_scc1 va9t37
    s_branch vad10
va11:
    s_mov_b32 s63, 100000
va11t38:
    buffer_load_dwordx4 v[224:227], v252, s[12:15], s36 offen offset:1024 sc1
    buffer_load_dwordx4 v[228:231], v252, s[12:15], s37 offen offset:1024 sc1
    buffer_load_dwordx4 v[232:235], v252, s[12:15], s38 offen offset:1024 sc1
    buffer_load_dwordx4 v[236:239], v252, s[12:15], s39 offen offset:1024 sc1
    s_add_u32 s45, s36, 4096
    buffer_load_dwordx4 v[240:243], v252, s[12:15], s45 offen offset:2048 sc1
    s_add_u32 s45, s37, 4096
    buffer_load_dwordx4 v[244:247], v252, s[12:15], s45 offen offset:2048 sc1
    s_add_u32 s45, s38, 4096
    buffer_load_dwordx4 v[248:251], v252, s[12:15], s45 offen offset:2048 sc1
    s_add_u32 s45, s39, 4096
    buffer_load_dwordx4 v[204:207], v252, s[12:15], s45 offen offset:2048 sc1
    buffer_load_dwordx4 v[208:211], v252, s[12:15], s36 offen offset:2048 sc1
    buffer_load_dwordx4 v[212:215], v252, s[12:15], s37 offen offset:2048 sc1
    buffer_load_dwordx4 v[216:219], v252, s[12:15], s38 offen offset:2048 sc1
    buffer_load_dwordx4 v[220:223], v252, s[12:15], s39 offen offset:2048 sc1
    s_add_u32 s45, s36, 4096
    buffer_load_dwordx4 v[172:175], v252, s[12:15], s45 offen offset:3072 sc1
    s_add_u32 s45, s37, 4096
    buffer_load_dwordx4 v[176:179], v252, s[12:15], s45 offen offset:3072 sc1
    s_add_u32 s45, s38, 4096
    buffer_load_dwordx4 v[180:183], v252, s[12:15], s45 offen offset:3072 sc1
    s_add_u32 s45, s39, 4096
    buffer_load_dwordx4 v[184:187], v252, s[12:15], s45 offen offset:3072 sc1
    buffer_load_dwordx4 v[16:19], v252, s[12:15], s36 offen offset:3072 sc1
    buffer_load_dwordx4 v[188:191], v252, s[12:15], s37 offen offset:3072 sc1
    buffer_load_dwordx4 v[20:23], v252, s[12:15], s38 offen offset:3072 sc1
    buffer_load_dwordx4 v[192:195], v252, s[12:15], s39 offen offset:3072 sc1
    s_add_u32 s45, s36, 8192
    buffer_load_dwordx4 v[196:199], v252, s[12:15], s45 offen offset:0 sc1
    s_waitcnt vmcnt(0)
    v_xor_b32 v224, s32, v224
    v_xor_b32 v225, s32, v225
    v_or_b32 v1, v224, v225
    v_xor_b32 v226, s32, v226
    v_xor_b32 v227, s32, v227
    v_or3_b32 v1, v226, v227, v1
    v_xor_b32 v228, s32, v228
    v_xor_b32 v229, s32, v229
    v_or3_b32 v1, v228, v229, v1
    v_xor_b32 v230, s32, v230
    v_xor_b32 v231, s32, v231
    v_or3_b32 v1, v230, v231, v1
    v_xor_b32 v232, s32, v232
    v_xor_b32 v233, s32, v233
    v_or3_b32 v1, v232, v233, v1
    v_xor_b32 v234, s32, v234
    v_xor_b32 v235, s32, v235
    v_or3_b32 v1, v234, v235, v1
    v_xor_b32 v236, s32, v236
    v_xor_b32 v237, s32, v237
    v_or3_b32 v1, v236, v237, v1
    v_xor_b32 v238, s32, v238
    v_xor_b32 v239, s32, v239
    v_or3_b32 v1, v238, v239, v1
    v_and_b32 v1, 0x10001, v1
    v_cmp_ne_u32 vcc, 0, v1
    s_nop 1
    s_cbranch_vccz vad12
    s_sub_u32 s63, s63, 1
    s_cmp_lg_u32 s63, 0
    s_cbranch_scc1 va11t38
    s_branch vad12
va13:
    s_mov_b32 s63, 100000
va13t39:
    s_add_u32 s45, s36, 4096
    buffer_load_dwordx4 v[240:243], v252, s[12:15], s45 offen offset:2048 sc1
    s_add_u32 s45, s37, 4096
    buffer_load_dwordx4 v[244:247], v252, s[12:15], s45 offen offset:2048 sc1
    s_add_u32 s45, s38, 4096
    buffer_load_dwordx4 v[248:251], v252, s[12:15], s45 offen offset:2048 sc1
    s_add_u32 s45, s39, 4096
    buffer_load_dwordx4 v[204:207], v252, s[12:15], s45 offen offset:2048 sc1
    buffer_load_dwordx4 v[208:211], v252, s[12:15], s36 offen offset:2048 sc1
    buffer_load_dwordx4 v[212:215], v252, s[12:15], s37 offen offset:2048 sc1
    buffer_load_dwordx4 v[216:219], v252, s[12:15], s38 offen offset:2048 sc1
    buffer_load_dwordx4 v[220:223], v252, s[12:15], s39 offen offset:2048 sc1
    s_add_u32 s45, s36, 4096
    buffer_load_dwordx4 v[172:175], v252, s[12:15], s45 offen offset:3072 sc1
    s_add_u32 s45, s37, 4096
    buffer_load_dwordx4 v[176:179], v252, s[12:15], s45 offen offset:3072 sc1
    s_add_u32 s45, s38, 4096
    buffer_load_dwordx4 v[180:183], v252, s[12:15], s45 offen offset:3072 sc1
    s_add_u32 s45, s39, 4096
    buffer_load_dwordx4 v[184:187], v252, s[12:15], s45 offen offset:3072 sc1
    buffer_load_dwordx4 v[16:19], v252, s[12:15], s36 offen offset:3072 sc1
    buffer_load_dwordx4 v[188:191], v252, s[12:15], s37 offen offset:3072 sc1
    buffer_load_dwordx4 v[20:23], v252, s[12:15], s38 offen offset:3072 sc1
    buffer_load_dwordx4 v[192:195], v252, s[12:15], s39 offen offset:3072 sc1
    s_add_u32 s45, s36, 8192
    buffer_load_dwordx4 v[196:199], v252, s[12:15], s45 offen offset:0 sc1
    s_add_u32 s45, s37, 8192
    buffer_load_dwordx4 v[200:203], v252, s[12:15], s45 offen offset:0 sc1
    s_add_u32 s45, s38, 8192
    buffer_load_dwordx4 v[224:227], v252, s[12:15], s45 offen offset:0 sc1
    s_add_u32 s45, s39, 8192
    buffer_load_dwordx4 v[228:231], v252, s[12:15], s45 offen offset:0 sc1
    s_add_u32 s45, s36, 4096
    buffer_load_dwordx4 v[24:27], v252, s[12:15], s45 offen offset:0 sc1
    s_waitcnt vmcnt(0)
    v_xor_b32 v240, s32, v240
    v_xor_b32 v241, s32, v241
    v_or_b32 v1, v240, v241
    v_xor_b32 v242, s32, v242
    v_xor_b32 v243, s32, v243
    v_or3_b32 v1, v242, v243, v1
    v_xor_b32 v244, s32, v244
    v_xor_b32 v245, s32, v245
    v_or3_b32 v1, v244, v245, v1
    v_xor_b32 v246, s32, v246
    v_xor_b32 v247, s32, v247
    v_or3_b32 v1, v246, v247, v1
    v_xor_b32 v248, s32, v248
    v_xor_b32 v249, s32, v249
    v_or3_b32 v1, v248, v249, v1
    v_xor_b32 v250, s32, v250
    v_xor_b32 v251, s32, v251
    v_or3_b32 v1, v250, v251, v1
    v_xor_b32 v204, s32, v204
    v_xor_b32 v205, s32, v205
    v_or3_b32 v1, v204, v205, v1
    v_xor_b32 v206, s32, v206
    v_xor_b32 v207, s32, v207
    v_or3_b32 v1, v206, v207, v1
    v_and_b32 v1, 0x10001, v1
    v_cmp_ne_u32 vcc, 0, v1
    s_nop 1
    s_cbranch_vccz vad14
    s_sub_u32 s63, s63, 1
    s_cmp_lg_u32 s63, 0
    s_cbranch_scc1 va13t39
    s_branch vad14
va15:
    s_mov_b32 s63, 100000
va15t40:
    buffer_load_dwordx4 v[208:211], v252, s[12:15], s36 offen offset:2048 sc1
    buffer_load_dwordx4 v[212:215], v252, s[12:15], s37 offen offset:2048 sc1
    buffer_load_dwordx4 v[216:219], v252, s[12:15], s38 offen offset:2048 sc1
    buffer_load_dwordx4 v[220:223], v252, s[12:15], s39 offen offset:2048 sc1
    s_add_u32 s45, s36, 4096
    buffer_load_dwordx4 v[172:175], v252, s[12:15], s45 offen offset:3072 sc1
    s_add_u32 s45, s37, 4096
    buffer_load_dwordx4 v[176:179], v252, s[12:15], s45 offen offset:3072 sc1
    s_add_u32 s45, s38, 4096
    buffer_load_dwordx4 v[180:183], v252, s[12:15], s45 offen offset:3072 sc1
    s_add_u32 s45, s39, 4096
    buffer_load_dwordx4 v[184:187], v252, s[12:15], s45 offen offset:3072 sc1
    buffer_load_dwordx4 v[16:19], v252, s[12:15], s36 offen offset:3072 sc1
    buffer_load_dwordx4 v[188:191], v252, s[12:15], s37 offen offset:3072 sc1
    buffer_load_dwordx4 v[20:23], v252, s[12:15], s38 offen offset:3072 sc1
    buffer_load_dwordx4 v[192:195], v252, s[12:15], s39 offen offset:3072 sc1
    s_add_u32 s45, s36, 8192
    buffer_load_dwordx4 v[196:199], v252, s[12:15], s45 offen offset:0 sc1
    s_add_u32 s45, s37, 8192
    buffer_load_dwordx4 v[200:203], v252, s[12:15], s45 offen offset:0 sc1
    s_add_u32 s45, s38, 8192
    buffer_load_dwordx4 v[224:227], v252, s[12:15], s45 offen offset:0 sc1
    s_add_u32 s45, s39, 8192
    buffer_load_dwordx4 v[228:231], v252, s[12:15], s45 offen offset:0 sc1
    s_add_u32 s45, s36, 4096
    buffer_load_dwordx4 v[24:27], v252, s[12:15], s45 offen offset:0 sc1
    s_add_u32 s45, s37, 4096
    buffer_load_dwordx4 v[28:31], v252, s[12:15], s45 offen offset:0 sc1
    s_add_u32 s45, s38, 4096
    buffer_load_dwordx4 v[32:35], v252, s[12:15], s45 offen offset:0 sc1
    s_add_u32 s45, s39, 4096
    buffer_load_dwordx4 v[36:39], v252, s[12:15], s45 offen offset:0 sc1
    s_add_u32 s45, s36, 8192
    buffer_load_dwordx4 v[40:43], v252, s[12:15], s45 offen offset:1024 sc1
    s_waitcnt vmcnt(0)
    v_xor_b32 v208, s32, v208
    v_xor_b32 v209, s32, v209
    v_or_b32 v1, v208, v209
    v_xor_b32 v210, s32, v210
    v_xor_b32 v211, s32, v211
    v_or3_b32 v1, v210, v211, v1
    v_xor_b32 v212, s32, v212
    v_xor_b32 v213, s32, v213
    v_or3_b32 v1, v212, v213, v1
    v_xor_b32 v214, s32, v214
    v_xor_b32 v215, s32, v215
    v_or3_b32 v1, v214, v215, v1
    v_xor_b32 v216, s32, v216
    v_xor_b32 v217, s32, v217
    v_or3_b32 v1, v216, v217, v1
    v_xor_b32 v218, s32, v218
    v_xor_b32 v219, s32, v219
    v_or3_b32 v1, v218, v219, v1
    v_xor_b32 v220, s32, v220
    v_xor_b32 v221, s32, v221
    v_or3_b32 v1, v220, v221, v1
    v_xor_b32 v222, s32, v222
    v_xor_b32 v223, s32, v223
    v_or3_b32 v1, v222, v223, v1
    v_and_b32 v1, 0x10001, v1
    v_cmp_ne_u32 vcc, 0, v1
    s_nop 1
    s_cbranch_vccz vad16
    s_sub_u32 s63, s63, 1
    s_cmp_lg_u32 s63, 0
    s_cbranch_scc1 va15t40
    s_branch vad16
va17:
    s_mov_b32 s63, 100000
va17t41:
    s_add_u32 s45, s36, 4096
    buffer_load_dwordx4 v[172:175], v252, s[12:15], s45 offen offset:3072 sc1
    s_add_u32 s45, s37, 4096
    buffer_load_dwordx4 v[176:179], v252, s[12:15], s45 offen offset:3072 sc1
    s_add_u32 s45, s38, 4096
    buffer_load_dwordx4 v[180:183], v252, s[12:15], s45 offen offset:3072 sc1
    s_add_u32 s45, s39, 4096
    buffer_load_dwordx4 v[184:187], v252, s[12:15], s45 offen offset:3072 sc1
    buffer_load_dwordx4 v[16:19], v252, s[12:15], s36 offen offset:3072 sc1
    buffer_load_dwordx4 v[188:191], v252, s[12:15], s37 offen offset:3072 sc1
    buffer_load_dwordx4 v[20:23], v252, s[12:15], s38 offen offset:3072 sc1
    buffer_load_dwordx4 v[192:195], v252, s[12:15], s39 offen offset:3072 sc1
    s_add_u32 s45, s36, 8192
    buffer_load_dwordx4 v[196:199], v252, s[12:15], s45 offen offset:0 sc1
    s_add_u32 s45, s37, 8192
    buffer_load_dwordx4 v[200:203], v252, s[12:15], s45 offen offset:0 sc1
    s_add_u32 s45, s38, 8192
    buffer_load_dwordx4 v[224:227], v252, s[12:15], s45 offen offset:0 sc1
    s_add_u32 s45, s39, 8192
    buffer_load_dwordx4 v[228:231], v252, s[12:15], s45 offen offset:0 sc1
    s_add_u32 s45, s36, 4096
    buffer_load_dwordx4 v[24:27], v252, s[12:15], s45 offen offset:0 sc1
    s_add_u32 s45, s37, 4096
    buffer_load_dwordx4 v[28:31], v252, s[12:15], s45 offen offset:0 sc1
    s_add_u32 s45, s38, 4096
    buffer_load_dwordx4 v[32:35], v252, s[12:15], s45 offen offset:0 sc1
    s_add_u32 s45, s39, 4096
    buffer_load_dwordx4 v[36:39], v252, s[12:15], s45 offen offset:0 sc1
    s_add_u32 s45, s36, 8192
    buffer_load_dwordx4 v[40:43], v252, s[12:15], s45 offen offset:1024 sc1
    s_add_u32 s45, s37, 8192
    buffer_load_dwordx4 v[44:47], v252, s[12:15], s45 offen offset:1024 sc1
    s_add_u32 s45, s38, 8192
    buffer_load_dwordx4 v[48:51], v252, s[12:15], s45 offen offset:1024 sc1
    s_add_u32 s45, s39, 8192
    buffer_load_dwordx4 v[52:55], v252, s[12:15], s45 offen offset:1024 sc1
    s_waitcnt vmcnt(0)
    v_xor_b32 v172, s32, v172
    v_xor_b32 v173, s32, v173
    v_or_b32 v1, v172, v173
    v_xor_b32 v174, s32, v174
    v_xor_b32 v175, s32, v175
    v_or3_b32 v1, v174, v175, v1
    v_xor_b32 v176, s32, v176
    v_xor_b32 v177, s32, v177
    v_or3_b32 v1, v176, v177, v1
    v_xor_b32 v178, s32, v178
    v_xor_b32 v179, s32, v179
    v_or3_b32 v1, v178, v179, v1
    v_xor_b32 v180, s32, v180
    v_xor_b32 v181, s32, v181
    v_or3_b32 v1, v180, v181, v1
    v_xor_b32 v182, s32, v182
    v_xor_b32 v183, s32, v183
    v_or3_b32 v1, v182, v183, v1
    v_xor_b32 v184, s32, v184
    v_xor_b32 v185, s32, v185
    v_or3_b32 v1, v184, v185, v1
    v_xor_b32 v186, s32, v186
    v_xor_b32 v187, s32, v187
    v_or3_b32 v1, v186, v187, v1
    v_and_b32 v1, 0x10001, v1
    v_cmp_ne_u32 vcc, 0, v1
    s_nop 1
    s_cbranch_vccz vad18
    s_sub_u32 s63, s63, 1
    s_cmp_lg_u32 s63, 0
    s_cbranch_scc1 va17t41
    s_branch vad18
va19:
    s_mov_b32 s63, 100000
va19t42:
    buffer_load_dwordx4 v[16:19], v252, s[12:15], s36 offen offset:3072 sc1
    buffer_load_dwordx4 v[188:191], v252, s[12:15], s37 offen offset:3072 sc1
    buffer_load_dwordx4 v[20:23], v252, s[12:15], s38 offen offset:3072 sc1
    buffer_load_dwordx4 v[192:195], v252, s[12:15], s39 offen offset:3072 sc1
    s_add_u32 s45, s36, 8192
    buffer_load_dwordx4 v[196:199], v252, s[12:15], s45 offen offset:0 sc1
    s_add_u32 s45, s37, 8192
    buffer_load_dwordx4 v[200:203], v252, s[12:15], s45 offen offset:0 sc1
    s_add_u32 s45, s38, 8192
    buffer_load_dwordx4 v[224:227], v252, s[12:15], s45 offen offset:0 sc1
    s_add_u32 s45, s39, 8192
    buffer_load_dwordx4 v[228:231], v252, s[12:15], s45 offen offset:0 sc1
    s_add_u32 s45, s36, 4096
    buffer_load_dwordx4 v[24:27], v252, s[12:15], s45 offen offset:0 sc1
    s_add_u32 s45, s37, 4096
    buffer_load_dwordx4 v[28:31], v252, s[12:15], s45 offen offset:0 sc1
    s_add_u32 s45, s38, 4096
    buffer_load_dwordx4 v[32:35], v252, s[12:15], s45 offen offset:0 sc1
    s_add_u32 s45, s39, 4096
    buffer_load_dwordx4 v[36:39], v252, s[12:15], s45 offen offset:0 sc1
    s_add_u32 s45, s36, 8192
    buffer_load_dwordx4 v[40:43], v252, s[12:15], s45 offen offset:1024 sc1
    s_add_u32 s45, s37, 8192
    buffer_load_dwordx4 v[44:47], v252, s[12:15], s45 offen offset:1024 sc1
    s_add_u32 s45, s38, 8192
    buffer_load_dwordx4 v[48:51], v252, s[12:15], s45 offen offset:1024 sc1
    s_add_u32 s45, s39, 8192
    buffer_load_dwordx4 v[52:55], v252, s[12:15], s45 offen offset:1024 sc1
    s_waitcnt vmcnt(0)
    v_xor_b32 v16, s32, v16
    v_xor_b32 v17, s32, v17
    v_or_b32 v1, v16, v17
    v_xor_b32 v18, s32, v18
    v_xor_b32 v19, s32, v19
    v_or3_b32 v1, v18, v19, v1
    v_xor_b32 v188, s32, v188
    v_xor_b32 v189, s32, v189
    v_or3_b32 v1, v188, v189, v1
    v_xor_b32 v190, s32, v190
    v_xor_b32 v191, s32, v191
    v_or3_b32 v1, v190, v191, v1
    v_xor_b32 v20, s32, v20
    v_xor_b32 v21, s32, v21
    v_or3_b32 v1, v20, v21, v1
    v_xor_b32 v22, s32, v22
    v_xor_b32 v23, s32, v23
    v_or3_b32 v1, v22, v23, v1
    v_xor_b32 v192, s32, v192
    v_xor_b32 v193, s32, v193
    v_or3_b32 v1, v192, v193, v1
    v_xor_b32 v194, s32, v194
    v_xor_b32 v195, s32, v195
    v_or3_b32 v1, v194, v195, v1
    v_and_b32 v1, 0x10001, v1
    v_cmp_ne_u32 vcc, 0, v1
    s_nop 1
    s_cbranch_vccz vad20
    s_sub_u32 s63, s63, 1
    s_cmp_lg_u32 s63, 0
    s_cbranch_scc1 va19t42
    s_branch vad20
va21:
    s_mov_b32 s63, 100000
va21t43:
    s_add_u32 s45, s36, 8192
    buffer_load_dwordx4 v[196:199], v252, s[12:15], s45 offen offset:0 sc1
    s_add_u32 s45, s37, 8192
    buffer_load_dwordx4 v[200:203], v252, s[12:15], s45 offen offset:0 sc1
    s_add_u32 s45, s38, 8192
    buffer_load_dwordx4 v[224:227], v252, s[12:15], s45 offen offset:0 sc1
    s_add_u32 s45, s39, 8192
    buffer_load_dwordx4 v[228:231], v252, s[12:15], s45 offen offset:0 sc1
    s_add_u32 s45, s36, 4096
    buffer_load_dwordx4 v[24:27], v252, s[12:15], s45 offen offset:0 sc1
    s_add_u32 s45, s37, 4096
    buffer_load_dwordx4 v[28:31], v252, s[12:15], s45 offen offset:0 sc1
    s_add_u32 s45, s38, 4096
    buffer_load_dwordx4 v[32:35], v252, s[12:15], s45 offen offset:0 sc1
    s_add_u32 s45, s39, 4096
    buffer_load_dwordx4 v[36:39], v252, s[12:15], s45 offen offset:0 sc1
    s_add_u32 s45, s36, 8192
    buffer_load_dwordx4 v[40:43], v252, s[12:15], s45 offen offset:1024 sc1
    s_add_u32 s45, s37, 8192
    buffer_load_dwordx4 v[44:47], v252, s[12:15], s45 offen offset:1024 sc1
    s_add_u32 s45, s38, 8192
    buffer_load_dwordx4 v[48:51], v252, s[12:15], s45 offen offset:1024 sc1
    s_add_u32 s45, s39, 8192
    buffer_load_dwordx4 v[52:55], v252, s[12:15], s45 offen offset:1024 sc1
    s_waitcnt vmcnt(0)
    v_xor_b32 v196, s32, v196
    v_xor_b32 v197, s32, v197
    v_or_b32 v1, v196, v197
    v_xor_b32 v198, s32, v198
    v_xor_b32 v199, s32, v199
    v_or3_b32 v1, v198, v199, v1
    v_xor_b32 v200, s32, v200
    v_xor_b32 v201, s32, v201
    v_or3_b32 v1, v200, v201, v1
    v_xor_b32 v202, s32, v202
    v_xor_b32 v203, s32, v203
    v_or3_b32 v1, v202, v203, v1
    v_xor_b32 v224, s32, v224
    v_xor_b32 v225, s32, v225
    v_or3_b32 v1, v224, v225, v1
    v_xor_b32 v226, s32, v226
    v_xor_b32 v227, s32, v227
    v_or3_b32 v1, v226, v227, v1
    v_xor_b32 v228, s32, v228
    v_xor_b32 v229, s32, v229
    v_or3_b32 v1, v228, v229, v1
    v_xor_b32 v230, s32, v230
    v_xor_b32 v231, s32, v231
    v_or3_b32 v1, v230, v231, v1
    v_and_b32 v1, 0x10001, v1
    v_cmp_ne_u32 vcc, 0, v1
    s_nop 1
    s_cbranch_vccz vad22
    s_sub_u32 s63, s63, 1
    s_cmp_lg_u32 s63, 0
    s_cbranch_scc1 va21t43
    s_branch vad22
fa23:
    s_mov_b32 s63, 100000
fa23t44:
    buffer_load_dword v4, v2, s[12:15], s95 offen sc1
    s_waitcnt vmcnt(0)
    v_cmp_ne_u32 vcc, s28, v4
    s_nop 1
    s_cbranch_vccz fad24
    s_sub_u32 s63, s63, 1
    s_cmp_lg_u32 s63, 0
    s_cbranch_scc1 fa23t44
    s_branch fad24
va25:
    s_mov_b32 s63, 100000
va25t45:
    s_add_u32 s45, s36, 4096
    buffer_load_dwordx4 v[24:27], v252, s[12:15], s45 offen offset:0 sc1
    s_add_u32 s45, s37, 4096
    buffer_load_dwordx4 v[28:31], v252, s[12:15], s45 offen offset:0 sc1
    s_add_u32 s45, s38, 4096
    buffer_load_dwordx4 v[32:35], v252, s[12:15], s45 offen offset:0 sc1
    s_add_u32 s45, s39, 4096
    buffer_load_dwordx4 v[36:39], v252, s[12:15], s45 offen offset:0 sc1
    s_add_u32 s45, s36, 8192
    buffer_load_dwordx4 v[40:43], v252, s[12:15], s45 offen offset:1024 sc1
    s_add_u32 s45, s37, 8192
    buffer_load_dwordx4 v[44:47], v252, s[12:15], s45 offen offset:1024 sc1
    s_add_u32 s45, s38, 8192
    buffer_load_dwordx4 v[48:51], v252, s[12:15], s45 offen offset:1024 sc1
    s_add_u32 s45, s39, 8192
    buffer_load_dwordx4 v[52:55], v252, s[12:15], s45 offen offset:1024 sc1
    s_waitcnt vmcnt(0)
    v_xor_b32 v24, s32, v24
    v_xor_b32 v25, s32, v25
    v_or_b32 v1, v24, v25
    v_xor_b32 v26, s32, v26
    v_xor_b32 v27, s32, v27
    v_or3_b32 v1, v26, v27, v1
    v_xor_b32 v28, s32, v28
    v_xor_b32 v29, s32, v29
    v_or3_b32 v1, v28, v29, v1
    v_xor_b32 v30, s32, v30
    v_xor_b32 v31, s32, v31
    v_or3_b32 v1, v30, v31, v1
    v_xor_b32 v32, s32, v32
    v_xor_b32 v33, s32, v33
    v_or3_b32 v1, v32, v33, v1
    v_xor_b32 v34, s32, v34
    v_xor_b32 v35, s32, v35
    v_or3_b32 v1, v34, v35, v1
    v_xor_b32 v36, s32, v36
    v_xor_b32 v37, s32, v37
    v_or3_b32 v1, v36, v37, v1
    v_xor_b32 v38, s32, v38
    v_xor_b32 v39, s32, v39
    v_or3_b32 v1, v38, v39, v1
    v_and_b32 v1, 0x10001, v1
    v_cmp_ne_u32 vcc, 0, v1
    s_nop 1
    s_cbranch_vccz vad26
    s_sub_u32 s63, s63, 1
    s_cmp_lg_u32 s63, 0
    s_cbranch_scc1 va25t45
    s_branch vad26
va27:
    s_mov_b32 s63, 100000
va27t46:
    s_add_u32 s45, s36, 8192
    buffer_load_dwordx4 v[40:43], v252, s[12:15], s45 offen offset:1024 sc1
    s_add_u32 s45, s37, 8192
    buffer_load_dwordx4 v[44:47], v252, s[12:15], s45 offen offset:1024 sc1
    s_add_u32 s45, s38, 8192
    buffer_load_dwordx4 v[48:51], v252, s[12:15], s45 offen offset:1024 sc1
    s_add_u32 s45, s39, 8192
    buffer_load_dwordx4 v[52:55], v252, s[12:15], s45 offen offset:1024 sc1
    s_waitcnt vmcnt(0)
    v_xor_b32 v40, s32, v40
    v_xor_b32 v41, s32, v41
    v_or_b32 v1, v40, v41
    v_xor_b32 v42, s32, v42
    v_xor_b32 v43, s32, v43
    v_or3_b32 v1, v42, v43, v1
    v_xor_b32 v44, s32, v44
    v_xor_b32 v45, s32, v45
    v_or3_b32 v1, v44, v45, v1
    v_xor_b32 v46, s32, v46
    v_xor_b32 v47, s32, v47
    v_or3_b32 v1, v46, v47, v1
    v_xor_b32 v48, s32, v48
    v_xor_b32 v49, s32, v49
    v_or3_b32 v1, v48, v49, v1
    v_xor_b32 v50, s32, v50
    v_xor_b32 v51, s32, v51
    v_or3_b32 v1, v50, v51, v1
    v_xor_b32 v52, s32, v52
    v_xor_b32 v53, s32, v53
    v_or3_b32 v1, v52, v53, v1
    v_xor_b32 v54, s32, v54
    v_xor_b32 v55, s32, v55
    v_or3_b32 v1, v54, v55, v1
    v_and_b32 v1, 0x10001, v1
    v_cmp_ne_u32 vcc, 0, v1
    s_nop 1
    s_cbranch_vccz vad28
    s_sub_u32 s63, s63, 1
    s_cmp_lg_u32 s63, 0
    s_cbranch_scc1 va27t46
    s_branch vad28
pp29:
    s_mov_b32 s63, 100000
pp29t47:
    buffer_load_dwordx4 v[104:107], v252, s[12:15], s88 offen offset:0 sc1
    buffer_load_dwordx4 v[120:123], v252, s[12:15], s88 offen offset:1024 sc1
    buffer_load_dwordx4 v[136:139], v252, s[12:15], s88 offen offset:2048 sc1
    buffer_load_dwordx4 v[152:155], v252, s[12:15], s88 offen offset:3072 sc1
    buffer_load_dwordx4 v[168:171], v252, s[12:15], s89 offen offset:0 sc1
    s_waitcnt vmcnt(0)
    v_xor_b32 v104, s82, v104
    v_xor_b32 v105, s82, v105
    v_or_b32 v1, v104, v105
    v_xor_b32 v106, s82, v106
    v_xor_b32 v107, s82, v107
    v_or3_b32 v1, v106, v107, v1
    v_xor_b32 v120, s82, v120
    v_xor_b32 v121, s82, v121
    v_or3_b32 v1, v120, v121, v1
    v_xor_b32 v122, s82, v122
    v_xor_b32 v123, s82, v123
    v_or3_b32 v1, v122, v123, v1
    v_xor_b32 v136, s82, v136
    v_xor_b32 v137, s82, v137
    v_or3_b32 v1, v136, v137, v1
    v_xor_b32 v138, s82, v138
    v_xor_b32 v139, s82, v139
    v_or3_b32 v1, v138, v139, v1
    v_xor_b32 v152, s82, v152
    v_xor_b32 v153, s82, v153
    v_or3_b32 v1, v152, v153, v1
    v_xor_b32 v154, s82, v154
    v_xor_b32 v155, s82, v155
    v_or3_b32 v1, v154, v155, v1
    v_xor_b32 v168, s82, v168
    v_xor_b32 v169, s82, v169
    v_or3_b32 v1, v168, v169, v1
    v_xor_b32 v170, s82, v170
    v_xor_b32 v171, s82, v171
    v_or3_b32 v1, v170, v171, v1
    v_and_b32 v1, 3, v1
    v_cmp_ne_u32 vcc, 0, v1
    s_nop 1
    s_cbranch_vccz ppd30
    s_sub_u32 s63, s63, 1
    s_cmp_lg_u32 s63, 0
    s_cbranch_scc1 pp29t47
    s_branch ppd30
pe31:
    s_mov_b32 s63, 100000
pe31t48:
    s_mov_b32 s49, 69632
    buffer_load_dword v64, v68, s[12:15], s49 offen sc1
    s_mov_b32 s49, 86016
    buffer_load_dword v65, v68, s[12:15], s49 offen sc1
    s_mov_b32 s49, 102400
    buffer_load_dword v66, v68, s[12:15], s49 offen sc1
    s_mov_b32 s49, 118784
    buffer_load_dword v67, v68, s[12:15], s49 offen sc1
    s_waitcnt vmcnt(0)
    v_xor_b32 v14, s28, v64
    v_bitop3_b32 v14, s28, v65, v14 bitop3:0xbe
    v_bitop3_b32 v14, s28, v66, v14 bitop3:0xbe
    v_bitop3_b32 v14, s28, v67, v14 bitop3:0xbe
    v_cmp_ne_u32 vcc, 0, v14
    s_nop 1
    s_cbranch_vccz ped32
    s_sub_u32 s63, s63, 1
    s_cmp_lg_u32 s63, 0
    s_cbranch_scc1 pe31t48
    s_branch ped32
L_second:
    v_lshrrev_b32 v1, 6, v0
    v_and_b32 v0, 63, v0
    v_readfirstlane_b32 s3, v1
    s_bfe_u32 s48, s2, 0x20001
    s_lshr_b32 s49, s2, 6
    s_lshl_b32 s30, s49, 2
    s_add_u32 s30, s30, s48
    s_bfe_u32 s31, s2, 0x30003
    s_lshl_b32 s48, s30, 3
    s_add_u32 s48, s48, s31
    s_lshl_b32 s48, s48, 2
    s_add_u32 s33, s48, s3
    s_lshl_b32 s34, s33, 6
    s_lshl_b32 s45, s3, 12
    s_lshl_b32 s50, s30, 7
    s_lshl_b32 s51, s3, 5
    s_add_u32 s50, s50, s51
    s_mul_i32 s36, s50, 1280
    v_lshrrev_b32 v11, 4, v0
    v_and_b32 v13, 7, v0
    v_xor_b32 v12, v13, v11
    v_lshlrev_b32 v12, 4, v12
    v_lshrrev_b32 v3, 3, v0
    v_mul_u32_u24 v3, 1280, v3
    v_lshl_add_u32 v253, v13, 4, v3
    v_add_u32 v3, v3, v12
    v_lshlrev_b32 v252, 4, v0
    v_xor_b32 v2, 64, v3
    s_add_u32 s37, s36, 9216
    s_add_u32 s38, s36, 18432
    s_add_u32 s39, s36, 27648
    s_lshr_b32 s48, s30, 2
    s_add_u32 s2, s48, s31
    s_and_b32 s2, s2, 1
    s_mov_b32 s0, s2
    s_lshl_b32 s1, s2, 7
    v_add_u32 v3, s1, v3
    v_add_u32 v2, s1, v2
    s_mul_i32 s1, s1, 1536
    v_add_u32 v10, 0, v0
    v_mul_u32_u24 v12, 2731, v10
    v_lshrrev_b32 v12, 16, v12
    v_mul_u32_u24 v13, 24, v12
    v_sub_u32 v13, v10, v13
    v_bfe_u32 v40, v12, 1, 1
    v_lshlrev_b32 v40, 2, v40
    v_xor_b32 v13, v13, v40
    v_mul_u32_u24 v12, 3072, v12
    v_lshl_add_u32 v4, v13, 4, v12
    v_add_u32 v4, s1, v4
    v_add_u32 v10, 64, v0
    v_mul_u32_u24 v12, 2731, v10
    v_lshrrev_b32 v12, 16, v12
    v_mul_u32_u24 v13, 24, v12
    v_sub_u32 v13, v10, v13
    v_bfe_u32 v40, v12, 1, 1
    v_lshlrev_b32 v40, 2, v40
    v_xor_b32 v13, v13, v40
    v_mul_u32_u24 v12, 3072, v12
    v_lshl_add_u32 v5, v13, 4, v12
    v_subrev_u32 v5, 1024, v5
    v_add_u32 v5, s1, v5
    v_add_u32 v10, 128, v0
    v_mul_u32_u24 v12, 2731, v10
    v_lshrrev_b32 v12, 16, v12
    v_mul_u32_u24 v13, 24, v12
    v_sub_u32 v13, v10, v13
    v_bfe_u32 v40, v12, 1, 1
    v_lshlrev_b32 v40, 2, v40
    v_xor_b32 v13, v13, v40
    v_mul_u32_u24 v12, 3072, v12
    v_lshl_add_u32 v6, v13, 4, v12
    v_subrev_u32 v6, 2048, v6
    v_add_u32 v6, s1, v6
    s_mul_i32 s46, s3, 6144
    s_mul_i32 s40, s3, 49152
    s_mul_i32 s48, s31, 384
    s_add_u32 s40, s40, s48
    s_add_u32 s41, s40, 21504
    s_add_u32 s44, s40, 25600
    s_waitcnt lgkmcnt(0)
    s_load_dword s28, s[96:97], 0
    s_mov_b32 s4, s64
    s_mov_b32 s5, s65
    s_mov_b32 s6, 2621440
    s_mov_b32 s7, 0x20000
    s_mov_b32 s12, s96
    s_mov_b32 s13, s97
    s_mov_b32 s14, 22020096
    s_mov_b32 s15, 0x20000
    s_add_u32 m0, s45, 24576
    s_nop 0
    buffer_load_dwordx4 v3, s[4:7], s36 offen offset:0 lds
    buffer_load_dwordx4 v2, s[4:7], s37 offen offset:1024 lds
    buffer_load_dwordx4 v3, s[4:7], s38 offen offset:2048 lds
    buffer_load_dwordx4 v2, s[4:7], s39 offen offset:3072 lds
    s_mov_b32 s8, s84
    s_and_b32 s9, s85, 0xffff
    s_mov_b32 s10, 1966080
    s_mov_b32 s11, 0x20000
    s_add_u32 m0, s46, 0
    s_nop 0
    buffer_load_dwordx4 v4, s[8:11], s40 offen offset:0 lds
    buffer_load_dwordx4 v5, s[8:11], s40 offen offset:1024 lds
    buffer_load_dwordx4 v6, s[8:11], s40 offen offset:2048 lds
    s_lshr_b32 s42, s3, 1
    s_and_b32 s43, s3, 1
    s_lshl_b32 s50, s3, 2
    s_lshl_b32 s48, s30, 7
    s_lshl_b32 s49, s31, 4
    buffer_load_dwordx4 v4, s[8:11], s41 offen offset:3072 lds
    s_add_u32 s48, s48, s49
    s_add_u32 s53, s48, s50
    s_lshl_b32 s56, s53, 4
    s_add_u32 s56, s56, 364544
    s_mov_b32 s49, 3
    s_add_u32 m0, s46, 4096
    s_nop 0
    buffer_load_dwordx4 v5, s[8:11], s44 offen offset:0 lds
    v_min_u32 v9, s49, v11
    v_mul_u32_u24 v8, 1280, v9
    v_and_b32 v13, 15, v0
    v_lshl_add_u32 v8, v13, 4, v8
    v_lshlrev_b32 v9, 4, v9
    buffer_load_dwordx4 v6, s[8:11], s44 offen offset:1024 lds
    s_mul_i32 s53, s53, 1280
    s_mov_b32 s24, s88
    s_and_b32 s25, s89, 0xffff
    s_mov_b32 s26, 1966080
    s_mov_b32 s27, 0x20000
    s_sub_u32 s48, s33, 480
    s_cmp_lt_u32 s33, 480
    s_cselect_b32 s62, s33, s48
    s_mul_i32 s50, s62, 6554
    s_lshr_b32 s50, s50, 16
    s_mul_i32 s48, s50, 10
    s_sub_u32 s48, s62, s48
    s_mul_i32 s49, s50, 40960
    s_lshl_b32 s51, s48, 7
    s_add_u32 s54, s49, s51
    s_mul_i32 s51, s48, 192
    s_add_u32 s51, s51, s50
    s_add_u32 m0, s45, 65536
    s_xor_b32 s1, s2, 1
    s_sub_u32 s66, s1, s0
    s_mov_b32 s0, s1
    s_lshl_b32 s66, s66, 7
    s_mul_i32 s67, s66, 1536
    v_add_u32 v3, s66, v3
    buffer_load_dwordx4 v3, s[4:7], s36 offen offset:0 lds
    s_lshl_b32 s51, s51, 10
    s_add_u32 s58, s51, 2097152
    s_lshl_b32 s62, s62, 6
    s_add_u32 s62, s62, 36864
    s_lshl_b32 s57, s30, 11
    s_lshl_b32 s48, s42, 10
    s_add_u32 s57, s57, s48
    s_add_u32 s57, s57, 364544
    v_and_b32 v11, 31, v0
    v_lshrrev_b32 v12, 5, v0
    v_bfe_u32 v13, v0, 1, 3
    v_xor_b32 v13, v13, v12
    v_add_u32 v2, s66, v2
    buffer_load_dwordx4 v2, s[4:7], s37 offen offset:1024 lds
    v_lshlrev_b32 v13, 4, v13
    v_lshl_add_u32 v13, v11, 7, v13
    s_lshl_b32 s48, s42, 13
    s_add_u32 s48, s48, 24576
    v_add_u32 v10, s48, v13
    v_bfe_u32 v13, v0, 2, 2
    v_lshl_add_u32 v40, v12, 3, v13
    v_mul_u32_u24 v40, 384, v40
    v_bfe_u32 v15, v0, 4, 1
    v_lshl_add_u32 v40, v15, 5, v40
    v_and_b32 v41, 3, v0
    buffer_load_dwordx4 v[200:203], v8, s[4:7], s53 offen offset:0
    v_lshl_add_u32 v40, v41, 3, v40
    v_lshlrev_b32 v7, 4, v12
    v_lshl_add_u32 v7, v15, 2, v7
    v_add_u32 v7, v7, v13
    v_lshlrev_b32 v7, 7, v7
    v_lshl_add_u32 v7, v41, 3, v7
    v_add_u32 v7, s45, v7
    v_add_u32 v7, 147456, v7
    s_mul_i32 s48, s43, 192
    v_add_u32 v40, s48, v40
    v_bfe_u32 v13, v0, 3, 1
    v_lshlrev_b32 v13, 6, v13
    buffer_load_dwordx4 v[204:207], v8, s[4:7], s53 offen offset:256
    s_cmp_eq_u32 s43, 0
    s_cselect_b32 s48, 1, -1
    v_mul_lo_u32 v13, v13, s48
    v_add_u32 v15, v40, v13
    v_sub_u32 v40, v40, v13
    v_mov_b32 v124, 0x3f803f80
    v_mov_b32 v125, 0x3f803f80
    s_lshl_b32 s48, s42, 1
    s_add_u32 s48, s48, 0
    s_and_b32 s48, s48, 3
    s_lshl_b32 s49, s48, 5
    s_mul_i32 s48, s48, 6144
    buffer_load_dwordx4 v[208:211], v8, s[4:7], s53 offen offset:512
    v_xor_b32 v176, s49, v10
    v_add_u32 v180, s48, v15
    v_add_u32 v184, s48, v40
    s_lshl_b32 s48, s42, 1
    s_add_u32 s48, s48, 1
    s_and_b32 s48, s48, 3
    s_lshl_b32 s49, s48, 5
    s_mul_i32 s48, s48, 6144
    v_xor_b32 v177, s49, v10
    v_add_u32 v181, s48, v15
    v_add_u32 v185, s48, v40
    s_lshl_b32 s48, s42, 1
    buffer_load_dwordx4 v[212:215], v8, s[4:7], s53 offen offset:768
    s_add_u32 s48, s48, 2
    s_and_b32 s48, s48, 3
    s_lshl_b32 s49, s48, 5
    s_mul_i32 s48, s48, 6144
    v_xor_b32 v178, s49, v10
    v_add_u32 v182, s48, v15
    v_add_u32 v186, s48, v40
    s_lshl_b32 s48, s42, 1
    s_add_u32 s48, s48, 3
    s_and_b32 s48, s48, 3
    s_lshl_b32 s49, s48, 5
    buffer_load_dwordx4 v[216:219], v8, s[4:7], s53 offen offset:1024
    s_mul_i32 s48, s48, 6144
    v_xor_b32 v179, s49, v10
    v_add_u32 v183, s48, v15
    v_add_u32 v187, s48, v40
    v_add_u32 v188, 81920, v176
    v_add_u32 v189, 81920, v177
    v_add_u32 v190, 81920, v178
    v_add_u32 v191, 81920, v179
    v_add_u32 v192, 81920, v180
    v_add_u32 v193, 81920, v181
    v_add_u32 v194, 81920, v182
    v_add_u32 v195, 81920, v183
    buffer_load_dwordx4 v3, s[4:7], s38 offen offset:2048 lds
    v_add_u32 v196, 81920, v184
    v_add_u32 v197, 81920, v185
    v_add_u32 v198, 81920, v186
    v_add_u32 v199, 81920, v187
    v_lshlrev_b32 v10, 4, v11
    v_min_u32 v11, 47, v0
    s_mul_i32 s48, s31, 192
    s_mul_i32 s49, s3, 48
    s_add_u32 s48, s48, s49
    v_add_lshl_u32 v12, v11, s48, 1
    v_add_lshl_u32 v11, v11, s49, 2
    buffer_load_dwordx4 v2, s[4:7], s39 offen offset:3072 lds
    v_add_u32 v11, 110592, v11
    s_mul_i32 s60, s3, 120
    s_mul_i32 s51, s31, 5
    s_lshr_b32 s51, s51, 2
    s_add_u32 s60, s60, s51
    s_lshl_b32 s60, s60, 6
    s_add_u32 s60, s60, 36864
    s_mul_i32 s47, s31, 240
    s_mul_i32 s51, s3, 12
    s_add_u32 s47, s47, s51
    s_lshl_b32 s47, s47, 10
    s_add_u32 s47, s47, 2097152
    s_waitcnt lgkmcnt(0)
    s_bitcmp1_b32 s28, 0
    s_cselect_b32 s32, 0x10000, 1
    s_cselect_b32 s82, 2, 1
    s_mul_i32 s28, s28, 0x9E3779B1
    s_add_u32 s28, s28, 0x7F4A7C15
    s_and_b32 s28, s28, 0xfffefffc
    s_or_b32 s28, s28, s32
    s_or_b32 s28, s28, s82
    s_xor_b32 s29, s28, 0x5bd1e995
    s_brev_b32 s29, s29
    s_mov_b32 s83, 0xfffefffe
    s_waitcnt vmcnt(9)
    s_barrier
L_mlp_code:
    ds_read_b128 v[128:131], v176 offset:0
    ds_read_b64_tr_b16 v[136:137], v180 offset:0
    ds_read_b64_tr_b16 v[138:139], v180 offset:1536
    ds_read_b128 v[132:135], v176 offset:4096
    ds_read_b64_tr_b16 v[140:141], v184 offset:64
    ds_read_b64_tr_b16 v[142:143], v184 offset:1600
    ds_read_b64_tr_b16 v[144:145], v180 offset:128
    ds_read_b64_tr_b16 v[146:147], v180 offset:1664
    s_add_u32 m0, s46, 40960
    v_add_u32 v4, s67, v4
    s_waitcnt lgkmcnt(5)
    v_mfma_f32_32x32x16_bf16 v[16:31], v[136:139], v[128:131], 0
    buffer_load_dwordx4 v4, s[8:11], s40 offen offset:0 lds
    ds_read_b128 v[148:151], v177 offset:0
    ds_read_b64_tr_b16 v[156:157], v181 offset:0
    ds_read_b64_tr_b16 v[158:159], v181 offset:1536
    s_waitcnt lgkmcnt(7)
    v_mfma_f32_32x32x16_bf16 v[32:47], v[136:139], v[132:135], 0
    ds_read_b128 v[152:155], v177 offset:4096
    ds_read_b64_tr_b16 v[160:161], v185 offset:64
    ds_read_b64_tr_b16 v[162:163], v185 offset:1600
    v_add_u32 v5, s67, v5
    s_waitcnt lgkmcnt(8)
    v_mfma_f32_32x32x16_bf16 v[48:63], v[140:143], v[128:131], 0
    buffer_load_dwordx4 v5, s[8:11], s40 offen offset:1024 lds
    ds_read_b64_tr_b16 v[164:165], v181 offset:128
    ds_read_b64_tr_b16 v[166:167], v181 offset:1664
    v_add_u32 v6, s67, v6
    v_mfma_f32_32x32x16_bf16 v[64:79], v[140:143], v[132:135], 0
    buffer_load_dwordx4 v6, s[8:11], s40 offen offset:2048 lds
    s_waitcnt lgkmcnt(8)
    v_mfma_f32_32x32x16_bf16 v[80:95], v[144:147], v[128:131], 0
    buffer_load_dwordx4 v4, s[8:11], s41 offen offset:3072 lds
    s_add_u32 m0, s46, 45056
    v_mfma_f32_32x32x16_bf16 v[96:111], v[144:147], v[132:135], 0
    buffer_load_dwordx4 v5, s[8:11], s44 offen offset:0 lds
    v_mfma_f32_4x4x4_16b_bf16 v[112:115], v[124:125], v[136:137], 0
    v_mfma_f32_4x4x4_16b_bf16 v[116:119], v[124:125], v[140:141], 0
    v_mfma_f32_4x4x4_16b_bf16 v[120:123], v[124:125], v[144:145], 0
    v_mfma_f32_4x4x4_16b_bf16 v[112:115], v[124:125], v[138:139], v[112:115]
    v_mfma_f32_4x4x4_16b_bf16 v[116:119], v[124:125], v[142:143], v[116:119]
    v_mfma_f32_4x4x4_16b_bf16 v[120:123], v[124:125], v[146:147], v[120:123]
    s_waitcnt lgkmcnt(5)
    v_mfma_f32_32x32x16_bf16 v[16:31], v[156:159], v[148:151], v[16:31]
    buffer_load_dwordx4 v6, s[8:11], s44 offen offset:1024 lds
    ds_read_b128 v[128:131], v178 offset:0
    ds_read_b64_tr_b16 v[136:137], v182 offset:0
    ds_read_b64_tr_b16 v[138:139], v182 offset:1536
    s_waitcnt lgkmcnt(7)
    v_mfma_f32_32x32x16_bf16 v[32:47], v[156:159], v[152:155], v[32:47]
    ds_read_b128 v[132:135], v178 offset:4096
    ds_read_b64_tr_b16 v[140:141], v186 offset:64
    ds_read_b64_tr_b16 v[142:143], v186 offset:1600
    s_add_u32 m0, s45, 147456
    s_waitcnt lgkmcnt(8)
    v_mfma_f32_32x32x16_bf16 v[48:63], v[160:163], v[148:151], v[48:63]
    s_add_u32 s50, s54, 0
    buffer_load_dwordx4 v253, s[24:27], s50 offen lds
    ds_read_b64_tr_b16 v[144:145], v182 offset:128
    ds_read_b64_tr_b16 v[146:147], v182 offset:1664
    s_add_u32 m0, s45, 148480
    v_mfma_f32_32x32x16_bf16 v[64:79], v[160:163], v[152:155], v[64:79]
    s_add_u32 s50, s54, 10240
    buffer_load_dwordx4 v253, s[24:27], s50 offen lds
    s_add_u32 m0, s45, 149504
    s_waitcnt lgkmcnt(8)
    v_mfma_f32_32x32x16_bf16 v[80:95], v[164:167], v[148:151], v[80:95]
    s_add_u32 s50, s54, 20480
    buffer_load_dwordx4 v253, s[24:27], s50 offen lds
    s_add_u32 m0, s45, 150528
    v_mfma_f32_32x32x16_bf16 v[96:111], v[164:167], v[152:155], v[96:111]
    s_add_u32 s50, s54, 30720
    buffer_load_dwordx4 v253, s[24:27], s50 offen lds
    v_mfma_f32_4x4x4_16b_bf16 v[112:115], v[124:125], v[156:157], v[112:115]
    v_mfma_f32_4x4x4_16b_bf16 v[116:119], v[124:125], v[160:161], v[116:119]
    v_mfma_f32_4x4x4_16b_bf16 v[120:123], v[124:125], v[164:165], v[120:123]
    v_mfma_f32_4x4x4_16b_bf16 v[112:115], v[124:125], v[158:159], v[112:115]
    v_mfma_f32_4x4x4_16b_bf16 v[116:119], v[124:125], v[162:163], v[116:119]
    v_mfma_f32_4x4x4_16b_bf16 v[120:123], v[124:125], v[166:167], v[120:123]
    s_add_u32 m0, s45, 106496
    s_xor_b32 s1, s2, 2
    s_sub_u32 s66, s1, s0
    s_mov_b32 s0, s1
    s_lshl_b32 s66, s66, 7
    s_mul_i32 s67, s66, 1536
    v_add_u32 v3, s66, v3
    s_waitcnt lgkmcnt(5)
    v_mfma_f32_32x32x16_bf16 v[16:31], v[136:139], v[128:131], v[16:31]
    buffer_load_dwordx4 v3, s[4:7], s36 offen offset:0 lds
    ds_read_b128 v[148:151], v179 offset:0
    ds_read_b64_tr_b16 v[156:157], v183 offset:0
    ds_read_b64_tr_b16 v[158:159], v183 offset:1536
    s_waitcnt lgkmcnt(7)
    v_mfma_f32_32x32x16_bf16 v[32:47], v[136:139], v[132:135], v[32:47]
    ds_read_b128 v[152:155], v179 offset:4096
    ds_read_b64_tr_b16 v[160:161], v187 offset:64
    ds_read_b64_tr_b16 v[162:163], v187 offset:1600
    v_add_u32 v2, s66, v2
    s_waitcnt lgkmcnt(8)
    v_mfma_f32_32x32x16_bf16 v[48:63], v[140:143], v[128:131], v[48:63]
    buffer_load_dwordx4 v2, s[4:7], s37 offen offset:1024 lds
    ds_read_b64_tr_b16 v[164:165], v183 offset:128
    ds_read_b64_tr_b16 v[166:167], v183 offset:1664
    v_mfma_f32_32x32x16_bf16 v[64:79], v[140:143], v[132:135], v[64:79]
    buffer_load_dwordx4 v3, s[4:7], s38 offen offset:2048 lds
    s_waitcnt lgkmcnt(8)
    v_mfma_f32_32x32x16_bf16 v[80:95], v[144:147], v[128:131], v[80:95]
    buffer_load_dwordx4 v2, s[4:7], s39 offen offset:3072 lds
    s_add_u32 m0, s46, 81920
    v_add_u32 v4, s67, v4
    v_mfma_f32_32x32x16_bf16 v[96:111], v[144:147], v[132:135], v[96:111]
    buffer_load_dwordx4 v4, s[8:11], s40 offen offset:0 lds
    v_add_u32 v5, s67, v5
    s_waitcnt lgkmcnt(5)
    v_mfma_f32_32x32x16_bf16 v[16:31], v[156:159], v[148:151], v[16:31]
    buffer_load_dwordx4 v5, s[8:11], s40 offen offset:1024 lds
    s_waitcnt lgkmcnt(4)
    v_mfma_f32_32x32x16_bf16 v[32:47], v[156:159], v[152:155], v[32:47]
    s_waitcnt vmcnt(18)
    s_mov_b32 s52, 0x3f803f80
    v_mov_b32 v221, s28
    v_mov_b32 v223, s29
    v_dot2_f32_bf16 v220, v200, s52, 0
    v_dot2_f32_bf16 v222, v200, v200, 0
    v_dot2_f32_bf16 v220, v201, s52, v220
    v_dot2_f32_bf16 v222, v201, v201, v222
    v_dot2_f32_bf16 v220, v202, s52, v220
    v_dot2_f32_bf16 v222, v202, v202, v222
    v_dot2_f32_bf16 v220, v203, s52, v220
    v_dot2_f32_bf16 v222, v203, v203, v222
    v_dot2_f32_bf16 v220, v204, s52, v220
    v_dot2_f32_bf16 v222, v204, v204, v222
    v_dot2_f32_bf16 v220, v205, s52, v220
    v_dot2_f32_bf16 v222, v205, v205, v222
    v_dot2_f32_bf16 v220, v206, s52, v220
    v_dot2_f32_bf16 v222, v206, v206, v222
    v_dot2_f32_bf16 v220, v207, s52, v220
    v_dot2_f32_bf16 v222, v207, v207, v222
    v_dot2_f32_bf16 v220, v208, s52, v220
    v_dot2_f32_bf16 v222, v208, v208, v222
    v_dot2_f32_bf16 v220, v209, s52, v220
    v_dot2_f32_bf16 v222, v209, v209, v222
    v_dot2_f32_bf16 v220, v210, s52, v220
    v_dot2_f32_bf16 v222, v210, v210, v222
    v_dot2_f32_bf16 v220, v211, s52, v220
    v_dot2_f32_bf16 v222, v211, v211, v222
    v_dot2_f32_bf16 v220, v212, s52, v220
    v_dot2_f32_bf16 v222, v212, v212, v222
    v_dot2_f32_bf16 v220, v213, s52, v220
    v_dot2_f32_bf16 v222, v213, v213, v222
    v_dot2_f32_bf16 v220, v214, s52, v220
    v_dot2_f32_bf16 v222, v214, v214, v222
    v_dot2_f32_bf16 v220, v215, s52, v220
    v_dot2_f32_bf16 v222, v215, v215, v222
    v_dot2_f32_bf16 v220, v216, s52, v220
    v_dot2_f32_bf16 v222, v216, v216, v222
    v_dot2_f32_bf16 v220, v217, s52, v220
    v_dot2_f32_bf16 v222, v217, v217, v222
    v_dot2_f32_bf16 v220, v218, s52, v220
    v_dot2_f32_bf16 v222, v218, v218, v222
    v_dot2_f32_bf16 v220, v219, s52, v220
    v_dot2_f32_bf16 v222, v219, v219, v222
    s_nop 1
    v_add_f32_dpp v220, v220, v220 row_ror:8 row_mask:0xf bank_mask:0xf
    v_add_f32_dpp v222, v222, v222 row_ror:8 row_mask:0xf bank_mask:0xf
    s_nop 0
    v_add_f32_dpp v220, v220, v220 row_ror:4 row_mask:0xf bank_mask:0xf
    v_add_f32_dpp v222, v222, v222 row_ror:4 row_mask:0xf bank_mask:0xf
    s_nop 0
    v_add_f32_dpp v220, v220, v220 row_ror:2 row_mask:0xf bank_mask:0xf
    v_add_f32_dpp v222, v222, v222 row_ror:2 row_mask:0xf bank_mask:0xf
    s_nop 0
    v_add_f32_dpp v220, v220, v220 row_ror:1 row_mask:0xf bank_mask:0xf
    v_add_f32_dpp v222, v222, v222 row_ror:1 row_mask:0xf bank_mask:0xf
    s_mov_b32 exec_lo, 0x00010001
    s_mov_b32 exec_hi, 0x00010001
    buffer_store_dwordx4 v[220:223], v9, s[12:15], s56 offen sc1
    s_mov_b64 exec, -1
    s_waitcnt vmcnt(11) lgkmcnt(0)
    s_barrier
    ds_read_b128 v[128:131], v176 offset:40960
    ds_read_b64_tr_b16 v[136:137], v180 offset:40960
    ds_read_b64_tr_b16 v[138:139], v180 offset:42496
    v_add_u32 v6, s67, v6
    v_mfma_f32_32x32x16_bf16 v[48:63], v[160:163], v[148:151], v[48:63]
    buffer_load_dwordx4 v6, s[8:11], s40 offen offset:2048 lds
    ds_read_b128 v[132:135], v176 offset:45056
    ds_read_b64_tr_b16 v[140:141], v184 offset:41024
    ds_read_b64_tr_b16 v[142:143], v184 offset:42560
    v_mfma_f32_32x32x16_bf16 v[64:79], v[160:163], v[152:155], v[64:79]
    buffer_load_dwordx4 v4, s[8:11], s41 offen offset:3072 lds
    ds_read_b64_tr_b16 v[144:145], v180 offset:41088
    ds_read_b64_tr_b16 v[146:147], v180 offset:42624
    s_add_u32 m0, s46, 86016
    v_mfma_f32_32x32x16_bf16 v[80:95], v[164:167], v[148:151], v[80:95]
    buffer_load_dwordx4 v5, s[8:11], s44 offen offset:0 lds
    v_mfma_f32_32x32x16_bf16 v[96:111], v[164:167], v[152:155], v[96:111]
    buffer_load_dwordx4 v6, s[8:11], s44 offen offset:1024 lds
    s_waitcnt lgkmcnt(5)
    v_mfma_f32_32x32x16_bf16 v[16:31], v[136:139], v[128:131], v[16:31]
    ds_read_b128 v[148:151], v177 offset:40960
    ds_read_b64_tr_b16 v[156:157], v181 offset:40960
    ds_read_b64_tr_b16 v[158:159], v181 offset:42496
    s_waitcnt lgkmcnt(7)
    v_mfma_f32_32x32x16_bf16 v[32:47], v[136:139], v[132:135], v[32:47]
    ds_read_b128 v[152:155], v177 offset:45056
    ds_read_b64_tr_b16 v[160:161], v185 offset:41024
    ds_read_b64_tr_b16 v[162:163], v185 offset:42560
    s_waitcnt lgkmcnt(8)
    v_mfma_f32_32x32x16_bf16 v[48:63], v[140:143], v[128:131], v[48:63]
    ds_read_b64_tr_b16 v[164:165], v181 offset:41088
    ds_read_b64_tr_b16 v[166:167], v181 offset:42624
    v_mfma_f32_32x32x16_bf16 v[64:79], v[140:143], v[132:135], v[64:79]
    s_waitcnt lgkmcnt(8)
    v_mfma_f32_32x32x16_bf16 v[80:95], v[144:147], v[128:131], v[80:95]
    v_mfma_f32_32x32x16_bf16 v[96:111], v[144:147], v[132:135], v[96:111]
    s_waitcnt vmcnt(11)
    ds_read_b64_tr_b16 a[240:241], v7 offset:0
    ds_read_b64_tr_b16 a[242:243], v7 offset:1024
    ds_read_b64_tr_b16 a[244:245], v7 offset:32
    ds_read_b64_tr_b16 a[246:247], v7 offset:1056
    ds_read_b64_tr_b16 a[248:249], v7 offset:64
    ds_read_b64_tr_b16 a[250:251], v7 offset:1088
    s_waitcnt lgkmcnt(9)
    ds_read_b64_tr_b16 a[252:253], v7 offset:96
    ds_read_b64_tr_b16 a[254:255], v7 offset:1120
    v_mfma_f32_4x4x4_16b_bf16 v[112:115], v[124:125], v[136:137], v[112:115]
    v_mfma_f32_4x4x4_16b_bf16 v[116:119], v[124:125], v[140:141], v[116:119]
    v_mfma_f32_4x4x4_16b_bf16 v[120:123], v[124:125], v[144:145], v[120:123]
    v_mfma_f32_4x4x4_16b_bf16 v[112:115], v[124:125], v[138:139], v[112:115]
    v_mfma_f32_4x4x4_16b_bf16 v[116:119], v[124:125], v[142:143], v[116:119]
    v_mfma_f32_4x4x4_16b_bf16 v[120:123], v[124:125], v[146:147], v[120:123]
    v_mfma_f32_32x32x16_bf16 v[16:31], v[156:159], v[148:151], v[16:31]
    ds_read_b128 v[128:131], v178 offset:40960
    ds_read_b64_tr_b16 v[136:137], v182 offset:40960
    ds_read_b64_tr_b16 v[138:139], v182 offset:42496
    v_min_u32 v253, 23, v0
    v_lshrrev_b32 v254, 1, v253
    v_mfma_f32_32x32x16_bf16 v[32:47], v[156:159], v[152:155], v[32:47]
    s_waitcnt lgkmcnt(9)
    ds_read_b128 v[132:135], v178 offset:45056
    ds_read_b64_tr_b16 v[140:141], v186 offset:41024
    ds_read_b64_tr_b16 v[142:143], v186 offset:42560
    v_lshlrev_b32 v254, 3, v254
    v_mfma_f32_32x32x16_bf16 v[48:63], v[160:163], v[148:151], v[48:63]
    s_waitcnt lgkmcnt(6)
    s_add_u32 s48, s58, 0
    buffer_store_dwordx4 a[240:243], v252, s[12:15], s48 offen sc1
    ds_read_b64_tr_b16 v[144:145], v182 offset:41088
    ds_read_b64_tr_b16 v[146:147], v182 offset:42624
    v_mfma_f32_32x32x16_bf16 v[64:79], v[160:163], v[152:155], v[64:79]
    s_add_u32 s48, s58, 49152
    buffer_store_dwordx4 a[244:247], v252, s[12:15], s48 offen sc1
    v_add_lshl_u32 v253, v253, v254, 6
    v_mfma_f32_32x32x16_bf16 v[80:95], v[164:167], v[148:151], v[80:95]
    s_add_u32 s48, s58, 98304
    buffer_store_dwordx4 a[248:251], v252, s[12:15], s48 offen sc1
    v_mfma_f32_32x32x16_bf16 v[96:111], v[164:167], v[152:155], v[96:111]
    s_add_u32 s48, s58, 147456
    buffer_store_dwordx4 a[252:255], v252, s[12:15], s48 offen sc1
    v_mfma_f32_4x4x4_16b_bf16 v[112:115], v[124:125], v[156:157], v[112:115]
    v_mfma_f32_4x4x4_16b_bf16 v[116:119], v[124:125], v[160:161], v[116:119]
    v_mfma_f32_4x4x4_16b_bf16 v[120:123], v[124:125], v[164:165], v[120:123]
    v_mfma_f32_4x4x4_16b_bf16 v[112:115], v[124:125], v[158:159], v[112:115]
    v_mfma_f32_4x4x4_16b_bf16 v[116:119], v[124:125], v[162:163], v[116:119]
    v_mfma_f32_4x4x4_16b_bf16 v[120:123], v[124:125], v[166:167], v[120:123]
    s_waitcnt lgkmcnt(5)
    v_mfma_f32_32x32x16_bf16 v[16:31], v[136:139], v[128:131], v[16:31]
    ds_read_b128 v[148:151], v179 offset:40960
    ds_read_b64_tr_b16 v[156:157], v183 offset:40960
    ds_read_b64_tr_b16 v[158:159], v183 offset:42496
    s_waitcnt lgkmcnt(7)
    v_mfma_f32_32x32x16_bf16 v[32:47], v[136:139], v[132:135], v[32:47]
    ds_read_b128 v[152:155], v179 offset:45056
    ds_read_b64_tr_b16 v[160:161], v187 offset:41024
    ds_read_b64_tr_b16 v[162:163], v187 offset:42560
    s_add_u32 m0, s46, 122880
    s_xor_b32 s1, s2, 3
    s_sub_u32 s66, s1, s0
    s_mov_b32 s0, s1
    s_lshl_b32 s66, s66, 7
    s_mul_i32 s67, s66, 1536
    v_add_u32 v4, s67, v4
    s_waitcnt lgkmcnt(8)
    v_mfma_f32_32x32x16_bf16 v[48:63], v[140:143], v[128:131], v[48:63]
    buffer_load_dwordx4 v4, s[8:11], s40 offen offset:0 lds
    ds_read_b64_tr_b16 v[164:165], v183 offset:41088
    ds_read_b64_tr_b16 v[166:167], v183 offset:42624
    v_mfma_f32_32x32x16_bf16 v[64:79], v[140:143], v[132:135], v[64:79]
    v_add_u32 v5, s67, v5
    s_waitcnt lgkmcnt(8)
    v_mfma_f32_32x32x16_bf16 v[80:95], v[144:147], v[128:131], v[80:95]
    buffer_load_dwordx4 v5, s[8:11], s40 offen offset:1024 lds
    v_add_u32 v6, s67, v6
    v_mfma_f32_32x32x16_bf16 v[96:111], v[144:147], v[132:135], v[96:111]
    buffer_load_dwordx4 v6, s[8:11], s40 offen offset:2048 lds
    s_waitcnt lgkmcnt(5)
    v_mfma_f32_32x32x16_bf16 v[16:31], v[156:159], v[148:151], v[16:31]
    buffer_load_dwordx4 v4, s[8:11], s41 offen offset:3072 lds
    s_waitcnt lgkmcnt(4)
    v_mfma_f32_32x32x16_bf16 v[32:47], v[156:159], v[152:155], v[32:47]
    s_waitcnt vmcnt(8) lgkmcnt(0)
    s_barrier
    ds_read_b128 v[128:131], v188 offset:0
    ds_read_b64_tr_b16 v[136:137], v192 offset:0
    ds_read_b64_tr_b16 v[138:139], v192 offset:1536
    v_mfma_f32_32x32x16_bf16 v[48:63], v[160:163], v[148:151], v[48:63]
    ds_read_b128 v[132:135], v188 offset:4096
    ds_read_b64_tr_b16 v[140:141], v196 offset:64
    ds_read_b64_tr_b16 v[142:143], v196 offset:1600
    v_mfma_f32_32x32x16_bf16 v[64:79], v[160:163], v[152:155], v[64:79]
    ds_read_b64_tr_b16 v[144:145], v192 offset:128
    ds_read_b64_tr_b16 v[146:147], v192 offset:1664
    s_add_u32 m0, s46, 126976
    v_mfma_f32_32x32x16_bf16 v[80:95], v[164:167], v[148:151], v[80:95]
    buffer_load_dwordx4 v5, s[8:11], s44 offen offset:0 lds
    v_mfma_f32_32x32x16_bf16 v[96:111], v[164:167], v[152:155], v[96:111]
    buffer_load_dwordx4 v6, s[8:11], s44 offen offset:1024 lds
    s_waitcnt lgkmcnt(5)
    v_mfma_f32_32x32x16_bf16 v[16:31], v[136:139], v[128:131], v[16:31]
    ds_read_b128 v[148:151], v189 offset:0
    ds_read_b64_tr_b16 v[156:157], v193 offset:0
    ds_read_b64_tr_b16 v[158:159], v193 offset:1536
    s_waitcnt lgkmcnt(7)
    v_mfma_f32_32x32x16_bf16 v[32:47], v[136:139], v[132:135], v[32:47]
    ds_read_b128 v[152:155], v189 offset:4096
    ds_read_b64_tr_b16 v[160:161], v197 offset:64
    ds_read_b64_tr_b16 v[162:163], v197 offset:1600
    s_add_u32 m0, s45, 147456
    v_add_u32 v3, s66, v3
    s_waitcnt lgkmcnt(8)
    v_mfma_f32_32x32x16_bf16 v[48:63], v[140:143], v[128:131], v[48:63]
    buffer_load_dwordx4 v3, s[4:7], s36 offen offset:0 lds
    ds_read_b64_tr_b16 v[164:165], v193 offset:128
    ds_read_b64_tr_b16 v[166:167], v193 offset:1664
    v_add_u32 v2, s66, v2
    v_mfma_f32_32x32x16_bf16 v[64:79], v[140:143], v[132:135], v[64:79]
    buffer_load_dwordx4 v2, s[4:7], s37 offen offset:1024 lds
    s_waitcnt lgkmcnt(8)
    v_mfma_f32_32x32x16_bf16 v[80:95], v[144:147], v[128:131], v[80:95]
    buffer_load_dwordx4 v3, s[4:7], s38 offen offset:2048 lds
    v_mfma_f32_32x32x16_bf16 v[96:111], v[144:147], v[132:135], v[96:111]
    buffer_load_dwordx4 v2, s[4:7], s39 offen offset:3072 lds
    v_mfma_f32_4x4x4_16b_bf16 v[112:115], v[124:125], v[136:137], v[112:115]
    v_mfma_f32_4x4x4_16b_bf16 v[116:119], v[124:125], v[140:141], v[116:119]
    v_mfma_f32_4x4x4_16b_bf16 v[120:123], v[124:125], v[144:145], v[120:123]
    v_mfma_f32_4x4x4_16b_bf16 v[112:115], v[124:125], v[138:139], v[112:115]
    v_mfma_f32_4x4x4_16b_bf16 v[116:119], v[124:125], v[142:143], v[116:119]
    v_mfma_f32_4x4x4_16b_bf16 v[120:123], v[124:125], v[146:147], v[120:123]
    s_waitcnt lgkmcnt(5)
    v_mfma_f32_32x32x16_bf16 v[16:31], v[156:159], v[148:151], v[16:31]
    ds_read_b128 v[128:131], v190 offset:0
    ds_read_b64_tr_b16 v[136:137], v194 offset:0
    ds_read_b64_tr_b16 v[138:139], v194 offset:1536
    s_waitcnt lgkmcnt(7)
    v_mfma_f32_32x32x16_bf16 v[32:47], v[156:159], v[152:155], v[32:47]
    ds_read_b128 v[132:135], v190 offset:4096
    ds_read_b64_tr_b16 v[140:141], v198 offset:64
    ds_read_b64_tr_b16 v[142:143], v198 offset:1600
    s_add_u32 m0, s45, 24576
    s_xor_b32 s1, s2, 4
    s_sub_u32 s66, s1, s0
    s_mov_b32 s0, s1
    s_lshl_b32 s66, s66, 7
    s_mul_i32 s67, s66, 1536
    v_add_u32 v3, s66, v3
    s_waitcnt lgkmcnt(8)
    v_mfma_f32_32x32x16_bf16 v[48:63], v[160:163], v[148:151], v[48:63]
    buffer_load_dwordx4 v3, s[4:7], s36 offen offset:0 lds
    ds_read_b64_tr_b16 v[144:145], v194 offset:128
    ds_read_b64_tr_b16 v[146:147], v194 offset:1664
    v_add_u32 v2, s66, v2
    v_mfma_f32_32x32x16_bf16 v[64:79], v[160:163], v[152:155], v[64:79]
    buffer_load_dwordx4 v2, s[4:7], s37 offen offset:1024 lds
    s_waitcnt lgkmcnt(8)
    v_mfma_f32_32x32x16_bf16 v[80:95], v[164:167], v[148:151], v[80:95]
    buffer_load_dwordx4 v3, s[4:7], s38 offen offset:2048 lds
    v_mfma_f32_32x32x16_bf16 v[96:111], v[164:167], v[152:155], v[96:111]
    buffer_load_dwordx4 v2, s[4:7], s39 offen offset:3072 lds
    v_mfma_f32_4x4x4_16b_bf16 v[112:115], v[124:125], v[156:157], v[112:115]
    v_mfma_f32_4x4x4_16b_bf16 v[116:119], v[124:125], v[160:161], v[116:119]
    v_mfma_f32_4x4x4_16b_bf16 v[120:123], v[124:125], v[164:165], v[120:123]
    v_mfma_f32_4x4x4_16b_bf16 v[112:115], v[124:125], v[158:159], v[112:115]
    v_mfma_f32_4x4x4_16b_bf16 v[116:119], v[124:125], v[162:163], v[116:119]
    v_mfma_f32_4x4x4_16b_bf16 v[120:123], v[124:125], v[166:167], v[120:123]
    s_waitcnt lgkmcnt(5)
    v_mfma_f32_32x32x16_bf16 v[16:31], v[136:139], v[128:131], v[16:31]
    ds_read_b128 v[148:151], v191 offset:0
    ds_read_b64_tr_b16 v[156:157], v195 offset:0
    ds_read_b64_tr_b16 v[158:159], v195 offset:1536
    s_waitcnt lgkmcnt(7)
    v_mfma_f32_32x32x16_bf16 v[32:47], v[136:139], v[132:135], v[32:47]
    ds_read_b128 v[152:155], v191 offset:4096
    ds_read_b64_tr_b16 v[160:161], v199 offset:64
    ds_read_b64_tr_b16 v[162:163], v199 offset:1600
    s_add_u32 m0, s46, 0
    v_add_u32 v4, s67, v4
    s_waitcnt lgkmcnt(8)
    v_mfma_f32_32x32x16_bf16 v[48:63], v[140:143], v[128:131], v[48:63]
    buffer_load_dwordx4 v4, s[8:11], s40 offen offset:0 lds
    ds_read_b64_tr_b16 v[164:165], v195 offset:128
    ds_read_b64_tr_b16 v[166:167], v195 offset:1664
    v_mfma_f32_32x32x16_bf16 v[64:79], v[140:143], v[132:135], v[64:79]
    v_add_u32 v5, s67, v5
    s_waitcnt lgkmcnt(8)
    v_mfma_f32_32x32x16_bf16 v[80:95], v[144:147], v[128:131], v[80:95]
    buffer_load_dwordx4 v5, s[8:11], s40 offen offset:1024 lds
    v_add_u32 v6, s67, v6
    v_mfma_f32_32x32x16_bf16 v[96:111], v[144:147], v[132:135], v[96:111]
    buffer_load_dwordx4 v6, s[8:11], s40 offen offset:2048 lds
    s_waitcnt lgkmcnt(5)
    v_mfma_f32_32x32x16_bf16 v[16:31], v[156:159], v[148:151], v[16:31]
    buffer_load_dwordx4 v4, s[8:11], s41 offen offset:3072 lds
    s_waitcnt lgkmcnt(4)
    v_mfma_f32_32x32x16_bf16 v[32:47], v[156:159], v[152:155], v[32:47]
    s_waitcnt vmcnt(8) lgkmcnt(0)
    s_barrier
    ds_read_b128 v[128:131], v188 offset:40960
    ds_read_b64_tr_b16 v[136:137], v192 offset:40960
    ds_read_b64_tr_b16 v[138:139], v192 offset:42496
    v_mfma_f32_32x32x16_bf16 v[48:63], v[160:163], v[148:151], v[48:63]
    ds_read_b128 v[132:135], v188 offset:45056
    ds_read_b64_tr_b16 v[140:141], v196 offset:41024
    ds_read_b64_tr_b16 v[142:143], v196 offset:42560
    v_mfma_f32_32x32x16_bf16 v[64:79], v[160:163], v[152:155], v[64:79]
    ds_read_b64_tr_b16 v[144:145], v192 offset:41088
    ds_read_b64_tr_b16 v[146:147], v192 offset:42624
    s_add_u32 m0, s46, 4096
    v_mfma_f32_32x32x16_bf16 v[80:95], v[164:167], v[148:151], v[80:95]
    buffer_load_dwordx4 v5, s[8:11], s44 offen offset:0 lds
    v_mfma_f32_32x32x16_bf16 v[96:111], v[164:167], v[152:155], v[96:111]
    buffer_load_dwordx4 v6, s[8:11], s44 offen offset:1024 lds
    s_waitcnt lgkmcnt(5)
    v_mfma_f32_32x32x16_bf16 v[16:31], v[136:139], v[128:131], v[16:31]
    ds_read_b128 v[148:151], v189 offset:40960
    ds_read_b64_tr_b16 v[156:157], v193 offset:40960
    ds_read_b64_tr_b16 v[158:159], v193 offset:42496
    s_waitcnt lgkmcnt(7)
    v_mfma_f32_32x32x16_bf16 v[32:47], v[136:139], v[132:135], v[32:47]
    ds_read_b128 v[152:155], v189 offset:45056
    ds_read_b64_tr_b16 v[160:161], v197 offset:41024
    ds_read_b64_tr_b16 v[162:163], v197 offset:42560
    s_waitcnt lgkmcnt(8)
    v_mfma_f32_32x32x16_bf16 v[48:63], v[140:143], v[128:131], v[48:63]
    global_load_ushort v126, v12, s[86:87]
    ds_read_b64_tr_b16 v[164:165], v193 offset:41088
    ds_read_b64_tr_b16 v[166:167], v193 offset:42624
    s_add_u32 m0, s45, 65536
    s_xor_b32 s1, s2, 5
    s_sub_u32 s66, s1, s0
    s_mov_b32 s0, s1
    s_lshl_b32 s66, s66, 7
    s_mul_i32 s67, s66, 1536
    v_add_u32 v3, s66, v3
    v_mfma_f32_32x32x16_bf16 v[64:79], v[140:143], v[132:135], v[64:79]
    buffer_load_dwordx4 v3, s[4:7], s36 offen offset:0 lds
    v_add_u32 v2, s66, v2
    s_waitcnt lgkmcnt(8)
    v_mfma_f32_32x32x16_bf16 v[80:95], v[144:147], v[128:131], v[80:95]
    buffer_load_dwordx4 v2, s[4:7], s37 offen offset:1024 lds
    v_mfma_f32_32x32x16_bf16 v[96:111], v[144:147], v[132:135], v[96:111]
    buffer_load_dwordx4 v3, s[4:7], s38 offen offset:2048 lds
    v_mov_b32 v13, s28
    s_mov_b64 exec, 1
    buffer_store_dword v13, off, s[12:15], s62 offset:0 sc1
    s_mov_b64 exec, -1
    v_mfma_f32_4x4x4_16b_bf16 v[112:115], v[124:125], v[136:137], v[112:115]
    v_mfma_f32_4x4x4_16b_bf16 v[116:119], v[124:125], v[140:141], v[116:119]
    v_mfma_f32_4x4x4_16b_bf16 v[120:123], v[124:125], v[144:145], v[120:123]
    v_mfma_f32_4x4x4_16b_bf16 v[112:115], v[124:125], v[138:139], v[112:115]
    v_mfma_f32_4x4x4_16b_bf16 v[116:119], v[124:125], v[142:143], v[116:119]
    v_mfma_f32_4x4x4_16b_bf16 v[120:123], v[124:125], v[146:147], v[120:123]
    s_waitcnt lgkmcnt(5)
    v_mfma_f32_32x32x16_bf16 v[16:31], v[156:159], v[148:151], v[16:31]
    ds_read_b128 v[128:131], v190 offset:40960
    ds_read_b64_tr_b16 v[136:137], v194 offset:40960
    ds_read_b64_tr_b16 v[138:139], v194 offset:42496
    v_and_b32 v200, 15, v0
    v_mul_u32_u24 v201, 336, v200
    s_waitcnt lgkmcnt(7)
    v_mfma_f32_32x32x16_bf16 v[32:47], v[156:159], v[152:155], v[32:47]
    ds_read_b128 v[132:135], v190 offset:45056
    ds_read_b64_tr_b16 v[140:141], v198 offset:41024
    ds_read_b64_tr_b16 v[142:143], v198 offset:42560
    v_lshrrev_b32 v200, 4, v0
    v_lshl_add_u32 v201, v200, 4, v201
    s_waitcnt lgkmcnt(8)
    v_mfma_f32_32x32x16_bf16 v[48:63], v[160:163], v[148:151], v[48:63]
    buffer_load_dwordx4 v2, s[4:7], s39 offen offset:3072 lds
    ds_read_b64_tr_b16 v[144:145], v194 offset:41088
    ds_read_b64_tr_b16 v[146:147], v194 offset:42624
    s_mul_i32 s50, s3, 21504
    s_add_u32 s50, s50, 16384
    s_add_u32 m0, s46, 40960
    v_add_u32 v4, s67, v4
    v_mfma_f32_32x32x16_bf16 v[64:79], v[160:163], v[152:155], v[64:79]
    buffer_load_dwordx4 v4, s[8:11], s40 offen offset:0 lds
    v_add_u32 v201, s50, v201
    v_accvgpr_write_b32 a240, v201
    s_mul_i32 s50, s3, 5376
    s_add_u32 s50, s50, 16384
    v_add_u32 v5, s67, v5
    s_waitcnt lgkmcnt(8)
    v_mfma_f32_32x32x16_bf16 v[80:95], v[164:167], v[148:151], v[80:95]
    buffer_load_dwordx4 v5, s[8:11], s40 offen offset:1024 lds
    v_add_u32 v200, 0, v0
    v_mul_u32_u24 v201, 3277, v200
    v_lshrrev_b32 v201, 16, v201
    v_mul_u32_u24 v202, 20, v201
    v_add_u32 v6, s67, v6
    v_mfma_f32_32x32x16_bf16 v[96:111], v[164:167], v[152:155], v[96:111]
    buffer_load_dwordx4 v6, s[8:11], s40 offen offset:2048 lds
    v_sub_u32 v202, v200, v202
    v_lshlrev_b32 v202, 4, v202
    v_mul_u32_u24 v203, 336, v201
    v_add3_u32 v203, v203, v202, s50
    v_mfma_f32_4x4x4_16b_bf16 v[112:115], v[124:125], v[156:157], v[112:115]
    v_mfma_f32_4x4x4_16b_bf16 v[116:119], v[124:125], v[160:161], v[116:119]
    v_mfma_f32_4x4x4_16b_bf16 v[120:123], v[124:125], v[164:165], v[120:123]
    v_mfma_f32_4x4x4_16b_bf16 v[112:115], v[124:125], v[158:159], v[112:115]
    v_mfma_f32_4x4x4_16b_bf16 v[116:119], v[124:125], v[162:163], v[116:119]
    v_mfma_f32_4x4x4_16b_bf16 v[120:123], v[124:125], v[166:167], v[120:123]
    s_waitcnt lgkmcnt(5)
    v_mfma_f32_32x32x16_bf16 v[16:31], v[136:139], v[128:131], v[16:31]
    ds_read_b128 v[148:151], v191 offset:40960
    ds_read_b64_tr_b16 v[156:157], v195 offset:40960
    ds_read_b64_tr_b16 v[158:159], v195 offset:42496
    v_accvgpr_write_b32 a241, v203
    v_mul_u32_u24 v203, 2560, v201
    s_waitcnt lgkmcnt(7)
    v_mfma_f32_32x32x16_bf16 v[32:47], v[136:139], v[132:135], v[32:47]
    ds_read_b128 v[152:155], v191 offset:45056
    ds_read_b64_tr_b16 v[160:161], v199 offset:41024
    ds_read_b64_tr_b16 v[162:163], v199 offset:42560
    v_add_u32 v203, v203, v202
    v_accvgpr_write_b32 a246, v203
    s_waitcnt lgkmcnt(8)
    v_mfma_f32_32x32x16_bf16 v[48:63], v[140:143], v[128:131], v[48:63]
    buffer_load_dwordx4 v4, s[8:11], s41 offen offset:3072 lds
    ds_read_b64_tr_b16 v[164:165], v195 offset:41088
    ds_read_b64_tr_b16 v[166:167], v195 offset:42624
    v_add_u32 v200, 64, v0
    v_mul_u32_u24 v201, 3277, v200
    v_mfma_f32_32x32x16_bf16 v[64:79], v[140:143], v[132:135], v[64:79]
    v_lshrrev_b32 v201, 16, v201
    v_mul_u32_u24 v202, 20, v201
    v_sub_u32 v202, v200, v202
    v_lshlrev_b32 v202, 4, v202
    v_mul_u32_u24 v203, 336, v201
    s_add_u32 m0, s46, 45056
    s_waitcnt lgkmcnt(8)
    v_mfma_f32_32x32x16_bf16 v[80:95], v[144:147], v[128:131], v[80:95]
    buffer_load_dwordx4 v5, s[8:11], s44 offen offset:0 lds
    v_add3_u32 v203, v203, v202, s50
    v_accvgpr_write_b32 a242, v203
    v_mul_u32_u24 v203, 2560, v201
    v_add_u32 v203, v203, v202
    v_mfma_f32_32x32x16_bf16 v[96:111], v[144:147], v[132:135], v[96:111]
    buffer_load_dwordx4 v6, s[8:11], s44 offen offset:1024 lds
    v_accvgpr_write_b32 a247, v203
    v_add_u32 v200, 128, v0
    v_mul_u32_u24 v201, 3277, v200
    v_lshrrev_b32 v201, 16, v201
    s_add_u32 m0, s45, 106496
    s_xor_b32 s1, s2, 6
    s_sub_u32 s66, s1, s0
    s_mov_b32 s0, s1
    s_lshl_b32 s66, s66, 7
    s_mul_i32 s67, s66, 1536
    v_add_u32 v3, s66, v3
    s_waitcnt lgkmcnt(5)
    v_mfma_f32_32x32x16_bf16 v[16:31], v[156:159], v[148:151], v[16:31]
    buffer_load_dwordx4 v3, s[4:7], s36 offen offset:0 lds
    v_mul_u32_u24 v202, 20, v201
    v_sub_u32 v202, v200, v202
    v_lshlrev_b32 v202, 4, v202
    v_mul_u32_u24 v203, 336, v201
    s_waitcnt lgkmcnt(4)
    v_mfma_f32_32x32x16_bf16 v[32:47], v[156:159], v[152:155], v[32:47]
    s_waitcnt vmcnt(13) lgkmcnt(0)
    s_barrier
    ds_read_b128 v[128:131], v176 offset:0
    ds_read_b64_tr_b16 v[136:137], v180 offset:0
    ds_read_b64_tr_b16 v[138:139], v180 offset:1536
    v_mfma_f32_32x32x16_bf16 v[48:63], v[160:163], v[148:151], v[48:63]
    ds_read_b128 v[132:135], v176 offset:4096
    ds_read_b64_tr_b16 v[140:141], v184 offset:64
    ds_read_b64_tr_b16 v[142:143], v184 offset:1600
    v_add3_u32 v203, v203, v202, s50
    v_accvgpr_write_b32 a243, v203
    v_mfma_f32_32x32x16_bf16 v[64:79], v[160:163], v[152:155], v[64:79]
    ds_read_b64_tr_b16 v[144:145], v180 offset:128
    ds_read_b64_tr_b16 v[146:147], v180 offset:1664
    v_mul_u32_u24 v203, 2560, v201
    v_add_u32 v203, v203, v202
    v_accvgpr_write_b32 a248, v203
    v_add_u32 v2, s66, v2
    v_mfma_f32_32x32x16_bf16 v[80:95], v[164:167], v[148:151], v[80:95]
    buffer_load_dwordx4 v2, s[4:7], s37 offen offset:1024 lds
    v_add_u32 v200, 192, v0
    v_mul_u32_u24 v201, 3277, v200
    v_lshrrev_b32 v201, 16, v201
    v_mul_u32_u24 v202, 20, v201
    v_mfma_f32_32x32x16_bf16 v[96:111], v[164:167], v[152:155], v[96:111]
    buffer_load_dwordx4 v3, s[4:7], s38 offen offset:2048 lds
    v_sub_u32 v202, v200, v202
    v_lshlrev_b32 v202, 4, v202
    v_mul_u32_u24 v203, 336, v201
    v_add3_u32 v203, v203, v202, s50
    s_waitcnt lgkmcnt(5)
    v_mfma_f32_32x32x16_bf16 v[16:31], v[136:139], v[128:131], v[16:31]
    ds_read_b128 v[148:151], v177 offset:0
    ds_read_b64_tr_b16 v[156:157], v181 offset:0
    ds_read_b64_tr_b16 v[158:159], v181 offset:1536
    v_accvgpr_write_b32 a244, v203
    v_mul_u32_u24 v203, 2560, v201
    s_waitcnt lgkmcnt(7)
    v_mfma_f32_32x32x16_bf16 v[32:47], v[136:139], v[132:135], v[32:47]
    ds_read_b128 v[152:155], v177 offset:4096
    ds_read_b64_tr_b16 v[160:161], v185 offset:64
    ds_read_b64_tr_b16 v[162:163], v185 offset:1600
    v_add_u32 v203, v203, v202
    v_accvgpr_write_b32 a249, v203
    s_waitcnt lgkmcnt(8)
    v_mfma_f32_32x32x16_bf16 v[48:63], v[140:143], v[128:131], v[48:63]
    buffer_load_dwordx4 v2, s[4:7], s39 offen offset:3072 lds
    ds_read_b64_tr_b16 v[164:165], v181 offset:128
    ds_read_b64_tr_b16 v[166:167], v181 offset:1664
    v_add_u32 v200, 256, v0
    v_mul_u32_u24 v201, 3277, v200
    s_add_u32 m0, s46, 81920
    v_add_u32 v4, s67, v4
    v_mfma_f32_32x32x16_bf16 v[64:79], v[140:143], v[132:135], v[64:79]
    buffer_load_dwordx4 v4, s[8:11], s40 offen offset:0 lds
    v_lshrrev_b32 v201, 16, v201
    v_mul_u32_u24 v202, 20, v201
    v_sub_u32 v202, v200, v202
    v_lshlrev_b32 v202, 4, v202
    v_add_u32 v5, s67, v5
    s_waitcnt lgkmcnt(8)
    v_mfma_f32_32x32x16_bf16 v[80:95], v[144:147], v[128:131], v[80:95]
    buffer_load_dwordx4 v5, s[8:11], s40 offen offset:1024 lds
    v_mul_u32_u24 v203, 336, v201
    v_add3_u32 v203, v203, v202, s50
    v_accvgpr_write_b32 a245, v203
    v_mul_u32_u24 v203, 2560, v201
    v_add_u32 v6, s67, v6
    v_mfma_f32_32x32x16_bf16 v[96:111], v[144:147], v[132:135], v[96:111]
    buffer_load_dwordx4 v6, s[8:11], s40 offen offset:2048 lds
    v_add_u32 v203, v203, v202
    v_accvgpr_write_b32 a250, v203
    s_lshl_b32 s50, s30, 5
    s_lshl_b32 s51, s3, 3
    v_mfma_f32_4x4x4_16b_bf16 v[112:115], v[124:125], v[136:137], v[112:115]
    v_mfma_f32_4x4x4_16b_bf16 v[116:119], v[124:125], v[140:141], v[116:119]
    v_mfma_f32_4x4x4_16b_bf16 v[120:123], v[124:125], v[144:145], v[120:123]
    v_mfma_f32_4x4x4_16b_bf16 v[112:115], v[124:125], v[138:139], v[112:115]
    v_mfma_f32_4x4x4_16b_bf16 v[116:119], v[124:125], v[142:143], v[116:119]
    v_mfma_f32_4x4x4_16b_bf16 v[120:123], v[124:125], v[146:147], v[120:123]
    s_waitcnt lgkmcnt(5)
    v_mfma_f32_32x32x16_bf16 v[16:31], v[156:159], v[148:151], v[16:31]
    ds_read_b128 v[128:131], v178 offset:0
    ds_read_b64_tr_b16 v[136:137], v182 offset:0
    ds_read_b64_tr_b16 v[138:139], v182 offset:1536
    s_add_u32 s50, s50, s51
    s_lshl_b32 s50, s50, 6
    s_waitcnt lgkmcnt(7)
    v_mfma_f32_32x32x16_bf16 v[32:47], v[156:159], v[152:155], v[32:47]
    ds_read_b128 v[132:135], v178 offset:4096
    ds_read_b64_tr_b16 v[140:141], v186 offset:64
    ds_read_b64_tr_b16 v[142:143], v186 offset:1600
    s_add_u32 s95, s50, 102400
    s_lshr_b32 s50, s33, 2
    s_waitcnt lgkmcnt(8)
    v_mfma_f32_32x32x16_bf16 v[48:63], v[160:163], v[148:151], v[48:63]
    buffer_load_dwordx4 v4, s[8:11], s41 offen offset:3072 lds
    ds_read_b64_tr_b16 v[144:145], v182 offset:128
    ds_read_b64_tr_b16 v[146:147], v182 offset:1664
    s_mul_i32 s50, s50, 20480
    s_mul_i32 s51, s3, 5120
    s_add_u32 m0, s46, 86016
    v_mfma_f32_32x32x16_bf16 v[64:79], v[160:163], v[152:155], v[64:79]
    buffer_load_dwordx4 v5, s[8:11], s44 offen offset:0 lds
    s_add_u32 s50, s50, s51
    s_add_u32 s88, s50, 15728640
    s_add_u32 s89, s88, 4096
    s_add_u32 s96, s50, 18350080
    s_waitcnt lgkmcnt(8)
    v_mfma_f32_32x32x16_bf16 v[80:95], v[164:167], v[148:151], v[80:95]
    buffer_load_dwordx4 v6, s[8:11], s44 offen offset:1024 lds
    s_add_u32 s97, s96, 4096
    s_lshl_b32 s50, s30, 7
    s_lshl_b32 s51, s3, 4
    s_add_u32 s50, s50, s51
    s_add_u32 m0, s45, 147456
    s_xor_b32 s1, s2, 7
    s_sub_u32 s66, s1, s0
    s_mov_b32 s0, s1
    s_lshl_b32 s66, s66, 7
    s_mul_i32 s67, s66, 1536
    v_add_u32 v3, s66, v3
    v_mfma_f32_32x32x16_bf16 v[96:111], v[164:167], v[152:155], v[96:111]
    buffer_load_dwordx4 v3, s[4:7], s36 offen offset:0 lds
    s_add_u32 s50, s50, 0
    s_mul_i32 s50, s50, 2560
    s_mul_i32 s51, s31, 320
    s_add_u32 s35, s50, s51
    v_mfma_f32_4x4x4_16b_bf16 v[112:115], v[124:125], v[156:157], v[112:115]
    v_mfma_f32_4x4x4_16b_bf16 v[116:119], v[124:125], v[160:161], v[116:119]
    v_mfma_f32_4x4x4_16b_bf16 v[120:123], v[124:125], v[164:165], v[120:123]
    v_mfma_f32_4x4x4_16b_bf16 v[112:115], v[124:125], v[158:159], v[112:115]
    v_mfma_f32_4x4x4_16b_bf16 v[116:119], v[124:125], v[162:163], v[116:119]
    v_mfma_f32_4x4x4_16b_bf16 v[120:123], v[124:125], v[166:167], v[120:123]
    s_waitcnt lgkmcnt(5)
    v_mfma_f32_32x32x16_bf16 v[16:31], v[136:139], v[128:131], v[16:31]
    ds_read_b128 v[148:151], v179 offset:0
    ds_read_b64_tr_b16 v[156:157], v183 offset:0
    ds_read_b64_tr_b16 v[158:159], v183 offset:1536
    s_mov_b32 s16, s92
    s_mov_b32 s17, s93
    s_waitcnt lgkmcnt(7)
    v_mfma_f32_32x32x16_bf16 v[32:47], v[136:139], v[132:135], v[32:47]
    ds_read_b128 v[152:155], v179 offset:4096
    ds_read_b64_tr_b16 v[160:161], v187 offset:64
    ds_read_b64_tr_b16 v[162:163], v187 offset:1600
    s_mov_b32 s18, 5242880
    s_mov_b32 s19, 0x20000
    v_add_u32 v2, s66, v2
    s_waitcnt lgkmcnt(8)
    v_mfma_f32_32x32x16_bf16 v[48:63], v[140:143], v[128:131], v[48:63]
    buffer_load_dwordx4 v2, s[4:7], s37 offen offset:1024 lds
    ds_read_b64_tr_b16 v[164:165], v183 offset:128
    ds_read_b64_tr_b16 v[166:167], v183 offset:1664
    v_mfma_f32_32x32x16_bf16 v[64:79], v[140:143], v[132:135], v[64:79]
    s_waitcnt lgkmcnt(8)
    v_mfma_f32_32x32x16_bf16 v[80:95], v[144:147], v[128:131], v[80:95]
    buffer_load_dwordx4 v3, s[4:7], s38 offen offset:2048 lds
    v_mfma_f32_32x32x16_bf16 v[96:111], v[144:147], v[132:135], v[96:111]
    buffer_load_dwordx4 v2, s[4:7], s39 offen offset:3072 lds
    s_add_u32 m0, s46, 122880
    v_add_u32 v4, s67, v4
    s_waitcnt lgkmcnt(5)
    v_mfma_f32_32x32x16_bf16 v[16:31], v[156:159], v[148:151], v[16:31]
    buffer_load_dwordx4 v4, s[8:11], s40 offen offset:0 lds
    s_waitcnt lgkmcnt(4)
    v_mfma_f32_32x32x16_bf16 v[32:47], v[156:159], v[152:155], v[32:47]
    s_waitcnt vmcnt(15) lgkmcnt(0)
    s_barrier
    ds_read_b128 v[128:131], v176 offset:40960
    ds_read_b64_tr_b16 v[136:137], v180 offset:40960
    ds_read_b64_tr_b16 v[138:139], v180 offset:42496
    v_mfma_f32_32x32x16_bf16 v[48:63], v[160:163], v[148:151], v[48:63]
    ds_read_b128 v[132:135], v176 offset:45056
    ds_read_b64_tr_b16 v[140:141], v184 offset:41024
    ds_read_b64_tr_b16 v[142:143], v184 offset:42560
    v_mfma_f32_32x32x16_bf16 v[64:79], v[160:163], v[152:155], v[64:79]
    ds_read_b64_tr_b16 v[144:145], v180 offset:41088
    ds_read_b64_tr_b16 v[146:147], v180 offset:42624
    v_add_u32 v5, s67, v5
    v_mfma_f32_32x32x16_bf16 v[80:95], v[164:167], v[148:151], v[80:95]
    buffer_load_dwordx4 v5, s[8:11], s40 offen offset:1024 lds
    v_add_u32 v6, s67, v6
    v_mfma_f32_32x32x16_bf16 v[96:111], v[164:167], v[152:155], v[96:111]
    buffer_load_dwordx4 v6, s[8:11], s40 offen offset:2048 lds
    s_waitcnt lgkmcnt(5)
    v_mfma_f32_32x32x16_bf16 v[16:31], v[136:139], v[128:131], v[16:31]
    ds_read_b128 v[148:151], v177 offset:40960
    ds_read_b64_tr_b16 v[156:157], v181 offset:40960
    ds_read_b64_tr_b16 v[158:159], v181 offset:42496
    s_waitcnt lgkmcnt(7)
    v_mfma_f32_32x32x16_bf16 v[32:47], v[136:139], v[132:135], v[32:47]
    ds_read_b128 v[152:155], v177 offset:45056
    ds_read_b64_tr_b16 v[160:161], v185 offset:41024
    ds_read_b64_tr_b16 v[162:163], v185 offset:42560
    s_waitcnt lgkmcnt(8)
    v_mfma_f32_32x32x16_bf16 v[48:63], v[140:143], v[128:131], v[48:63]
    buffer_load_dwordx4 v4, s[8:11], s41 offen offset:3072 lds
    ds_read_b64_tr_b16 v[164:165], v181 offset:41088
    ds_read_b64_tr_b16 v[166:167], v181 offset:42624
    s_add_u32 m0, s46, 126976
    v_mfma_f32_32x32x16_bf16 v[64:79], v[140:143], v[132:135], v[64:79]
    buffer_load_dwordx4 v5, s[8:11], s44 offen offset:0 lds
    s_waitcnt lgkmcnt(8)
    v_mfma_f32_32x32x16_bf16 v[80:95], v[144:147], v[128:131], v[80:95]
    buffer_load_dwordx4 v6, s[8:11], s44 offen offset:1024 lds
    s_add_u32 m0, s45, 24576
    s_xor_b32 s1, s2, 8
    s_sub_u32 s66, s1, s0
    s_mov_b32 s0, s1
    s_lshl_b32 s66, s66, 7
    s_mul_i32 s67, s66, 1536
    v_add_u32 v3, s66, v3
    v_mfma_f32_32x32x16_bf16 v[96:111], v[144:147], v[132:135], v[96:111]
    buffer_load_dwordx4 v3, s[4:7], s36 offen offset:0 lds
    v_mfma_f32_4x4x4_16b_bf16 v[112:115], v[124:125], v[136:137], v[112:115]
    v_mfma_f32_4x4x4_16b_bf16 v[116:119], v[124:125], v[140:141], v[116:119]
    v_mfma_f32_4x4x4_16b_bf16 v[120:123], v[124:125], v[144:145], v[120:123]
    v_mfma_f32_4x4x4_16b_bf16 v[112:115], v[124:125], v[138:139], v[112:115]
    v_mfma_f32_4x4x4_16b_bf16 v[116:119], v[124:125], v[142:143], v[116:119]
    v_mfma_f32_4x4x4_16b_bf16 v[120:123], v[124:125], v[146:147], v[120:123]
    s_waitcnt lgkmcnt(5)
    v_mfma_f32_32x32x16_bf16 v[16:31], v[156:159], v[148:151], v[16:31]
    ds_read_b128 v[128:131], v178 offset:40960
    ds_read_b64_tr_b16 v[136:137], v182 offset:40960
    ds_read_b64_tr_b16 v[138:139], v182 offset:42496
    s_waitcnt lgkmcnt(7)
    v_mfma_f32_32x32x16_bf16 v[32:47], v[156:159], v[152:155], v[32:47]
    ds_read_b128 v[132:135], v178 offset:45056
    ds_read_b64_tr_b16 v[140:141], v186 offset:41024
    ds_read_b64_tr_b16 v[142:143], v186 offset:42560
    s_waitcnt lgkmcnt(8)
    v_mfma_f32_32x32x16_bf16 v[48:63], v[160:163], v[148:151], v[48:63]
    buffer_load_dword v254, v253, s[12:15], s60 offen sc1
    ds_read_b64_tr_b16 v[144:145], v182 offset:41088
    ds_read_b64_tr_b16 v[146:147], v182 offset:42624
    v_add_u32 v2, s66, v2
    v_mfma_f32_32x32x16_bf16 v[64:79], v[160:163], v[152:155], v[64:79]
    buffer_load_dwordx4 v2, s[4:7], s37 offen offset:1024 lds
    s_waitcnt lgkmcnt(8)
    v_mfma_f32_32x32x16_bf16 v[80:95], v[164:167], v[148:151], v[80:95]
    buffer_load_dwordx4 v3, s[4:7], s38 offen offset:2048 lds
    v_mfma_f32_32x32x16_bf16 v[96:111], v[164:167], v[152:155], v[96:111]
    buffer_load_dwordx4 v2, s[4:7], s39 offen offset:3072 lds
    v_mfma_f32_4x4x4_16b_bf16 v[112:115], v[124:125], v[156:157], v[112:115]
    v_mfma_f32_4x4x4_16b_bf16 v[116:119], v[124:125], v[160:161], v[116:119]
    v_mfma_f32_4x4x4_16b_bf16 v[120:123], v[124:125], v[164:165], v[120:123]
    v_mfma_f32_4x4x4_16b_bf16 v[112:115], v[124:125], v[158:159], v[112:115]
    v_mfma_f32_4x4x4_16b_bf16 v[116:119], v[124:125], v[162:163], v[116:119]
    v_mfma_f32_4x4x4_16b_bf16 v[120:123], v[124:125], v[166:167], v[120:123]
    s_waitcnt lgkmcnt(5)
    v_mfma_f32_32x32x16_bf16 v[16:31], v[136:139], v[128:131], v[16:31]
    ds_read_b128 v[148:151], v179 offset:40960
    ds_read_b64_tr_b16 v[156:157], v183 offset:40960
    ds_read_b64_tr_b16 v[158:159], v183 offset:42496
    s_waitcnt lgkmcnt(7)
    v_mfma_f32_32x32x16_bf16 v[32:47], v[136:139], v[132:135], v[32:47]
    ds_read_b128 v[152:155], v179 offset:45056
    ds_read_b64_tr_b16 v[160:161], v187 offset:41024
    ds_read_b64_tr_b16 v[162:163], v187 offset:42560
    s_add_u32 m0, s46, 0
    v_add_u32 v4, s67, v4
    s_waitcnt lgkmcnt(8)
    v_mfma_f32_32x32x16_bf16 v[48:63], v[140:143], v[128:131], v[48:63]
    buffer_load_dwordx4 v4, s[8:11], s40 offen offset:0 lds
    ds_read_b64_tr_b16 v[164:165], v183 offset:41088
    ds_read_b64_tr_b16 v[166:167], v183 offset:42624
    v_mfma_f32_32x32x16_bf16 v[64:79], v[140:143], v[132:135], v[64:79]
    v_add_u32 v5, s67, v5
    s_waitcnt lgkmcnt(8)
    v_mfma_f32_32x32x16_bf16 v[80:95], v[144:147], v[128:131], v[80:95]
    buffer_load_dwordx4 v5, s[8:11], s40 offen offset:1024 lds
    v_add_u32 v6, s67, v6
    v_mfma_f32_32x32x16_bf16 v[96:111], v[144:147], v[132:135], v[96:111]
    buffer_load_dwordx4 v6, s[8:11], s40 offen offset:2048 lds
    s_waitcnt lgkmcnt(5)
    v_mfma_f32_32x32x16_bf16 v[16:31], v[156:159], v[148:151], v[16:31]
    buffer_load_dwordx4 v4, s[8:11], s41 offen offset:3072 lds
    s_waitcnt lgkmcnt(4)
    v_mfma_f32_32x32x16_bf16 v[32:47], v[156:159], v[152:155], v[32:47]
    s_waitcnt vmcnt(19) lgkmcnt(0)
    s_barrier
    ds_read_b128 v[128:131], v188 offset:0
    ds_read_b64_tr_b16 v[136:137], v192 offset:0
    ds_read_b64_tr_b16 v[138:139], v192 offset:1536
    v_mfma_f32_32x32x16_bf16 v[48:63], v[160:163], v[148:151], v[48:63]
    ds_read_b128 v[132:135], v188 offset:4096
    ds_read_b64_tr_b16 v[140:141], v196 offset:64
    ds_read_b64_tr_b16 v[142:143], v196 offset:1600
    v_mfma_f32_32x32x16_bf16 v[64:79], v[160:163], v[152:155], v[64:79]
    ds_read_b64_tr_b16 v[144:145], v192 offset:128
    ds_read_b64_tr_b16 v[146:147], v192 offset:1664
    s_add_u32 m0, s46, 4096
    v_mfma_f32_32x32x16_bf16 v[80:95], v[164:167], v[148:151], v[80:95]
    buffer_load_dwordx4 v5, s[8:11], s44 offen offset:0 lds
    v_mfma_f32_32x32x16_bf16 v[96:111], v[164:167], v[152:155], v[96:111]
    buffer_load_dwordx4 v6, s[8:11], s44 offen offset:1024 lds
    s_waitcnt lgkmcnt(5)
    v_mfma_f32_32x32x16_bf16 v[16:31], v[136:139], v[128:131], v[16:31]
    ds_read_b128 v[148:151], v189 offset:0
    ds_read_b64_tr_b16 v[156:157], v193 offset:0
    ds_read_b64_tr_b16 v[158:159], v193 offset:1536
    s_waitcnt lgkmcnt(7)
    v_mfma_f32_32x32x16_bf16 v[32:47], v[136:139], v[132:135], v[32:47]
    ds_read_b128 v[152:155], v189 offset:4096
    ds_read_b64_tr_b16 v[160:161], v197 offset:64
    ds_read_b64_tr_b16 v[162:163], v197 offset:1600
    s_add_u32 m0, s45, 65536
    s_xor_b32 s1, s2, 9
    s_sub_u32 s66, s1, s0
    s_mov_b32 s0, s1
    s_lshl_b32 s66, s66, 7
    s_mul_i32 s67, s66, 1536
    v_add_u32 v3, s66, v3
    s_waitcnt lgkmcnt(8)
    v_mfma_f32_32x32x16_bf16 v[48:63], v[140:143], v[128:131], v[48:63]
    buffer_load_dwordx4 v3, s[4:7], s36 offen offset:0 lds
    ds_read_b64_tr_b16 v[164:165], v193 offset:128
    ds_read_b64_tr_b16 v[166:167], v193 offset:1664
    v_add_u32 v2, s66, v2
    v_mfma_f32_32x32x16_bf16 v[64:79], v[140:143], v[132:135], v[64:79]
    buffer_load_dwordx4 v2, s[4:7], s37 offen offset:1024 lds
    s_waitcnt lgkmcnt(8)
    v_mfma_f32_32x32x16_bf16 v[80:95], v[144:147], v[128:131], v[80:95]
    buffer_load_dwordx4 v3, s[4:7], s38 offen offset:2048 lds
    v_mfma_f32_32x32x16_bf16 v[96:111], v[144:147], v[132:135], v[96:111]
    buffer_load_dwordx4 v2, s[4:7], s39 offen offset:3072 lds
    v_mfma_f32_4x4x4_16b_bf16 v[112:115], v[124:125], v[136:137], v[112:115]
    v_mfma_f32_4x4x4_16b_bf16 v[116:119], v[124:125], v[140:141], v[116:119]
    v_mfma_f32_4x4x4_16b_bf16 v[120:123], v[124:125], v[144:145], v[120:123]
    v_mfma_f32_4x4x4_16b_bf16 v[112:115], v[124:125], v[138:139], v[112:115]
    v_mfma_f32_4x4x4_16b_bf16 v[116:119], v[124:125], v[142:143], v[116:119]
    v_mfma_f32_4x4x4_16b_bf16 v[120:123], v[124:125], v[146:147], v[120:123]
    s_waitcnt lgkmcnt(5)
    v_mfma_f32_32x32x16_bf16 v[16:31], v[156:159], v[148:151], v[16:31]
    ds_read_b128 v[128:131], v190 offset:0
    ds_read_b64_tr_b16 v[136:137], v194 offset:0
    ds_read_b64_tr_b16 v[138:139], v194 offset:1536
    s_waitcnt lgkmcnt(7)
    v_mfma_f32_32x32x16_bf16 v[32:47], v[156:159], v[152:155], v[32:47]
    ds_read_b128 v[132:135], v190 offset:4096
    ds_read_b64_tr_b16 v[140:141], v198 offset:64
    ds_read_b64_tr_b16 v[142:143], v198 offset:1600
    s_add_u32 m0, s46, 40960
    v_add_u32 v4, s67, v4
    s_waitcnt lgkmcnt(8)
    v_mfma_f32_32x32x16_bf16 v[48:63], v[160:163], v[148:151], v[48:63]
    buffer_load_dwordx4 v4, s[8:11], s40 offen offset:0 lds
    ds_read_b64_tr_b16 v[144:145], v194 offset:128
    ds_read_b64_tr_b16 v[146:147], v194 offset:1664
    v_add_u32 v5, s67, v5
    v_mfma_f32_32x32x16_bf16 v[64:79], v[160:163], v[152:155], v[64:79]
    buffer_load_dwordx4 v5, s[8:11], s40 offen offset:1024 lds
    v_add_u32 v6, s67, v6
    s_waitcnt lgkmcnt(8)
    v_mfma_f32_32x32x16_bf16 v[80:95], v[164:167], v[148:151], v[80:95]
    buffer_load_dwordx4 v6, s[8:11], s40 offen offset:2048 lds
    v_mfma_f32_32x32x16_bf16 v[96:111], v[164:167], v[152:155], v[96:111]
    buffer_load_dwordx4 v4, s[8:11], s41 offen offset:3072 lds
    v_mfma_f32_4x4x4_16b_bf16 v[112:115], v[124:125], v[156:157], v[112:115]
    v_mfma_f32_4x4x4_16b_bf16 v[116:119], v[124:125], v[160:161], v[116:119]
    v_mfma_f32_4x4x4_16b_bf16 v[120:123], v[124:125], v[164:165], v[120:123]
    v_mfma_f32_4x4x4_16b_bf16 v[112:115], v[124:125], v[158:159], v[112:115]
    v_mfma_f32_4x4x4_16b_bf16 v[116:119], v[124:125], v[162:163], v[116:119]
    v_mfma_f32_4x4x4_16b_bf16 v[120:123], v[124:125], v[166:167], v[120:123]
    s_waitcnt vmcnt(17)
    v_cmp_ne_u32 vcc, s28, v254
    s_nop 1
    s_cbranch_vccnz pb49
pbd50:
    s_waitcnt lgkmcnt(5)
    v_mfma_f32_32x32x16_bf16 v[16:31], v[136:139], v[128:131], v[16:31]
    ds_read_b128 v[148:151], v191 offset:0
    ds_read_b64_tr_b16 v[156:157], v195 offset:0
    ds_read_b64_tr_b16 v[158:159], v195 offset:1536
    s_waitcnt lgkmcnt(7)
    v_mfma_f32_32x32x16_bf16 v[32:47], v[136:139], v[132:135], v[32:47]
    ds_read_b128 v[152:155], v191 offset:4096
    ds_read_b64_tr_b16 v[160:161], v199 offset:64
    ds_read_b64_tr_b16 v[162:163], v199 offset:1600
    s_add_u32 m0, s46, 45056
    s_waitcnt lgkmcnt(8)
    v_mfma_f32_32x32x16_bf16 v[48:63], v[140:143], v[128:131], v[48:63]
    buffer_load_dwordx4 v5, s[8:11], s44 offen offset:0 lds
    ds_read_b64_tr_b16 v[164:165], v195 offset:128
    ds_read_b64_tr_b16 v[166:167], v195 offset:1664
    v_mfma_f32_32x32x16_bf16 v[64:79], v[140:143], v[132:135], v[64:79]
    s_waitcnt lgkmcnt(8)
    v_mfma_f32_32x32x16_bf16 v[80:95], v[144:147], v[128:131], v[80:95]
    buffer_load_dwordx4 v6, s[8:11], s44 offen offset:1024 lds
    v_mfma_f32_32x32x16_bf16 v[96:111], v[144:147], v[132:135], v[96:111]
    s_add_u32 s94, s47, 0
    buffer_load_dwordx4 a[0:3], v252, s[12:15], s94 offen sc1
    s_waitcnt lgkmcnt(5)
    v_mfma_f32_32x32x16_bf16 v[16:31], v[156:159], v[148:151], v[16:31]
    s_add_u32 s94, s47, 49152
    buffer_load_dwordx4 a[4:7], v252, s[12:15], s94 offen sc1
    s_waitcnt lgkmcnt(4)
    v_mfma_f32_32x32x16_bf16 v[32:47], v[156:159], v[152:155], v[32:47]
    s_waitcnt lgkmcnt(0)
    s_barrier
    ds_read_b128 v[128:131], v188 offset:40960
    ds_read_b64_tr_b16 v[136:137], v192 offset:40960
    ds_read_b64_tr_b16 v[138:139], v192 offset:42496
    v_mfma_f32_32x32x16_bf16 v[48:63], v[160:163], v[148:151], v[48:63]
    ds_read_b128 v[132:135], v188 offset:45056
    ds_read_b64_tr_b16 v[140:141], v196 offset:41024
    ds_read_b64_tr_b16 v[142:143], v196 offset:42560
    v_mfma_f32_32x32x16_bf16 v[64:79], v[160:163], v[152:155], v[64:79]
    ds_read_b64_tr_b16 v[144:145], v192 offset:41088
    ds_read_b64_tr_b16 v[146:147], v192 offset:42624
    v_mfma_f32_32x32x16_bf16 v[80:95], v[164:167], v[148:151], v[80:95]
    s_add_u32 s94, s47, 98304
    buffer_load_dwordx4 a[8:11], v252, s[12:15], s94 offen sc1
    v_mfma_f32_32x32x16_bf16 v[96:111], v[164:167], v[152:155], v[96:111]
    s_add_u32 s94, s47, 147456
    buffer_load_dwordx4 a[12:15], v252, s[12:15], s94 offen sc1
    s_waitcnt lgkmcnt(5)
    v_mfma_f32_32x32x16_bf16 v[16:31], v[136:139], v[128:131], v[16:31]
    ds_read_b128 v[148:151], v189 offset:40960
    ds_read_b64_tr_b16 v[156:157], v193 offset:40960
    ds_read_b64_tr_b16 v[158:159], v193 offset:42496
    v_lshlrev_b32 v126, 16, v126
    s_waitcnt lgkmcnt(7)
    v_mfma_f32_32x32x16_bf16 v[32:47], v[136:139], v[132:135], v[32:47]
    ds_read_b128 v[152:155], v189 offset:45056
    ds_read_b64_tr_b16 v[160:161], v197 offset:41024
    ds_read_b64_tr_b16 v[162:163], v197 offset:42560
    ds_write_b32 v11, v126 offset:1536
    v_and_b32 v11, 31, v0
    s_waitcnt lgkmcnt(9)
    v_mfma_f32_32x32x16_bf16 v[48:63], v[140:143], v[128:131], v[48:63]
    s_add_u32 s94, s47, 196608
    buffer_load_dwordx4 a[16:19], v252, s[12:15], s94 offen sc1
    ds_read_b64_tr_b16 v[164:165], v193 offset:41088
    ds_read_b64_tr_b16 v[166:167], v193 offset:42624
    s_mul_i32 s50, s42, 768
    v_mfma_f32_32x32x16_bf16 v[64:79], v[140:143], v[132:135], v[64:79]
    s_add_u32 s94, s47, 3072
    buffer_load_dwordx4 a[60:63], v252, s[12:15], s94 offen sc1
    s_mul_i32 s51, s43, 384
    s_add_u32 s50, s50, s51
    v_lshl_add_u32 v13, v11, 2, s50
    s_waitcnt lgkmcnt(9)
    v_mfma_f32_32x32x16_bf16 v[80:95], v[144:147], v[128:131], v[80:95]
    s_add_u32 s94, s47, 52224
    buffer_load_dwordx4 a[64:67], v252, s[12:15], s94 offen sc1
    v_add_u32 v13, 110592, v13
    v_lshrrev_b32 v14, 5, v0
    v_lshl_add_u32 v12, v14, 4, s51
    v_mfma_f32_32x32x16_bf16 v[96:111], v[144:147], v[132:135], v[96:111]
    s_add_u32 s94, s47, 101376
    buffer_load_dwordx4 a[68:71], v252, s[12:15], s94 offen sc1
    v_add_u32 v12, 110592, v12
    v_lshrrev_b32 v253, 4, v11
    v_mul_u32_u24 v253, 49152, v253
    v_mfma_f32_4x4x4_16b_bf16 v[112:115], v[124:125], v[136:137], v[112:115]
    v_mfma_f32_4x4x4_16b_bf16 v[116:119], v[124:125], v[140:141], v[116:119]
    v_mfma_f32_4x4x4_16b_bf16 v[120:123], v[124:125], v[144:145], v[120:123]
    v_mfma_f32_4x4x4_16b_bf16 v[112:115], v[124:125], v[138:139], v[112:115]
    v_mfma_f32_4x4x4_16b_bf16 v[116:119], v[124:125], v[142:143], v[116:119]
    v_mfma_f32_4x4x4_16b_bf16 v[120:123], v[124:125], v[146:147], v[120:123]
    s_waitcnt lgkmcnt(6)
    v_mfma_f32_32x32x16_bf16 v[16:31], v[156:159], v[148:151], v[16:31]
    ds_read_b128 v[128:131], v190 offset:40960
    ds_read_b64_tr_b16 v[136:137], v194 offset:40960
    ds_read_b64_tr_b16 v[138:139], v194 offset:42496
    v_and_b32 v15, 15, v0
    v_lshl_add_u32 v253, v15, 4, v253
    s_waitcnt lgkmcnt(8)
    v_mfma_f32_32x32x16_bf16 v[32:47], v[156:159], v[152:155], v[32:47]
    ds_read_b128 v[132:135], v190 offset:45056
    ds_read_b64_tr_b16 v[140:141], v198 offset:41024
    ds_read_b64_tr_b16 v[142:143], v198 offset:42560
    v_lshl_add_u32 v253, v14, 8, v253
    s_lshl_b32 s50, s30, 3
    s_waitcnt lgkmcnt(9)
    v_mfma_f32_32x32x16_bf16 v[48:63], v[160:163], v[148:151], v[48:63]
    s_add_u32 s94, s47, 150528
    buffer_load_dwordx4 a[72:75], v252, s[12:15], s94 offen sc1
    ds_read_b64_tr_b16 v[144:145], v194 offset:41088
    ds_read_b64_tr_b16 v[146:147], v194 offset:42624
    s_lshl_b32 s51, s42, 2
    v_mfma_f32_32x32x16_bf16 v[64:79], v[160:163], v[152:155], v[64:79]
    s_add_u32 s94, s47, 199680
    buffer_load_dwordx4 a[76:79], v252, s[12:15], s94 offen sc1
    s_add_u32 s50, s50, s51
    s_mul_i32 s50, s50, 48
    s_mul_i32 s51, s31, 6
    s_waitcnt lgkmcnt(8)
    v_mfma_f32_32x32x16_bf16 v[80:95], v[164:167], v[148:151], v[80:95]
    s_add_u32 s94, s47, 6144
    buffer_load_dwordx4 a[120:123], v252, s[12:15], s94 offen sc1
    s_add_u32 s50, s50, s51
    s_mul_i32 s51, s43, 3
    s_add_u32 s50, s50, s51
    v_mfma_f32_32x32x16_bf16 v[96:111], v[164:167], v[152:155], v[96:111]
    s_add_u32 s94, s47, 55296
    buffer_load_dwordx4 a[124:127], v252, s[12:15], s94 offen sc1
    s_lshl_b32 s50, s50, 10
    s_add_u32 s54, s50, 9437184
    s_add_u32 s55, s54, 98304
    v_mfma_f32_4x4x4_16b_bf16 v[112:115], v[124:125], v[156:157], v[112:115]
    v_mfma_f32_4x4x4_16b_bf16 v[116:119], v[124:125], v[160:161], v[116:119]
    v_mfma_f32_4x4x4_16b_bf16 v[120:123], v[124:125], v[164:165], v[120:123]
    v_mfma_f32_4x4x4_16b_bf16 v[112:115], v[124:125], v[158:159], v[112:115]
    v_mfma_f32_4x4x4_16b_bf16 v[116:119], v[124:125], v[162:163], v[116:119]
    v_mfma_f32_4x4x4_16b_bf16 v[120:123], v[124:125], v[166:167], v[120:123]
    s_waitcnt lgkmcnt(5)
    v_mfma_f32_32x32x16_bf16 v[16:31], v[136:139], v[128:131], v[16:31]
    ds_read_b128 v[148:151], v191 offset:40960
    ds_read_b64_tr_b16 v[156:157], v195 offset:40960
    ds_read_b64_tr_b16 v[158:159], v195 offset:42496
    s_mov_b32 s52, 0xbdd2d3e8
    s_mov_b32 s53, s52
    s_waitcnt lgkmcnt(7)
    v_mfma_f32_32x32x16_bf16 v[32:47], v[136:139], v[132:135], v[32:47]
    ds_read_b128 v[152:155], v191 offset:45056
    ds_read_b64_tr_b16 v[160:161], v199 offset:41024
    ds_read_b64_tr_b16 v[162:163], v199 offset:42560
    s_cmp_ge_u32 s3, 2
    s_cselect_b32 s83, s83, -1
    s_cselect_b32 s50, s32, 0
    v_mov_b32 v15, s50
    s_waitcnt lgkmcnt(8)
    v_mfma_f32_32x32x16_bf16 v[48:63], v[140:143], v[128:131], v[48:63]
    buffer_load_dwordx4 v[168:171], v10, s[12:15], s57 offen sc1
    ds_read_b64_tr_b16 v[164:165], v195 offset:41088
    ds_read_b64_tr_b16 v[166:167], v195 offset:42624
    s_mov_b32 s50, 0x3acccccd
    v_mfma_f32_32x32x16_bf16 v[64:79], v[140:143], v[132:135], v[64:79]
    buffer_load_dwordx4 v[172:175], v10, s[12:15], s57 offen offset:512 sc1
    s_waitcnt lgkmcnt(8)
    v_mfma_f32_32x32x16_bf16 v[80:95], v[144:147], v[128:131], v[80:95]
    s_add_u32 s94, s47, 104448
    buffer_load_dwordx4 a[128:131], v252, s[12:15], s94 offen sc1
    v_mfma_f32_32x32x16_bf16 v[96:111], v[144:147], v[132:135], v[96:111]
    s_add_u32 s94, s47, 153600
    buffer_load_dwordx4 a[132:135], v252, s[12:15], s94 offen sc1
    s_waitcnt lgkmcnt(5)
    v_mfma_f32_32x32x16_bf16 v[16:31], v[156:159], v[148:151], v[16:31]
    s_add_u32 s94, s47, 202752
    buffer_load_dwordx4 a[136:139], v252, s[12:15], s94 offen sc1
    s_waitcnt lgkmcnt(4)
    v_mfma_f32_32x32x16_bf16 v[32:47], v[156:159], v[152:155], v[32:47]
    s_waitcnt vmcnt(27) lgkmcnt(0)
    s_barrier
    ds_read_b128 v[128:131], v176 offset:0
    ds_read_b64_tr_b16 v[136:137], v180 offset:0
    ds_read_b64_tr_b16 v[138:139], v180 offset:1536
    v_mfma_f32_32x32x16_bf16 v[48:63], v[160:163], v[148:151], v[48:63]
    ds_read_b128 v[132:135], v176 offset:4096
    ds_read_b64_tr_b16 v[140:141], v184 offset:64
    ds_read_b64_tr_b16 v[142:143], v184 offset:1600
    v_mfma_f32_32x32x16_bf16 v[64:79], v[160:163], v[152:155], v[64:79]
    s_add_u32 s94, s47, 9216
    buffer_load_dwordx4 a[180:183], v252, s[12:15], s94 offen sc1
    ds_read_b64_tr_b16 v[144:145], v180 offset:128
    ds_read_b64_tr_b16 v[146:147], v180 offset:1664
    v_mfma_f32_32x32x16_bf16 v[80:95], v[164:167], v[148:151], v[80:95]
    s_add_u32 s94, s47, 58368
    buffer_load_dwordx4 a[184:187], v252, s[12:15], s94 offen sc1
    v_mfma_f32_32x32x16_bf16 v[96:111], v[164:167], v[152:155], v[96:111]
    s_add_u32 s94, s47, 107520
    buffer_load_dwordx4 a[188:191], v252, s[12:15], s94 offen sc1
    s_waitcnt lgkmcnt(5)
    v_mfma_f32_32x32x16_bf16 v[16:31], v[136:139], v[128:131], v[16:31]
    ds_read_b128 v[148:151], v177 offset:0
    ds_read_b64_tr_b16 v[156:157], v181 offset:0
    ds_read_b64_tr_b16 v[158:159], v181 offset:1536
    v_mov_b32 v6, 0xc0135761
    v_mov_b32 v7, 0xc0135761
    s_waitcnt lgkmcnt(7)
    v_mfma_f32_32x32x16_bf16 v[32:47], v[136:139], v[132:135], v[32:47]
    ds_read_b128 v[152:155], v177 offset:4096
    ds_read_b64_tr_b16 v[160:161], v185 offset:64
    ds_read_b64_tr_b16 v[162:163], v185 offset:1600
    s_waitcnt lgkmcnt(8)
    v_mfma_f32_32x32x16_bf16 v[48:63], v[140:143], v[128:131], v[48:63]
    s_add_u32 s94, s47, 156672
    buffer_load_dwordx4 a[192:195], v252, s[12:15], s94 offen sc1
    ds_read_b64_tr_b16 v[164:165], v181 offset:128
    ds_read_b64_tr_b16 v[166:167], v181 offset:1664
    v_mfma_f32_32x32x16_bf16 v[64:79], v[140:143], v[132:135], v[64:79]
    s_add_u32 s94, s47, 205824
    buffer_load_dwordx4 a[196:199], v252, s[12:15], s94 offen sc1
    s_waitcnt lgkmcnt(8)
    v_mfma_f32_32x32x16_bf16 v[80:95], v[144:147], v[128:131], v[80:95]
    s_add_u32 s94, s47, 1024
    buffer_load_dwordx4 a[20:23], v252, s[12:15], s94 offen sc1
    v_mfma_f32_32x32x16_bf16 v[96:111], v[144:147], v[132:135], v[96:111]
    s_add_u32 s94, s47, 50176
    buffer_load_dwordx4 a[24:27], v252, s[12:15], s94 offen sc1
    v_mfma_f32_4x4x4_16b_bf16 v[112:115], v[124:125], v[136:137], v[112:115]
    v_mfma_f32_4x4x4_16b_bf16 v[116:119], v[124:125], v[140:141], v[116:119]
    v_mfma_f32_4x4x4_16b_bf16 v[120:123], v[124:125], v[144:145], v[120:123]
    v_mfma_f32_4x4x4_16b_bf16 v[112:115], v[124:125], v[138:139], v[112:115]
    v_mfma_f32_4x4x4_16b_bf16 v[116:119], v[124:125], v[142:143], v[116:119]
    v_mfma_f32_4x4x4_16b_bf16 v[120:123], v[124:125], v[146:147], v[120:123]
    s_waitcnt lgkmcnt(5)
    v_mfma_f32_32x32x16_bf16 v[16:31], v[156:159], v[148:151], v[16:31]
    ds_read_b128 v[128:131], v178 offset:0
    ds_read_b64_tr_b16 v[136:137], v182 offset:0
    ds_read_b64_tr_b16 v[138:139], v182 offset:1536
    s_waitcnt lgkmcnt(7)
    v_mfma_f32_32x32x16_bf16 v[32:47], v[156:159], v[152:155], v[32:47]
    ds_read_b128 v[132:135], v178 offset:4096
    ds_read_b64_tr_b16 v[140:141], v186 offset:64
    ds_read_b64_tr_b16 v[142:143], v186 offset:1600
    s_waitcnt lgkmcnt(8)
    v_mfma_f32_32x32x16_bf16 v[48:63], v[160:163], v[148:151], v[48:63]
    s_add_u32 s94, s47, 99328
    buffer_load_dwordx4 a[28:31], v252, s[12:15], s94 offen sc1
    ds_read_b64_tr_b16 v[144:145], v182 offset:128
    ds_read_b64_tr_b16 v[146:147], v182 offset:1664
    v_mfma_f32_32x32x16_bf16 v[64:79], v[160:163], v[152:155], v[64:79]
    s_add_u32 s94, s47, 148480
    buffer_load_dwordx4 a[32:35], v252, s[12:15], s94 offen sc1
    s_waitcnt lgkmcnt(8)
    v_mfma_f32_32x32x16_bf16 v[80:95], v[164:167], v[148:151], v[80:95]
    s_add_u32 s94, s47, 197632
    buffer_load_dwordx4 a[36:39], v252, s[12:15], s94 offen sc1
    v_mfma_f32_32x32x16_bf16 v[96:111], v[164:167], v[152:155], v[96:111]
    s_add_u32 s94, s47, 4096
    buffer_load_dwordx4 a[80:83], v252, s[12:15], s94 offen sc1
    v_mfma_f32_4x4x4_16b_bf16 v[112:115], v[124:125], v[156:157], v[112:115]
    v_mfma_f32_4x4x4_16b_bf16 v[116:119], v[124:125], v[160:161], v[116:119]
    v_mfma_f32_4x4x4_16b_bf16 v[120:123], v[124:125], v[164:165], v[120:123]
    v_mfma_f32_4x4x4_16b_bf16 v[112:115], v[124:125], v[158:159], v[112:115]
    v_mfma_f32_4x4x4_16b_bf16 v[116:119], v[124:125], v[162:163], v[116:119]
    v_mfma_f32_4x4x4_16b_bf16 v[120:123], v[124:125], v[166:167], v[120:123]
    s_waitcnt lgkmcnt(5)
    v_mfma_f32_32x32x16_bf16 v[16:31], v[136:139], v[128:131], v[16:31]
    ds_read_b128 v[148:151], v179 offset:0
    ds_read_b64_tr_b16 v[156:157], v183 offset:0
    ds_read_b64_tr_b16 v[158:159], v183 offset:1536
    s_waitcnt lgkmcnt(7)
    v_mfma_f32_32x32x16_bf16 v[32:47], v[136:139], v[132:135], v[32:47]
    ds_read_b128 v[152:155], v179 offset:4096
    ds_read_b64_tr_b16 v[160:161], v187 offset:64
    ds_read_b64_tr_b16 v[162:163], v187 offset:1600
    s_waitcnt lgkmcnt(8)
    v_mfma_f32_32x32x16_bf16 v[48:63], v[140:143], v[128:131], v[48:63]
    s_add_u32 s94, s47, 53248
    buffer_load_dwordx4 a[84:87], v252, s[12:15], s94 offen sc1
    ds_read_b64_tr_b16 v[164:165], v183 offset:128
    ds_read_b64_tr_b16 v[166:167], v183 offset:1664
    v_mfma_f32_32x32x16_bf16 v[64:79], v[140:143], v[132:135], v[64:79]
    s_add_u32 s94, s47, 102400
    buffer_load_dwordx4 a[88:91], v252, s[12:15], s94 offen sc1
    s_waitcnt lgkmcnt(8)
    v_mfma_f32_32x32x16_bf16 v[80:95], v[144:147], v[128:131], v[80:95]
    s_add_u32 s94, s47, 151552
    buffer_load_dwordx4 a[92:95], v252, s[12:15], s94 offen sc1
    v_mfma_f32_32x32x16_bf16 v[96:111], v[144:147], v[132:135], v[96:111]
    s_add_u32 s94, s47, 200704
    buffer_load_dwordx4 a[96:99], v252, s[12:15], s94 offen sc1
    s_waitcnt vmcnt(18)
    v_xor_b32 v202, s28, v169
    v_bitop3_b32 v202, s29, v171, v202 bitop3:0xbe
    v_bitop3_b32 v202, s28, v173, v202 bitop3:0xbe
    v_bitop3_b32 v202, s29, v175, v202 bitop3:0xbe
    v_cmp_ne_u32 vcc, 0, v202
    s_nop 1
    s_cbranch_vccnz ps51
psd52:
    s_waitcnt lgkmcnt(5)
    v_mfma_f32_32x32x16_bf16 v[16:31], v[156:159], v[148:151], v[16:31]
    s_add_u32 s94, s47, 7168
    buffer_load_dwordx4 a[140:143], v252, s[12:15], s94 offen sc1
    v_mul_f32 v168, s50, v168
    v_mul_f32 v172, s50, v172
    v_mul_f32 v200, v168, v168
    s_waitcnt lgkmcnt(4)
    v_mfma_f32_32x32x16_bf16 v[32:47], v[156:159], v[152:155], v[32:47]
    s_waitcnt lgkmcnt(0)
    s_barrier
    ds_read_b128 v[128:131], v176 offset:40960
    ds_read_b64_tr_b16 v[136:137], v180 offset:40960
    ds_read_b64_tr_b16 v[138:139], v180 offset:42496
    v_mfma_f32_32x32x16_bf16 v[48:63], v[160:163], v[148:151], v[48:63]
    ds_read_b128 v[132:135], v176 offset:45056
    ds_read_b64_tr_b16 v[140:141], v184 offset:41024
    ds_read_b64_tr_b16 v[142:143], v184 offset:42560
    v_mul_f32 v201, v172, v172
    v_fma_f32 v170, v170, s50, -v200
    v_mfma_f32_32x32x16_bf16 v[64:79], v[160:163], v[152:155], v[64:79]
    s_add_u32 s94, s47, 56320
    buffer_load_dwordx4 a[144:147], v252, s[12:15], s94 offen sc1
    ds_read_b64_tr_b16 v[144:145], v180 offset:41088
    ds_read_b64_tr_b16 v[146:147], v180 offset:42624
    v_fma_f32 v174, v174, s50, -v201
    v_mfma_f32_32x32x16_bf16 v[80:95], v[164:167], v[148:151], v[80:95]
    s_add_u32 s94, s47, 105472
    buffer_load_dwordx4 a[148:151], v252, s[12:15], s94 offen sc1
    v_max_f32 v170, 0, v170
    v_max_f32 v174, 0, v174
    v_add_f32 v200, 0x3727c5ac, v170
    v_mfma_f32_32x32x16_bf16 v[96:111], v[164:167], v[152:155], v[96:111]
    s_add_u32 s94, s47, 154624
    buffer_load_dwordx4 a[152:155], v252, s[12:15], s94 offen sc1
    v_add_f32 v201, 0x3727c5ac, v174
    v_rsq_f32 v169, v200
    s_waitcnt lgkmcnt(5)
    v_mfma_f32_32x32x16_bf16 v[16:31], v[136:139], v[128:131], v[16:31]
    ds_read_b128 v[148:151], v177 offset:40960
    ds_read_b64_tr_b16 v[156:157], v181 offset:40960
    ds_read_b64_tr_b16 v[158:159], v181 offset:42496
    v_rsq_f32 v173, v201
    s_waitcnt lgkmcnt(7)
    v_mfma_f32_32x32x16_bf16 v[32:47], v[136:139], v[132:135], v[32:47]
    ds_read_b128 v[152:155], v177 offset:45056
    ds_read_b64_tr_b16 v[160:161], v185 offset:41024
    ds_read_b64_tr_b16 v[162:163], v185 offset:42560
    v_mul_f32 v200, v169, v169
    v_mul_f32 v201, v173, v173
    s_waitcnt lgkmcnt(8)
    v_mfma_f32_32x32x16_bf16 v[48:63], v[140:143], v[128:131], v[48:63]
    s_add_u32 s94, s47, 203776
    buffer_load_dwordx4 a[156:159], v252, s[12:15], s94 offen sc1
    ds_read_b64_tr_b16 v[164:165], v181 offset:41088
    ds_read_b64_tr_b16 v[166:167], v181 offset:42624
    v_mul_f32 v200, v200, v170
    v_mfma_f32_32x32x16_bf16 v[64:79], v[140:143], v[132:135], v[64:79]
    s_add_u32 s94, s47, 10240
    buffer_load_dwordx4 a[200:203], v252, s[12:15], s94 offen sc1
    v_mul_f32 v201, v201, v174
    v_add_f32 v200, 0x3727c5ac, v200
    v_add_f32 v201, 0x3727c5ac, v201
    s_waitcnt lgkmcnt(8)
    v_mfma_f32_32x32x16_bf16 v[80:95], v[144:147], v[128:131], v[80:95]
    s_add_u32 s94, s47, 59392
    buffer_load_dwordx4 a[204:207], v252, s[12:15], s94 offen sc1
    v_rsq_f32 v200, v200
    v_mfma_f32_32x32x16_bf16 v[96:111], v[144:147], v[132:135], v[96:111]
    s_add_u32 s94, s47, 108544
    buffer_load_dwordx4 a[208:211], v252, s[12:15], s94 offen sc1
    v_rsq_f32 v201, v201
    v_mul_f32 v250, v200, v169
    v_mfma_f32_4x4x4_16b_bf16 v[112:115], v[124:125], v[136:137], v[112:115]
    v_mfma_f32_4x4x4_16b_bf16 v[116:119], v[124:125], v[140:141], v[116:119]
    v_mfma_f32_4x4x4_16b_bf16 v[120:123], v[124:125], v[144:145], v[120:123]
    v_mfma_f32_4x4x4_16b_bf16 v[112:115], v[124:125], v[138:139], v[112:115]
    v_mfma_f32_4x4x4_16b_bf16 v[116:119], v[124:125], v[142:143], v[116:119]
    v_mfma_f32_4x4x4_16b_bf16 v[120:123], v[124:125], v[146:147], v[120:123]
    s_waitcnt lgkmcnt(5)
    v_mfma_f32_32x32x16_bf16 v[16:31], v[156:159], v[148:151], v[16:31]
    ds_read_b128 v[128:131], v178 offset:40960
    ds_read_b64_tr_b16 v[136:137], v182 offset:40960
    ds_read_b64_tr_b16 v[138:139], v182 offset:42496
    v_mul_f32 v251, v201, v173
    v_mul_f32_e64 v8, v168, -v250
    s_waitcnt lgkmcnt(7)
    v_mfma_f32_32x32x16_bf16 v[32:47], v[156:159], v[152:155], v[32:47]
    ds_read_b128 v[132:135], v178 offset:45056
    ds_read_b64_tr_b16 v[140:141], v186 offset:41024
    ds_read_b64_tr_b16 v[142:143], v186 offset:42560
    v_mul_f32_e64 v9, v172, -v251
    ds_read_b128 v[218:221], v12 offset:1536
    s_waitcnt lgkmcnt(9)
    v_mfma_f32_32x32x16_bf16 v[48:63], v[160:163], v[148:151], v[48:63]
    s_add_u32 s94, s47, 157696
    buffer_load_dwordx4 a[212:215], v252, s[12:15], s94 offen sc1
    ds_read_b64_tr_b16 v[144:145], v182 offset:41088
    ds_read_b64_tr_b16 v[146:147], v182 offset:42624
    ds_read_b128 v[222:225], v12 offset:1568
    v_mfma_f32_32x32x16_bf16 v[64:79], v[160:163], v[152:155], v[64:79]
    s_add_u32 s94, s47, 206848
    buffer_load_dwordx4 a[216:219], v252, s[12:15], s94 offen sc1
    ds_read_b128 v[226:229], v12 offset:1600
    ds_read_b128 v[230:233], v12 offset:1632
    s_waitcnt lgkmcnt(12)
    v_mfma_f32_32x32x16_bf16 v[80:95], v[164:167], v[148:151], v[80:95]
    s_add_u32 s94, s47, 2048
    buffer_load_dwordx4 a[40:43], v252, s[12:15], s94 offen sc1
    v_mfma_f32_32x32x16_bf16 v[96:111], v[164:167], v[152:155], v[96:111]
    s_add_u32 s94, s47, 51200
    buffer_load_dwordx4 a[44:47], v252, s[12:15], s94 offen sc1
    v_mfma_f32_4x4x4_16b_bf16 v[112:115], v[124:125], v[156:157], v[112:115]
    v_mfma_f32_4x4x4_16b_bf16 v[116:119], v[124:125], v[160:161], v[116:119]
    v_mfma_f32_4x4x4_16b_bf16 v[120:123], v[124:125], v[164:165], v[120:123]
    v_mfma_f32_4x4x4_16b_bf16 v[112:115], v[124:125], v[158:159], v[112:115]
    v_mfma_f32_4x4x4_16b_bf16 v[116:119], v[124:125], v[162:163], v[116:119]
    v_mfma_f32_4x4x4_16b_bf16 v[120:123], v[124:125], v[166:167], v[120:123]
    s_waitcnt lgkmcnt(9)
    v_mfma_f32_32x32x16_bf16 v[16:31], v[136:139], v[128:131], v[16:31]
    ds_read_b128 v[148:151], v179 offset:40960
    ds_read_b64_tr_b16 v[156:157], v183 offset:40960
    ds_read_b64_tr_b16 v[158:159], v183 offset:42496
    s_waitcnt lgkmcnt(11)
    v_mfma_f32_32x32x16_bf16 v[32:47], v[136:139], v[132:135], v[32:47]
    ds_read_b128 v[152:155], v179 offset:45056
    ds_read_b64_tr_b16 v[160:161], v187 offset:41024
    ds_read_b64_tr_b16 v[162:163], v187 offset:42560
    s_waitcnt lgkmcnt(12)
    v_mfma_f32_32x32x16_bf16 v[48:63], v[140:143], v[128:131], v[48:63]
    s_add_u32 s94, s47, 100352
    buffer_load_dwordx4 a[48:51], v252, s[12:15], s94 offen sc1
    ds_read_b64_tr_b16 v[164:165], v183 offset:41088
    ds_read_b64_tr_b16 v[166:167], v183 offset:42624
    v_mfma_f32_32x32x16_bf16 v[64:79], v[140:143], v[132:135], v[64:79]
    s_add_u32 s94, s47, 149504
    buffer_load_dwordx4 a[52:55], v252, s[12:15], s94 offen sc1
    s_waitcnt lgkmcnt(11)
    v_mfma_f32_32x32x16_bf16 v[80:95], v[144:147], v[128:131], v[80:95]
    s_add_u32 s94, s47, 198656
    buffer_load_dwordx4 a[56:59], v252, s[12:15], s94 offen sc1
    v_mfma_f32_32x32x16_bf16 v[96:111], v[144:147], v[132:135], v[96:111]
    s_add_u32 s94, s47, 5120
    buffer_load_dwordx4 a[100:103], v252, s[12:15], s94 offen sc1
    s_waitcnt lgkmcnt(5)
    v_mfma_f32_32x32x16_bf16 v[16:31], v[156:159], v[148:151], v[16:31]
    s_waitcnt lgkmcnt(4)
    v_mfma_f32_32x32x16_bf16 v[32:47], v[156:159], v[152:155], v[32:47]
    s_waitcnt lgkmcnt(2)
    v_mfma_f32_32x32x16_bf16 v[48:63], v[160:163], v[148:151], v[48:63]
    s_add_u32 s94, s47, 54272
    buffer_load_dwordx4 a[104:107], v252, s[12:15], s94 offen sc1
    v_mfma_f32_32x32x16_bf16 v[64:79], v[160:163], v[152:155], v[64:79]
    s_add_u32 s94, s47, 103424
    buffer_load_dwordx4 a[108:111], v252, s[12:15], s94 offen sc1
    s_waitcnt lgkmcnt(0)
    v_mfma_f32_32x32x16_bf16 v[80:95], v[164:167], v[148:151], v[80:95]
    s_add_u32 s94, s47, 152576
    buffer_load_dwordx4 a[112:115], v252, s[12:15], s94 offen sc1
    v_mfma_f32_32x32x16_bf16 v[96:111], v[164:167], v[152:155], v[96:111]
    s_add_u32 s94, s47, 201728
    buffer_load_dwordx4 a[116:119], v252, s[12:15], s94 offen sc1
    v_permlane32_swap_b32 v112, v113
    v_permlane32_swap_b32 v116, v117
    v_permlane32_swap_b32 v120, v121
    v_add_f32 v112, v112, v113
    ds_write_b32 v13, v112 offset:0
    v_add_f32 v116, v116, v117
    ds_write_b32 v13, v116 offset:128
    v_add_f32 v120, v120, v121
    ds_write_b32 v13, v120 offset:256
    s_waitcnt lgkmcnt(0)
    s_barrier
    ds_read_b128 v[186:189], v12 offset:0
    ds_read_b128 v[202:205], v12 offset:768
    ds_read_b128 v[190:193], v12 offset:32
    ds_read_b128 v[206:209], v12 offset:800
    ds_read_b128 v[194:197], v12 offset:64
    ds_read_b128 v[210:213], v12 offset:832
    ds_read_b128 v[198:201], v12 offset:96
    ds_read_b128 v[214:217], v12 offset:864
    v_pk_fma_f32 v[16:17], v[250:251], v[16:17], v[218:219] op_sel:[0,0,0] op_sel_hi:[0,1,1]
    v_pk_fma_f32 v[18:19], v[250:251], v[18:19], v[220:221] op_sel:[0,0,0] op_sel_hi:[0,1,1]
    v_pk_fma_f32 v[20:21], v[250:251], v[20:21], v[222:223] op_sel:[0,0,0] op_sel_hi:[0,1,1]
    v_pk_fma_f32 v[22:23], v[250:251], v[22:23], v[224:225] op_sel:[0,0,0] op_sel_hi:[0,1,1]
    v_pk_fma_f32 v[24:25], v[250:251], v[24:25], v[226:227] op_sel:[0,0,0] op_sel_hi:[0,1,1]
    v_pk_fma_f32 v[26:27], v[250:251], v[26:27], v[228:229] op_sel:[0,0,0] op_sel_hi:[0,1,1]
    v_pk_fma_f32 v[28:29], v[250:251], v[28:29], v[230:231] op_sel:[0,0,0] op_sel_hi:[0,1,1]
    v_pk_fma_f32 v[30:31], v[250:251], v[30:31], v[232:233] op_sel:[0,0,0] op_sel_hi:[0,1,1]
    v_pk_fma_f32 v[32:33], v[250:251], v[32:33], v[218:219] op_sel:[1,0,0] op_sel_hi:[1,1,1]
    v_pk_fma_f32 v[34:35], v[250:251], v[34:35], v[220:221] op_sel:[1,0,0] op_sel_hi:[1,1,1]
    v_pk_fma_f32 v[36:37], v[250:251], v[36:37], v[222:223] op_sel:[1,0,0] op_sel_hi:[1,1,1]
    v_pk_fma_f32 v[38:39], v[250:251], v[38:39], v[224:225] op_sel:[1,0,0] op_sel_hi:[1,1,1]
    v_pk_fma_f32 v[40:41], v[250:251], v[40:41], v[226:227] op_sel:[1,0,0] op_sel_hi:[1,1,1]
    v_pk_fma_f32 v[42:43], v[250:251], v[42:43], v[228:229] op_sel:[1,0,0] op_sel_hi:[1,1,1]
    v_pk_fma_f32 v[44:45], v[250:251], v[44:45], v[230:231] op_sel:[1,0,0] op_sel_hi:[1,1,1]
    v_pk_fma_f32 v[46:47], v[250:251], v[46:47], v[232:233] op_sel:[1,0,0] op_sel_hi:[1,1,1]
    s_mul_i32 s45, s30, 384
    s_mul_i32 s46, s3, 12
    s_add_u32 s45, s45, s46
    s_lshl_b32 s45, s45, 10
    s_add_u32 s45, s45, 9437184
    s_add_u32 s36, s45, 196608
    s_add_u32 s40, s45, 0
    s_add_u32 s37, s45, 245760
    s_add_u32 s41, s45, 49152
    s_add_u32 s38, s45, 294912
    s_add_u32 s42, s45, 98304
    s_add_u32 s39, s45, 344064
    s_add_u32 s43, s45, 147456
    s_waitcnt lgkmcnt(0)
    v_pk_add_f32 v[186:187], v[186:187], v[202:203]
    v_pk_add_f32 v[188:189], v[188:189], v[204:205]
    v_pk_add_f32 v[190:191], v[190:191], v[206:207]
    v_pk_add_f32 v[192:193], v[192:193], v[208:209]
    v_pk_add_f32 v[194:195], v[194:195], v[210:211]
    v_pk_add_f32 v[196:197], v[196:197], v[212:213]
    v_pk_add_f32 v[198:199], v[198:199], v[214:215]
    v_pk_add_f32 v[200:201], v[200:201], v[216:217]
    v_pk_fma_f32 v[16:17], v[8:9], v[186:187], v[16:17] op_sel:[0,0,0] op_sel_hi:[0,1,1]
    v_pk_fma_f32 v[18:19], v[8:9], v[188:189], v[18:19] op_sel:[0,0,0] op_sel_hi:[0,1,1]
    v_pk_fma_f32 v[20:21], v[8:9], v[190:191], v[20:21] op_sel:[0,0,0] op_sel_hi:[0,1,1]
    v_pk_fma_f32 v[22:23], v[8:9], v[192:193], v[22:23] op_sel:[0,0,0] op_sel_hi:[0,1,1]
    v_pk_mul_f32 v[160:161], v[16:17], v[16:17]
    v_pk_mul_f32 v[162:163], v[18:19], v[18:19]
    ds_read_b128 v[112:115], v12 offset:128
    v_pk_mul_f32 v[164:165], v[20:21], v[20:21]
    v_pk_mul_f32 v[166:167], v[22:23], v[22:23]
    v_pk_fma_f32 v[160:161], v[160:161], s[52:53], v[6:7]
    v_pk_fma_f32 v[162:163], v[162:163], s[52:53], v[6:7]
    v_pk_fma_f32 v[164:165], v[164:165], s[52:53], v[6:7]
    v_pk_fma_f32 v[166:167], v[166:167], s[52:53], v[6:7]
    ds_read_b128 v[128:131], v12 offset:896
    v_pk_mul_f32 v[160:161], v[160:161], v[16:17]
    v_pk_mul_f32 v[162:163], v[162:163], v[18:19]
    v_pk_mul_f32 v[164:165], v[164:165], v[20:21]
    v_pk_mul_f32 v[166:167], v[166:167], v[22:23]
    v_exp_f32 v160, v160
    v_exp_f32 v161, v161
    ds_read_b128 v[144:147], v12 offset:1664
    v_exp_f32 v162, v162
    v_exp_f32 v163, v163
    v_exp_f32 v164, v164
    v_exp_f32 v165, v165
    v_exp_f32 v166, v166
    v_exp_f32 v167, v167
    ds_read_b128 v[116:119], v12 offset:160
    v_pk_add_f32 v[160:161], v[160:161], 1.0 op_sel_hi:[1,0]
    v_pk_add_f32 v[162:163], v[162:163], 1.0 op_sel_hi:[1,0]
    v_pk_add_f32 v[164:165], v[164:165], 1.0 op_sel_hi:[1,0]
    v_pk_add_f32 v[166:167], v[166:167], 1.0 op_sel_hi:[1,0]
    v_rcp_f32 v160, v160
    v_rcp_f32 v161, v161
    ds_read_b128 v[132:135], v12 offset:928
    v_rcp_f32 v162, v162
    v_rcp_f32 v163, v163
    v_rcp_f32 v164, v164
    v_rcp_f32 v165, v165
    v_rcp_f32 v166, v166
    v_rcp_f32 v167, v167
    ds_read_b128 v[148:151], v12 offset:1696
    v_pk_mul_f32 v[160:161], v[160:161], v[16:17]
    v_pk_mul_f32 v[162:163], v[162:163], v[18:19]
    v_pk_mul_f32 v[164:165], v[164:165], v[20:21]
    v_pk_mul_f32 v[166:167], v[166:167], v[22:23]
    v_cvt_pk_bf16_f32 v168, v160, v161
    v_cvt_pk_bf16_f32 v169, v162, v163
    ds_read_b128 v[120:123], v12 offset:192
    v_cvt_pk_bf16_f32 v170, v164, v165
    v_cvt_pk_bf16_f32 v171, v166, v167
    v_and_or_b32 v168, v168, s83, v15
    v_and_or_b32 v169, v169, s83, v15
    v_and_or_b32 v170, v170, s83, v15
    v_and_or_b32 v171, v171, s83, v15
    buffer_store_dwordx4 v[168:171], v253, s[12:15], s54 offen offset:0 sc1
    ds_read_b128 v[136:139], v12 offset:960
    v_pk_fma_f32 v[24:25], v[8:9], v[194:195], v[24:25] op_sel:[0,0,0] op_sel_hi:[0,1,1]
    v_pk_fma_f32 v[26:27], v[8:9], v[196:197], v[26:27] op_sel:[0,0,0] op_sel_hi:[0,1,1]
    v_pk_fma_f32 v[28:29], v[8:9], v[198:199], v[28:29] op_sel:[0,0,0] op_sel_hi:[0,1,1]
    v_pk_fma_f32 v[30:31], v[8:9], v[200:201], v[30:31] op_sel:[0,0,0] op_sel_hi:[0,1,1]
    v_pk_mul_f32 v[160:161], v[24:25], v[24:25]
    v_pk_mul_f32 v[162:163], v[26:27], v[26:27]
    ds_read_b128 v[152:155], v12 offset:1728
    v_pk_mul_f32 v[164:165], v[28:29], v[28:29]
    v_pk_mul_f32 v[166:167], v[30:31], v[30:31]
    v_pk_fma_f32 v[160:161], v[160:161], s[52:53], v[6:7]
    v_pk_fma_f32 v[162:163], v[162:163], s[52:53], v[6:7]
    v_pk_fma_f32 v[164:165], v[164:165], s[52:53], v[6:7]
    v_pk_fma_f32 v[166:167], v[166:167], s[52:53], v[6:7]
    ds_read_b128 v[124:127], v12 offset:224
    v_pk_mul_f32 v[160:161], v[160:161], v[24:25]
    v_pk_mul_f32 v[162:163], v[162:163], v[26:27]
    v_pk_mul_f32 v[164:165], v[164:165], v[28:29]
    v_pk_mul_f32 v[166:167], v[166:167], v[30:31]
    v_exp_f32 v160, v160
    v_exp_f32 v161, v161
    ds_read_b128 v[140:143], v12 offset:992
    v_exp_f32 v162, v162
    v_exp_f32 v163, v163
    v_exp_f32 v164, v164
    v_exp_f32 v165, v165
    v_exp_f32 v166, v166
    v_exp_f32 v167, v167
    ds_read_b128 v[156:159], v12 offset:1760
    v_pk_add_f32 v[160:161], v[160:161], 1.0 op_sel_hi:[1,0]
    v_pk_add_f32 v[162:163], v[162:163], 1.0 op_sel_hi:[1,0]
    v_pk_add_f32 v[164:165], v[164:165], 1.0 op_sel_hi:[1,0]
    v_pk_add_f32 v[166:167], v[166:167], 1.0 op_sel_hi:[1,0]
    v_rcp_f32 v160, v160
    v_rcp_f32 v161, v161
    s_add_u32 s94, s47, 8192
    buffer_load_dwordx4 a[160:163], v252, s[12:15], s94 offen sc1
    v_rcp_f32 v162, v162
    v_rcp_f32 v163, v163
    v_rcp_f32 v164, v164
    v_rcp_f32 v165, v165
    v_rcp_f32 v166, v166
    v_rcp_f32 v167, v167
    s_add_u32 s94, s47, 57344
    buffer_load_dwordx4 a[164:167], v252, s[12:15], s94 offen sc1
    v_pk_mul_f32 v[160:161], v[160:161], v[24:25]
    v_pk_mul_f32 v[162:163], v[162:163], v[26:27]
    v_pk_mul_f32 v[164:165], v[164:165], v[28:29]
    v_pk_mul_f32 v[166:167], v[166:167], v[30:31]
    v_cvt_pk_bf16_f32 v172, v160, v161
    v_cvt_pk_bf16_f32 v173, v162, v163
    s_add_u32 s94, s47, 106496
    buffer_load_dwordx4 a[168:171], v252, s[12:15], s94 offen sc1
    v_cvt_pk_bf16_f32 v174, v164, v165
    v_cvt_pk_bf16_f32 v175, v166, v167
    v_and_or_b32 v172, v172, s83, v15
    v_and_or_b32 v173, v173, s83, v15
    v_and_or_b32 v174, v174, s83, v15
    v_and_or_b32 v175, v175, s83, v15
    buffer_store_dwordx4 v[172:175], v253, s[12:15], s54 offen offset:512 sc1
    v_pk_fma_f32 v[32:33], v[8:9], v[186:187], v[32:33] op_sel:[1,0,0] op_sel_hi:[1,1,1]
    v_pk_fma_f32 v[34:35], v[8:9], v[188:189], v[34:35] op_sel:[1,0,0] op_sel_hi:[1,1,1]
    v_pk_fma_f32 v[36:37], v[8:9], v[190:191], v[36:37] op_sel:[1,0,0] op_sel_hi:[1,1,1]
    v_pk_fma_f32 v[38:39], v[8:9], v[192:193], v[38:39] op_sel:[1,0,0] op_sel_hi:[1,1,1]
    v_pk_mul_f32 v[160:161], v[32:33], v[32:33]
    v_pk_mul_f32 v[162:163], v[34:35], v[34:35]
    v_pk_mul_f32 v[164:165], v[36:37], v[36:37]
    v_pk_mul_f32 v[166:167], v[38:39], v[38:39]
    v_pk_fma_f32 v[160:161], v[160:161], s[52:53], v[6:7]
    v_pk_fma_f32 v[162:163], v[162:163], s[52:53], v[6:7]
    v_pk_fma_f32 v[164:165], v[164:165], s[52:53], v[6:7]
    v_pk_fma_f32 v[166:167], v[166:167], s[52:53], v[6:7]
    v_pk_mul_f32 v[160:161], v[160:161], v[32:33]
    v_pk_mul_f32 v[162:163], v[162:163], v[34:35]
    v_pk_mul_f32 v[164:165], v[164:165], v[36:37]
    v_pk_mul_f32 v[166:167], v[166:167], v[38:39]
    v_exp_f32 v160, v160
    v_exp_f32 v161, v161
    v_exp_f32 v162, v162
    v_exp_f32 v163, v163
    v_exp_f32 v164, v164
    v_exp_f32 v165, v165
    v_exp_f32 v166, v166
    v_exp_f32 v167, v167
    v_pk_add_f32 v[160:161], v[160:161], 1.0 op_sel_hi:[1,0]
    v_pk_add_f32 v[162:163], v[162:163], 1.0 op_sel_hi:[1,0]
    v_pk_add_f32 v[164:165], v[164:165], 1.0 op_sel_hi:[1,0]
    v_pk_add_f32 v[166:167], v[166:167], 1.0 op_sel_hi:[1,0]
    v_rcp_f32 v160, v160
    v_rcp_f32 v161, v161
    s_add_u32 s94, s47, 155648
    buffer_load_dwordx4 a[172:175], v252, s[12:15], s94 offen sc1
    v_rcp_f32 v162, v162
    v_rcp_f32 v163, v163
    v_rcp_f32 v164, v164
    v_rcp_f32 v165, v165
    v_rcp_f32 v166, v166
    v_rcp_f32 v167, v167
    v_pk_mul_f32 v[160:161], v[160:161], v[32:33]
    v_pk_mul_f32 v[162:163], v[162:163], v[34:35]
    v_pk_mul_f32 v[164:165], v[164:165], v[36:37]
    v_pk_mul_f32 v[166:167], v[166:167], v[38:39]
    v_cvt_pk_bf16_f32 v234, v160, v161
    v_cvt_pk_bf16_f32 v235, v162, v163
    v_cvt_pk_bf16_f32 v236, v164, v165
    v_cvt_pk_bf16_f32 v237, v166, v167
    v_and_or_b32 v234, v234, s83, v15
    v_and_or_b32 v235, v235, s83, v15
    v_and_or_b32 v236, v236, s83, v15
    v_and_or_b32 v237, v237, s83, v15
    buffer_store_dwordx4 v[234:237], v253, s[12:15], s55 offen offset:0 sc1
    v_pk_fma_f32 v[40:41], v[8:9], v[194:195], v[40:41] op_sel:[1,0,0] op_sel_hi:[1,1,1]
    v_pk_fma_f32 v[42:43], v[8:9], v[196:197], v[42:43] op_sel:[1,0,0] op_sel_hi:[1,1,1]
    v_pk_fma_f32 v[44:45], v[8:9], v[198:199], v[44:45] op_sel:[1,0,0] op_sel_hi:[1,1,1]
    v_pk_fma_f32 v[46:47], v[8:9], v[200:201], v[46:47] op_sel:[1,0,0] op_sel_hi:[1,1,1]
    s_add_u32 s94, s47, 204800
    buffer_load_dwordx4 a[176:179], v252, s[12:15], s94 offen sc1
    v_pk_mul_f32 v[160:161], v[40:41], v[40:41]
    v_pk_mul_f32 v[162:163], v[42:43], v[42:43]
    v_pk_mul_f32 v[164:165], v[44:45], v[44:45]
    v_pk_mul_f32 v[166:167], v[46:47], v[46:47]
    v_pk_fma_f32 v[160:161], v[160:161], s[52:53], v[6:7]
    v_pk_fma_f32 v[162:163], v[162:163], s[52:53], v[6:7]
    v_pk_fma_f32 v[164:165], v[164:165], s[52:53], v[6:7]
    v_pk_fma_f32 v[166:167], v[166:167], s[52:53], v[6:7]
    v_pk_mul_f32 v[160:161], v[160:161], v[40:41]
    v_pk_mul_f32 v[162:163], v[162:163], v[42:43]
    v_pk_mul_f32 v[164:165], v[164:165], v[44:45]
    v_pk_mul_f32 v[166:167], v[166:167], v[46:47]
    v_exp_f32 v160, v160
    v_exp_f32 v161, v161
    v_exp_f32 v162, v162
    v_exp_f32 v163, v163
    v_exp_f32 v164, v164
    v_exp_f32 v165, v165
    v_exp_f32 v166, v166
    v_exp_f32 v167, v167
    v_pk_add_f32 v[160:161], v[160:161], 1.0 op_sel_hi:[1,0]
    v_pk_add_f32 v[162:163], v[162:163], 1.0 op_sel_hi:[1,0]
    s_add_u32 s94, s47, 11264
    buffer_load_dwordx4 a[220:223], v252, s[12:15], s94 offen sc1
    v_pk_add_f32 v[164:165], v[164:165], 1.0 op_sel_hi:[1,0]
    v_pk_add_f32 v[166:167], v[166:167], 1.0 op_sel_hi:[1,0]
    v_rcp_f32 v160, v160
    v_rcp_f32 v161, v161
    v_rcp_f32 v162, v162
    v_rcp_f32 v163, v163
    v_rcp_f32 v164, v164
    v_rcp_f32 v165, v165
    v_rcp_f32 v166, v166
    v_rcp_f32 v167, v167
    v_pk_mul_f32 v[160:161], v[160:161], v[40:41]
    v_pk_mul_f32 v[162:163], v[162:163], v[42:43]
    v_pk_mul_f32 v[164:165], v[164:165], v[44:45]
    v_pk_mul_f32 v[166:167], v[166:167], v[46:47]
    v_cvt_pk_bf16_f32 v238, v160, v161
    v_cvt_pk_bf16_f32 v239, v162, v163
    v_cvt_pk_bf16_f32 v240, v164, v165
    v_cvt_pk_bf16_f32 v241, v166, v167
    v_and_or_b32 v238, v238, s83, v15
    v_and_or_b32 v239, v239, s83, v15
    v_and_or_b32 v240, v240, s83, v15
    v_and_or_b32 v241, v241, s83, v15
    buffer_store_dwordx4 v[238:241], v253, s[12:15], s55 offen offset:512 sc1
    s_waitcnt lgkmcnt(0)
    v_pk_add_f32 v[112:113], v[112:113], v[128:129]
    v_pk_add_f32 v[114:115], v[114:115], v[130:131]
    v_pk_add_f32 v[116:117], v[116:117], v[132:133]
    v_pk_add_f32 v[118:119], v[118:119], v[134:135]
    v_pk_add_f32 v[120:121], v[120:121], v[136:137]
    v_pk_add_f32 v[122:123], v[122:123], v[138:139]
    v_pk_add_f32 v[124:125], v[124:125], v[140:141]
    v_pk_add_f32 v[126:127], v[126:127], v[142:143]
    v_pk_fma_f32 v[48:49], v[250:251], v[48:49], v[144:145] op_sel:[0,0,0] op_sel_hi:[0,1,1]
    v_pk_fma_f32 v[50:51], v[250:251], v[50:51], v[146:147] op_sel:[0,0,0] op_sel_hi:[0,1,1]
    v_pk_fma_f32 v[52:53], v[250:251], v[52:53], v[148:149] op_sel:[0,0,0] op_sel_hi:[0,1,1]
    v_pk_fma_f32 v[54:55], v[250:251], v[54:55], v[150:151] op_sel:[0,0,0] op_sel_hi:[0,1,1]
    v_pk_fma_f32 v[48:49], v[8:9], v[112:113], v[48:49] op_sel:[0,0,0] op_sel_hi:[0,1,1]
    v_pk_fma_f32 v[50:51], v[8:9], v[114:115], v[50:51] op_sel:[0,0,0] op_sel_hi:[0,1,1]
    v_pk_fma_f32 v[52:53], v[8:9], v[116:117], v[52:53] op_sel:[0,0,0] op_sel_hi:[0,1,1]
    ds_read_b128 v[186:189], v12 offset:256
    v_pk_fma_f32 v[54:55], v[8:9], v[118:119], v[54:55] op_sel:[0,0,0] op_sel_hi:[0,1,1]
    v_pk_mul_f32 v[160:161], v[48:49], v[48:49]
    v_pk_mul_f32 v[162:163], v[50:51], v[50:51]
    v_pk_mul_f32 v[164:165], v[52:53], v[52:53]
    v_pk_mul_f32 v[166:167], v[54:55], v[54:55]
    v_pk_fma_f32 v[160:161], v[160:161], s[52:53], v[6:7]
    v_pk_fma_f32 v[162:163], v[162:163], s[52:53], v[6:7]
    ds_read_b128 v[202:205], v12 offset:1024
    v_pk_fma_f32 v[164:165], v[164:165], s[52:53], v[6:7]
    v_pk_fma_f32 v[166:167], v[166:167], s[52:53], v[6:7]
    v_pk_mul_f32 v[160:161], v[160:161], v[48:49]
    v_pk_mul_f32 v[162:163], v[162:163], v[50:51]
    v_pk_mul_f32 v[164:165], v[164:165], v[52:53]
    v_pk_mul_f32 v[166:167], v[166:167], v[54:55]
    v_exp_f32 v160, v160
    ds_read_b128 v[218:221], v12 offset:1792
    v_exp_f32 v161, v161
    v_exp_f32 v162, v162
    v_exp_f32 v163, v163
    v_exp_f32 v164, v164
    v_exp_f32 v165, v165
    v_exp_f32 v166, v166
    v_exp_f32 v167, v167
    ds_read_b128 v[190:193], v12 offset:288
    v_pk_add_f32 v[160:161], v[160:161], 1.0 op_sel_hi:[1,0]
    v_pk_add_f32 v[162:163], v[162:163], 1.0 op_sel_hi:[1,0]
    v_pk_add_f32 v[164:165], v[164:165], 1.0 op_sel_hi:[1,0]
    v_pk_add_f32 v[166:167], v[166:167], 1.0 op_sel_hi:[1,0]
    v_rcp_f32 v160, v160
    v_rcp_f32 v161, v161
    v_rcp_f32 v162, v162
    ds_read_b128 v[206:209], v12 offset:1056
    v_rcp_f32 v163, v163
    v_rcp_f32 v164, v164
    v_rcp_f32 v165, v165
    v_rcp_f32 v166, v166
    v_rcp_f32 v167, v167
    v_pk_mul_f32 v[160:161], v[160:161], v[48:49]
    v_pk_mul_f32 v[162:163], v[162:163], v[50:51]
    ds_read_b128 v[222:225], v12 offset:1824
    v_pk_mul_f32 v[164:165], v[164:165], v[52:53]
    v_pk_mul_f32 v[166:167], v[166:167], v[54:55]
    v_cvt_pk_bf16_f32 v168, v160, v161
    v_cvt_pk_bf16_f32 v169, v162, v163
    v_cvt_pk_bf16_f32 v170, v164, v165
    v_cvt_pk_bf16_f32 v171, v166, v167
    v_and_or_b32 v168, v168, s83, v15
    ds_read_b128 v[194:197], v12 offset:320
    v_and_or_b32 v169, v169, s83, v15
    v_and_or_b32 v170, v170, s83, v15
    v_and_or_b32 v171, v171, s83, v15
    buffer_store_dwordx4 v[168:171], v253, s[12:15], s54 offen offset:1024 sc1
    v_pk_fma_f32 v[56:57], v[250:251], v[56:57], v[152:153] op_sel:[0,0,0] op_sel_hi:[0,1,1]
    v_pk_fma_f32 v[58:59], v[250:251], v[58:59], v[154:155] op_sel:[0,0,0] op_sel_hi:[0,1,1]
    v_pk_fma_f32 v[60:61], v[250:251], v[60:61], v[156:157] op_sel:[0,0,0] op_sel_hi:[0,1,1]
    ds_read_b128 v[210:213], v12 offset:1088
    v_pk_fma_f32 v[62:63], v[250:251], v[62:63], v[158:159] op_sel:[0,0,0] op_sel_hi:[0,1,1]
    v_pk_fma_f32 v[56:57], v[8:9], v[120:121], v[56:57] op_sel:[0,0,0] op_sel_hi:[0,1,1]
    v_pk_fma_f32 v[58:59], v[8:9], v[122:123], v[58:59] op_sel:[0,0,0] op_sel_hi:[0,1,1]
    v_pk_fma_f32 v[60:61], v[8:9], v[124:125], v[60:61] op_sel:[0,0,0] op_sel_hi:[0,1,1]
    v_pk_fma_f32 v[62:63], v[8:9], v[126:127], v[62:63] op_sel:[0,0,0] op_sel_hi:[0,1,1]
    v_pk_mul_f32 v[160:161], v[56:57], v[56:57]
    v_pk_mul_f32 v[162:163], v[58:59], v[58:59]
    ds_read_b128 v[226:229], v12 offset:1856
    v_pk_mul_f32 v[164:165], v[60:61], v[60:61]
    v_pk_mul_f32 v[166:167], v[62:63], v[62:63]
    v_pk_fma_f32 v[160:161], v[160:161], s[52:53], v[6:7]
    v_pk_fma_f32 v[162:163], v[162:163], s[52:53], v[6:7]
    v_pk_fma_f32 v[164:165], v[164:165], s[52:53], v[6:7]
    v_pk_fma_f32 v[166:167], v[166:167], s[52:53], v[6:7]
    v_pk_mul_f32 v[160:161], v[160:161], v[56:57]
    ds_read_b128 v[198:201], v12 offset:352
    v_pk_mul_f32 v[162:163], v[162:163], v[58:59]
    v_pk_mul_f32 v[164:165], v[164:165], v[60:61]
    v_pk_mul_f32 v[166:167], v[166:167], v[62:63]
    v_exp_f32 v160, v160
    v_exp_f32 v161, v161
    v_exp_f32 v162, v162
    v_exp_f32 v163, v163
    ds_read_b128 v[214:217], v12 offset:1120
    v_exp_f32 v164, v164
    v_exp_f32 v165, v165
    v_exp_f32 v166, v166
    v_exp_f32 v167, v167
    v_pk_add_f32 v[160:161], v[160:161], 1.0 op_sel_hi:[1,0]
    v_pk_add_f32 v[162:163], v[162:163], 1.0 op_sel_hi:[1,0]
    v_pk_add_f32 v[164:165], v[164:165], 1.0 op_sel_hi:[1,0]
    ds_read_b128 v[230:233], v12 offset:1888
    v_pk_add_f32 v[166:167], v[166:167], 1.0 op_sel_hi:[1,0]
    v_rcp_f32 v160, v160
    v_rcp_f32 v161, v161
    v_rcp_f32 v162, v162
    v_rcp_f32 v163, v163
    v_rcp_f32 v164, v164
    v_rcp_f32 v165, v165
    s_add_u32 s94, s47, 60416
    buffer_load_dwordx4 a[224:227], v252, s[12:15], s94 offen sc1
    v_rcp_f32 v166, v166
    v_rcp_f32 v167, v167
    v_pk_mul_f32 v[160:161], v[160:161], v[56:57]
    v_pk_mul_f32 v[162:163], v[162:163], v[58:59]
    v_pk_mul_f32 v[164:165], v[164:165], v[60:61]
    v_pk_mul_f32 v[166:167], v[166:167], v[62:63]
    v_cvt_pk_bf16_f32 v172, v160, v161
    s_add_u32 s94, s47, 109568
    buffer_load_dwordx4 a[228:231], v252, s[12:15], s94 offen sc1
    v_cvt_pk_bf16_f32 v173, v162, v163
    v_cvt_pk_bf16_f32 v174, v164, v165
    v_cvt_pk_bf16_f32 v175, v166, v167
    v_and_or_b32 v172, v172, s83, v15
    v_and_or_b32 v173, v173, s83, v15
    v_and_or_b32 v174, v174, s83, v15
    v_and_or_b32 v175, v175, s83, v15
    buffer_store_dwordx4 v[172:175], v253, s[12:15], s54 offen offset:1536 sc1
    v_pk_fma_f32 v[64:65], v[250:251], v[64:65], v[144:145] op_sel:[1,0,0] op_sel_hi:[1,1,1]
    v_pk_fma_f32 v[66:67], v[250:251], v[66:67], v[146:147] op_sel:[1,0,0] op_sel_hi:[1,1,1]
    v_pk_fma_f32 v[68:69], v[250:251], v[68:69], v[148:149] op_sel:[1,0,0] op_sel_hi:[1,1,1]
    v_pk_fma_f32 v[70:71], v[250:251], v[70:71], v[150:151] op_sel:[1,0,0] op_sel_hi:[1,1,1]
    v_pk_fma_f32 v[64:65], v[8:9], v[112:113], v[64:65] op_sel:[1,0,0] op_sel_hi:[1,1,1]
    v_pk_fma_f32 v[66:67], v[8:9], v[114:115], v[66:67] op_sel:[1,0,0] op_sel_hi:[1,1,1]
    v_pk_fma_f32 v[68:69], v[8:9], v[116:117], v[68:69] op_sel:[1,0,0] op_sel_hi:[1,1,1]
    v_pk_fma_f32 v[70:71], v[8:9], v[118:119], v[70:71] op_sel:[1,0,0] op_sel_hi:[1,1,1]
    v_pk_mul_f32 v[160:161], v[64:65], v[64:65]
    v_pk_mul_f32 v[162:163], v[66:67], v[66:67]
    v_pk_mul_f32 v[164:165], v[68:69], v[68:69]
    v_pk_mul_f32 v[166:167], v[70:71], v[70:71]
    v_pk_fma_f32 v[160:161], v[160:161], s[52:53], v[6:7]
    v_pk_fma_f32 v[162:163], v[162:163], s[52:53], v[6:7]
    v_pk_fma_f32 v[164:165], v[164:165], s[52:53], v[6:7]
    v_pk_fma_f32 v[166:167], v[166:167], s[52:53], v[6:7]
    v_pk_mul_f32 v[160:161], v[160:161], v[64:65]
    v_pk_mul_f32 v[162:163], v[162:163], v[66:67]
    v_pk_mul_f32 v[164:165], v[164:165], v[68:69]
    v_pk_mul_f32 v[166:167], v[166:167], v[70:71]
    v_exp_f32 v160, v160
    v_exp_f32 v161, v161
    v_exp_f32 v162, v162
    v_exp_f32 v163, v163
    v_exp_f32 v164, v164
    v_exp_f32 v165, v165
    v_exp_f32 v166, v166
    v_exp_f32 v167, v167
    v_pk_add_f32 v[160:161], v[160:161], 1.0 op_sel_hi:[1,0]
    v_pk_add_f32 v[162:163], v[162:163], 1.0 op_sel_hi:[1,0]
    v_pk_add_f32 v[164:165], v[164:165], 1.0 op_sel_hi:[1,0]
    v_pk_add_f32 v[166:167], v[166:167], 1.0 op_sel_hi:[1,0]
    v_rcp_f32 v160, v160
    v_rcp_f32 v161, v161
    v_rcp_f32 v162, v162
    v_rcp_f32 v163, v163
    v_rcp_f32 v164, v164
    v_rcp_f32 v165, v165
    v_rcp_f32 v166, v166
    v_rcp_f32 v167, v167
    s_add_u32 s94, s47, 158720
    buffer_load_dwordx4 a[232:235], v252, s[12:15], s94 offen sc1
    v_pk_mul_f32 v[160:161], v[160:161], v[64:65]
    v_pk_mul_f32 v[162:163], v[162:163], v[66:67]
    v_pk_mul_f32 v[164:165], v[164:165], v[68:69]
    v_pk_mul_f32 v[166:167], v[166:167], v[70:71]
    v_cvt_pk_bf16_f32 v234, v160, v161
    v_cvt_pk_bf16_f32 v235, v162, v163
    v_cvt_pk_bf16_f32 v236, v164, v165
    v_cvt_pk_bf16_f32 v237, v166, v167
    v_and_or_b32 v234, v234, s83, v15
    v_and_or_b32 v235, v235, s83, v15
    v_and_or_b32 v236, v236, s83, v15
    v_and_or_b32 v237, v237, s83, v15
    buffer_store_dwordx4 v[234:237], v253, s[12:15], s55 offen offset:1024 sc1
    v_pk_fma_f32 v[72:73], v[250:251], v[72:73], v[152:153] op_sel:[1,0,0] op_sel_hi:[1,1,1]
    v_pk_fma_f32 v[74:75], v[250:251], v[74:75], v[154:155] op_sel:[1,0,0] op_sel_hi:[1,1,1]
    v_pk_fma_f32 v[76:77], v[250:251], v[76:77], v[156:157] op_sel:[1,0,0] op_sel_hi:[1,1,1]
    v_pk_fma_f32 v[78:79], v[250:251], v[78:79], v[158:159] op_sel:[1,0,0] op_sel_hi:[1,1,1]
    v_pk_fma_f32 v[72:73], v[8:9], v[120:121], v[72:73] op_sel:[1,0,0] op_sel_hi:[1,1,1]
    v_pk_fma_f32 v[74:75], v[8:9], v[122:123], v[74:75] op_sel:[1,0,0] op_sel_hi:[1,1,1]
    v_pk_fma_f32 v[76:77], v[8:9], v[124:125], v[76:77] op_sel:[1,0,0] op_sel_hi:[1,1,1]
    v_pk_fma_f32 v[78:79], v[8:9], v[126:127], v[78:79] op_sel:[1,0,0] op_sel_hi:[1,1,1]
    v_pk_mul_f32 v[160:161], v[72:73], v[72:73]
    v_pk_mul_f32 v[162:163], v[74:75], v[74:75]
    v_pk_mul_f32 v[164:165], v[76:77], v[76:77]
    v_pk_mul_f32 v[166:167], v[78:79], v[78:79]
    v_pk_fma_f32 v[160:161], v[160:161], s[52:53], v[6:7]
    v_pk_fma_f32 v[162:163], v[162:163], s[52:53], v[6:7]
    v_pk_fma_f32 v[164:165], v[164:165], s[52:53], v[6:7]
    v_pk_fma_f32 v[166:167], v[166:167], s[52:53], v[6:7]
    v_pk_mul_f32 v[160:161], v[160:161], v[72:73]
    v_pk_mul_f32 v[162:163], v[162:163], v[74:75]
    v_pk_mul_f32 v[164:165], v[164:165], v[76:77]
    v_pk_mul_f32 v[166:167], v[166:167], v[78:79]
    s_add_u32 s94, s47, 207872
    buffer_load_dwordx4 a[236:239], v252, s[12:15], s94 offen sc1
    v_exp_f32 v160, v160
    v_exp_f32 v161, v161
    v_exp_f32 v162, v162
    v_exp_f32 v163, v163
    v_exp_f32 v164, v164
    v_exp_f32 v165, v165
    v_exp_f32 v166, v166
    v_exp_f32 v167, v167
    v_pk_add_f32 v[160:161], v[160:161], 1.0 op_sel_hi:[1,0]
    v_pk_add_f32 v[162:163], v[162:163], 1.0 op_sel_hi:[1,0]
    v_pk_add_f32 v[164:165], v[164:165], 1.0 op_sel_hi:[1,0]
    v_pk_add_f32 v[166:167], v[166:167], 1.0 op_sel_hi:[1,0]
    v_rcp_f32 v160, v160
    v_rcp_f32 v161, v161
    v_rcp_f32 v162, v162
    v_rcp_f32 v163, v163
    v_rcp_f32 v164, v164
    v_rcp_f32 v165, v165
    v_rcp_f32 v166, v166
    v_rcp_f32 v167, v167
    v_pk_mul_f32 v[160:161], v[160:161], v[72:73]
    v_pk_mul_f32 v[162:163], v[162:163], v[74:75]
    v_pk_mul_f32 v[164:165], v[164:165], v[76:77]
    v_pk_mul_f32 v[166:167], v[166:167], v[78:79]
    v_cvt_pk_bf16_f32 v238, v160, v161
    v_cvt_pk_bf16_f32 v239, v162, v163
    v_cvt_pk_bf16_f32 v240, v164, v165
    v_cvt_pk_bf16_f32 v241, v166, v167
    v_and_or_b32 v238, v238, s83, v15
    v_and_or_b32 v239, v239, s83, v15
    v_and_or_b32 v240, v240, s83, v15
    v_and_or_b32 v241, v241, s83, v15
    buffer_store_dwordx4 v[238:241], v253, s[12:15], s55 offen offset:1536 sc1
    s_waitcnt lgkmcnt(0)
    v_pk_add_f32 v[186:187], v[186:187], v[202:203]
    v_pk_add_f32 v[188:189], v[188:189], v[204:205]
    v_pk_add_f32 v[190:191], v[190:191], v[206:207]
    v_pk_add_f32 v[192:193], v[192:193], v[208:209]
    v_pk_add_f32 v[194:195], v[194:195], v[210:211]
    v_pk_add_f32 v[196:197], v[196:197], v[212:213]
    v_pk_add_f32 v[198:199], v[198:199], v[214:215]
    v_pk_add_f32 v[200:201], v[200:201], v[216:217]
    v_pk_fma_f32 v[80:81], v[250:251], v[80:81], v[218:219] op_sel:[0,0,0] op_sel_hi:[0,1,1]
    v_pk_fma_f32 v[82:83], v[250:251], v[82:83], v[220:221] op_sel:[0,0,0] op_sel_hi:[0,1,1]
    v_pk_fma_f32 v[84:85], v[250:251], v[84:85], v[222:223] op_sel:[0,0,0] op_sel_hi:[0,1,1]
    v_pk_fma_f32 v[86:87], v[250:251], v[86:87], v[224:225] op_sel:[0,0,0] op_sel_hi:[0,1,1]
    v_pk_fma_f32 v[80:81], v[8:9], v[186:187], v[80:81] op_sel:[0,0,0] op_sel_hi:[0,1,1]
    v_pk_fma_f32 v[82:83], v[8:9], v[188:189], v[82:83] op_sel:[0,0,0] op_sel_hi:[0,1,1]
    v_pk_fma_f32 v[84:85], v[8:9], v[190:191], v[84:85] op_sel:[0,0,0] op_sel_hi:[0,1,1]
    v_pk_fma_f32 v[86:87], v[8:9], v[192:193], v[86:87] op_sel:[0,0,0] op_sel_hi:[0,1,1]
    v_pk_mul_f32 v[160:161], v[80:81], v[80:81]
    v_pk_mul_f32 v[162:163], v[82:83], v[82:83]
    v_pk_mul_f32 v[164:165], v[84:85], v[84:85]
    buffer_load_dwordx4 v[16:19], v252, s[12:15], s36 offen offset:0 sc1
    v_pk_mul_f32 v[166:167], v[86:87], v[86:87]
    v_pk_fma_f32 v[160:161], v[160:161], s[52:53], v[6:7]
    v_pk_fma_f32 v[162:163], v[162:163], s[52:53], v[6:7]
    v_pk_fma_f32 v[164:165], v[164:165], s[52:53], v[6:7]
    v_pk_fma_f32 v[166:167], v[166:167], s[52:53], v[6:7]
    v_pk_mul_f32 v[160:161], v[160:161], v[80:81]
    v_pk_mul_f32 v[162:163], v[162:163], v[82:83]
    v_pk_mul_f32 v[164:165], v[164:165], v[84:85]
    v_pk_mul_f32 v[166:167], v[166:167], v[86:87]
    v_exp_f32 v160, v160
    v_exp_f32 v161, v161
    v_exp_f32 v162, v162
    buffer_load_dwordx4 v[20:23], v252, s[12:15], s37 offen offset:0 sc1
    v_exp_f32 v163, v163
    v_exp_f32 v164, v164
    v_exp_f32 v165, v165
    v_exp_f32 v166, v166
    v_exp_f32 v167, v167
    v_pk_add_f32 v[160:161], v[160:161], 1.0 op_sel_hi:[1,0]
    v_pk_add_f32 v[162:163], v[162:163], 1.0 op_sel_hi:[1,0]
    v_pk_add_f32 v[164:165], v[164:165], 1.0 op_sel_hi:[1,0]
    v_pk_add_f32 v[166:167], v[166:167], 1.0 op_sel_hi:[1,0]
    v_rcp_f32 v160, v160
    v_rcp_f32 v161, v161
    buffer_load_dwordx4 v[24:27], v252, s[12:15], s38 offen offset:0 sc1
    v_rcp_f32 v162, v162
    v_rcp_f32 v163, v163
    v_rcp_f32 v164, v164
    v_rcp_f32 v165, v165
    v_rcp_f32 v166, v166
    v_rcp_f32 v167, v167
    v_pk_mul_f32 v[160:161], v[160:161], v[80:81]
    v_pk_mul_f32 v[162:163], v[162:163], v[82:83]
    v_pk_mul_f32 v[164:165], v[164:165], v[84:85]
    v_pk_mul_f32 v[166:167], v[166:167], v[86:87]
    v_cvt_pk_bf16_f32 v168, v160, v161
    v_cvt_pk_bf16_f32 v169, v162, v163
    buffer_load_dwordx4 v[28:31], v252, s[12:15], s39 offen offset:0 sc1
    v_cvt_pk_bf16_f32 v170, v164, v165
    v_cvt_pk_bf16_f32 v171, v166, v167
    v_and_or_b32 v168, v168, s83, v15
    v_and_or_b32 v169, v169, s83, v15
    v_and_or_b32 v170, v170, s83, v15
    v_and_or_b32 v171, v171, s83, v15
    v_pk_fma_f32 v[88:89], v[250:251], v[88:89], v[226:227] op_sel:[0,0,0] op_sel_hi:[0,1,1]
    v_pk_fma_f32 v[90:91], v[250:251], v[90:91], v[228:229] op_sel:[0,0,0] op_sel_hi:[0,1,1]
    v_pk_fma_f32 v[92:93], v[250:251], v[92:93], v[230:231] op_sel:[0,0,0] op_sel_hi:[0,1,1]
    v_pk_fma_f32 v[94:95], v[250:251], v[94:95], v[232:233] op_sel:[0,0,0] op_sel_hi:[0,1,1]
    v_pk_fma_f32 v[88:89], v[8:9], v[194:195], v[88:89] op_sel:[0,0,0] op_sel_hi:[0,1,1]
    buffer_load_dwordx4 v[32:35], v252, s[12:15], s36 offen offset:3072 sc1
    v_pk_fma_f32 v[90:91], v[8:9], v[196:197], v[90:91] op_sel:[0,0,0] op_sel_hi:[0,1,1]
    v_pk_fma_f32 v[92:93], v[8:9], v[198:199], v[92:93] op_sel:[0,0,0] op_sel_hi:[0,1,1]
    v_pk_fma_f32 v[94:95], v[8:9], v[200:201], v[94:95] op_sel:[0,0,0] op_sel_hi:[0,1,1]
    v_pk_mul_f32 v[160:161], v[88:89], v[88:89]
    v_pk_mul_f32 v[162:163], v[90:91], v[90:91]
    v_pk_mul_f32 v[164:165], v[92:93], v[92:93]
    v_pk_mul_f32 v[166:167], v[94:95], v[94:95]
    v_pk_fma_f32 v[160:161], v[160:161], s[52:53], v[6:7]
    v_pk_fma_f32 v[162:163], v[162:163], s[52:53], v[6:7]
    v_pk_fma_f32 v[164:165], v[164:165], s[52:53], v[6:7]
    v_pk_fma_f32 v[166:167], v[166:167], s[52:53], v[6:7]
    v_pk_mul_f32 v[160:161], v[160:161], v[88:89]
    buffer_load_dwordx4 v[36:39], v252, s[12:15], s37 offen offset:3072 sc1
    v_pk_mul_f32 v[162:163], v[162:163], v[90:91]
    v_pk_mul_f32 v[164:165], v[164:165], v[92:93]
    v_pk_mul_f32 v[166:167], v[166:167], v[94:95]
    v_exp_f32 v160, v160
    v_exp_f32 v161, v161
    v_exp_f32 v162, v162
    v_exp_f32 v163, v163
    v_exp_f32 v164, v164
    v_exp_f32 v165, v165
    v_exp_f32 v166, v166
    v_exp_f32 v167, v167
    s_waitcnt vmcnt(52)
    buffer_load_dwordx4 v[40:43], v252, s[12:15], s38 offen offset:3072 sc1
    v_pk_add_f32 v[160:161], v[160:161], 1.0 op_sel_hi:[1,0]
    v_pk_add_f32 v[162:163], v[162:163], 1.0 op_sel_hi:[1,0]
    v_pk_add_f32 v[164:165], v[164:165], 1.0 op_sel_hi:[1,0]
    v_pk_add_f32 v[166:167], v[166:167], 1.0 op_sel_hi:[1,0]
    v_rcp_f32 v160, v160
    v_rcp_f32 v161, v161
    v_rcp_f32 v162, v162
    v_rcp_f32 v163, v163
    v_rcp_f32 v164, v164
    v_rcp_f32 v165, v165
    v_rcp_f32 v166, v166
    v_rcp_f32 v167, v167
    buffer_load_dwordx4 v[44:47], v252, s[12:15], s39 offen offset:3072 sc1
    v_pk_mul_f32 v[160:161], v[160:161], v[88:89]
    v_pk_mul_f32 v[162:163], v[162:163], v[90:91]
    v_pk_mul_f32 v[164:165], v[164:165], v[92:93]
    v_pk_mul_f32 v[166:167], v[166:167], v[94:95]
    v_cvt_pk_bf16_f32 v172, v160, v161
    v_cvt_pk_bf16_f32 v173, v162, v163
    v_cvt_pk_bf16_f32 v174, v164, v165
    v_cvt_pk_bf16_f32 v175, v166, v167
    v_and_or_b32 v172, v172, s83, v15
    v_and_or_b32 v173, v173, s83, v15
    v_and_or_b32 v174, v174, s83, v15
    v_and_or_b32 v175, v175, s83, v15
    v_pk_fma_f32 v[96:97], v[250:251], v[96:97], v[218:219] op_sel:[1,0,0] op_sel_hi:[1,1,1]
    v_pk_fma_f32 v[98:99], v[250:251], v[98:99], v[220:221] op_sel:[1,0,0] op_sel_hi:[1,1,1]
    v_pk_fma_f32 v[100:101], v[250:251], v[100:101], v[222:223] op_sel:[1,0,0] op_sel_hi:[1,1,1]
    v_pk_fma_f32 v[102:103], v[250:251], v[102:103], v[224:225] op_sel:[1,0,0] op_sel_hi:[1,1,1]
    v_pk_fma_f32 v[96:97], v[8:9], v[186:187], v[96:97] op_sel:[1,0,0] op_sel_hi:[1,1,1]
    v_pk_fma_f32 v[98:99], v[8:9], v[188:189], v[98:99] op_sel:[1,0,0] op_sel_hi:[1,1,1]
    v_pk_fma_f32 v[100:101], v[8:9], v[190:191], v[100:101] op_sel:[1,0,0] op_sel_hi:[1,1,1]
    v_pk_fma_f32 v[102:103], v[8:9], v[192:193], v[102:103] op_sel:[1,0,0] op_sel_hi:[1,1,1]
    v_pk_mul_f32 v[160:161], v[96:97], v[96:97]
    v_pk_mul_f32 v[162:163], v[98:99], v[98:99]
    v_pk_mul_f32 v[164:165], v[100:101], v[100:101]
    v_pk_mul_f32 v[166:167], v[102:103], v[102:103]
    v_pk_fma_f32 v[160:161], v[160:161], s[52:53], v[6:7]
    v_pk_fma_f32 v[162:163], v[162:163], s[52:53], v[6:7]
    v_pk_fma_f32 v[164:165], v[164:165], s[52:53], v[6:7]
    v_pk_fma_f32 v[166:167], v[166:167], s[52:53], v[6:7]
    v_pk_mul_f32 v[160:161], v[160:161], v[96:97]
    v_pk_mul_f32 v[162:163], v[162:163], v[98:99]
    s_add_u32 s45, s36, 4096
    buffer_load_dwordx4 v[48:51], v252, s[12:15], s45 offen offset:2048 sc1
    v_pk_mul_f32 v[164:165], v[164:165], v[100:101]
    v_pk_mul_f32 v[166:167], v[166:167], v[102:103]
    v_exp_f32 v160, v160
    v_exp_f32 v161, v161
    v_exp_f32 v162, v162
    v_exp_f32 v163, v163
    v_exp_f32 v164, v164
    v_exp_f32 v165, v165
    v_exp_f32 v166, v166
    v_exp_f32 v167, v167
    v_pk_add_f32 v[160:161], v[160:161], 1.0 op_sel_hi:[1,0]
    s_add_u32 s45, s37, 4096
    buffer_load_dwordx4 v[52:55], v252, s[12:15], s45 offen offset:2048 sc1
    v_pk_add_f32 v[162:163], v[162:163], 1.0 op_sel_hi:[1,0]
    v_pk_add_f32 v[164:165], v[164:165], 1.0 op_sel_hi:[1,0]
    v_pk_add_f32 v[166:167], v[166:167], 1.0 op_sel_hi:[1,0]
    v_rcp_f32 v160, v160
    v_rcp_f32 v161, v161
    v_rcp_f32 v162, v162
    v_rcp_f32 v163, v163
    v_rcp_f32 v164, v164
    v_rcp_f32 v165, v165
    v_rcp_f32 v166, v166
    v_rcp_f32 v167, v167
    s_add_u32 s45, s38, 4096
    buffer_load_dwordx4 v[56:59], v252, s[12:15], s45 offen offset:2048 sc1
    v_pk_mul_f32 v[160:161], v[160:161], v[96:97]
    v_pk_mul_f32 v[162:163], v[162:163], v[98:99]
    v_pk_mul_f32 v[164:165], v[164:165], v[100:101]
    v_pk_mul_f32 v[166:167], v[166:167], v[102:103]
    v_cvt_pk_bf16_f32 v234, v160, v161
    v_cvt_pk_bf16_f32 v235, v162, v163
    v_cvt_pk_bf16_f32 v236, v164, v165
    v_cvt_pk_bf16_f32 v237, v166, v167
    v_and_or_b32 v234, v234, s83, v15
    v_and_or_b32 v235, v235, s83, v15
    s_add_u32 s45, s39, 4096
    buffer_load_dwordx4 v[60:63], v252, s[12:15], s45 offen offset:2048 sc1
    v_and_or_b32 v236, v236, s83, v15
    v_and_or_b32 v237, v237, s83, v15
    v_pk_fma_f32 v[104:105], v[250:251], v[104:105], v[226:227] op_sel:[1,0,0] op_sel_hi:[1,1,1]
    v_pk_fma_f32 v[106:107], v[250:251], v[106:107], v[228:229] op_sel:[1,0,0] op_sel_hi:[1,1,1]
    v_pk_fma_f32 v[108:109], v[250:251], v[108:109], v[230:231] op_sel:[1,0,0] op_sel_hi:[1,1,1]
    v_pk_fma_f32 v[110:111], v[250:251], v[110:111], v[232:233] op_sel:[1,0,0] op_sel_hi:[1,1,1]
    v_pk_fma_f32 v[104:105], v[8:9], v[194:195], v[104:105] op_sel:[1,0,0] op_sel_hi:[1,1,1]
    v_pk_fma_f32 v[106:107], v[8:9], v[196:197], v[106:107] op_sel:[1,0,0] op_sel_hi:[1,1,1]
    v_pk_fma_f32 v[108:109], v[8:9], v[198:199], v[108:109] op_sel:[1,0,0] op_sel_hi:[1,1,1]
    v_pk_fma_f32 v[110:111], v[8:9], v[200:201], v[110:111] op_sel:[1,0,0] op_sel_hi:[1,1,1]
    v_pk_mul_f32 v[160:161], v[104:105], v[104:105]
    s_add_u32 s45, s36, 8192
    buffer_load_dwordx4 v[64:67], v252, s[12:15], s45 offen offset:1024 sc1
    v_pk_mul_f32 v[162:163], v[106:107], v[106:107]
    v_pk_mul_f32 v[164:165], v[108:109], v[108:109]
    v_pk_mul_f32 v[166:167], v[110:111], v[110:111]
    v_pk_fma_f32 v[160:161], v[160:161], s[52:53], v[6:7]
    v_pk_fma_f32 v[162:163], v[162:163], s[52:53], v[6:7]
    v_pk_fma_f32 v[164:165], v[164:165], s[52:53], v[6:7]
    v_pk_fma_f32 v[166:167], v[166:167], s[52:53], v[6:7]
    v_pk_mul_f32 v[160:161], v[160:161], v[104:105]
    v_pk_mul_f32 v[162:163], v[162:163], v[106:107]
    v_pk_mul_f32 v[164:165], v[164:165], v[108:109]
    v_pk_mul_f32 v[166:167], v[166:167], v[110:111]
    s_add_u32 s45, s37, 8192
    buffer_load_dwordx4 v[68:71], v252, s[12:15], s45 offen offset:1024 sc1
    v_exp_f32 v160, v160
    v_exp_f32 v161, v161
    v_exp_f32 v162, v162
    v_exp_f32 v163, v163
    v_exp_f32 v164, v164
    v_exp_f32 v165, v165
    v_exp_f32 v166, v166
    v_exp_f32 v167, v167
    v_pk_add_f32 v[160:161], v[160:161], 1.0 op_sel_hi:[1,0]
    v_pk_add_f32 v[162:163], v[162:163], 1.0 op_sel_hi:[1,0]
    s_add_u32 s45, s38, 8192
    buffer_load_dwordx4 v[72:75], v252, s[12:15], s45 offen offset:1024 sc1
    v_pk_add_f32 v[164:165], v[164:165], 1.0 op_sel_hi:[1,0]
    v_pk_add_f32 v[166:167], v[166:167], 1.0 op_sel_hi:[1,0]
    v_rcp_f32 v160, v160
    v_rcp_f32 v161, v161
    v_rcp_f32 v162, v162
    v_rcp_f32 v163, v163
    v_rcp_f32 v164, v164
    v_rcp_f32 v165, v165
    v_rcp_f32 v166, v166
    v_rcp_f32 v167, v167
    v_pk_mul_f32 v[160:161], v[160:161], v[104:105]
    s_add_u32 s45, s39, 8192
    buffer_load_dwordx4 v[76:79], v252, s[12:15], s45 offen offset:1024 sc1
    v_pk_mul_f32 v[162:163], v[162:163], v[106:107]
    v_pk_mul_f32 v[164:165], v[164:165], v[108:109]
    v_pk_mul_f32 v[166:167], v[166:167], v[110:111]
    v_cvt_pk_bf16_f32 v238, v160, v161
    v_cvt_pk_bf16_f32 v239, v162, v163
    v_cvt_pk_bf16_f32 v240, v164, v165
    v_cvt_pk_bf16_f32 v241, v166, v167
    v_and_or_b32 v238, v238, s83, v15
    v_and_or_b32 v239, v239, s83, v15
    v_and_or_b32 v240, v240, s83, v15
    v_and_or_b32 v241, v241, s83, v15
    s_waitcnt vmcnt(52)
    buffer_store_dwordx4 v[168:171], v253, s[12:15], s54 offen offset:2048 sc1
    buffer_store_dwordx4 v[172:175], v253, s[12:15], s54 offen offset:2560 sc1
    buffer_store_dwordx4 v[234:237], v253, s[12:15], s55 offen offset:2048 sc1
    buffer_store_dwordx4 v[238:241], v253, s[12:15], s55 offen offset:2560 sc1
    v_and_b32 v2, 7, v0
    v_lshlrev_b32 v2, 6, v2
    s_waitcnt vmcnt(16)
    v_xor_b32 v16, s32, v16
    v_xor_b32 v17, s32, v17
    v_or_b32 v1, v16, v17
    v_xor_b32 v18, s32, v18
    v_xor_b32 v19, s32, v19
    v_or3_b32 v1, v18, v19, v1
    v_xor_b32 v20, s32, v20
    v_xor_b32 v21, s32, v21
    v_or3_b32 v1, v20, v21, v1
    v_xor_b32 v22, s32, v22
    v_xor_b32 v23, s32, v23
    v_or3_b32 v1, v22, v23, v1
    v_xor_b32 v24, s32, v24
    v_xor_b32 v25, s32, v25
    v_or3_b32 v1, v24, v25, v1
    v_xor_b32 v26, s32, v26
    v_xor_b32 v27, s32, v27
    v_or3_b32 v1, v26, v27, v1
    v_xor_b32 v28, s32, v28
    v_xor_b32 v29, s32, v29
    v_or3_b32 v1, v28, v29, v1
    v_xor_b32 v30, s32, v30
    v_xor_b32 v31, s32, v31
    v_or3_b32 v1, v30, v31, v1
    v_and_b32 v1, 0x10001, v1
    v_cmp_ne_u32 vcc, 0, v1
    s_nop 1
    s_cbranch_vccnz va53
vad54:
    v_mfma_f32_16x16x32_bf16 v[92:95], a[0:3], v[16:19], 0
    buffer_load_dwordx4 v[172:175], v252, s[12:15], s36 offen offset:1024 sc1
    v_mfma_f32_16x16x32_bf16 v[96:99], a[4:7], v[16:19], 0
    s_waitcnt vmcnt(16)
    v_xor_b32 v32, s32, v32
    v_xor_b32 v33, s32, v33
    v_mfma_f32_16x16x32_bf16 v[100:103], a[8:11], v[16:19], 0
    v_or_b32 v1, v32, v33
    v_xor_b32 v34, s32, v34
    v_mfma_f32_16x16x32_bf16 v[104:107], a[12:15], v[16:19], 0
    buffer_load_dwordx4 v[176:179], v252, s[12:15], s37 offen offset:1024 sc1
    v_mfma_f32_16x16x32_bf16 v[108:111], a[16:19], v[16:19], 0
    v_xor_b32 v35, s32, v35
    v_or3_b32 v1, v34, v35, v1
    v_mfma_f32_16x16x32_bf16 v[112:115], a[0:3], v[20:23], 0
    v_mov_b32 v3, s82
    s_mov_b32 s83, -4
    v_mfma_f32_16x16x32_bf16 v[116:119], a[4:7], v[20:23], 0
    buffer_load_dwordx4 v[180:183], v252, s[12:15], s38 offen offset:1024 sc1
    v_mfma_f32_16x16x32_bf16 v[120:123], a[8:11], v[20:23], 0
    s_waitcnt vmcnt(17)
    v_xor_b32 v36, s32, v36
    v_xor_b32 v37, s32, v37
    v_mfma_f32_16x16x32_bf16 v[124:127], a[12:15], v[20:23], 0
    v_or3_b32 v1, v36, v37, v1
    v_xor_b32 v38, s32, v38
    v_mfma_f32_16x16x32_bf16 v[128:131], a[16:19], v[20:23], 0
    buffer_load_dwordx4 v[184:187], v252, s[12:15], s39 offen offset:1024 sc1
    v_mfma_f32_16x16x32_bf16 v[132:135], a[0:3], v[24:27], 0
    v_xor_b32 v39, s32, v39
    v_or3_b32 v1, v38, v39, v1
    v_mfma_f32_16x16x32_bf16 v[136:139], a[4:7], v[24:27], 0
    s_waitcnt vmcnt(17)
    v_xor_b32 v40, s32, v40
    v_xor_b32 v41, s32, v41
    v_mfma_f32_16x16x32_bf16 v[140:143], a[8:11], v[24:27], 0
    s_add_u32 s45, s36, 4096
    buffer_load_dwordx4 v[188:191], v252, s[12:15], s45 offen offset:0 sc1
    v_mfma_f32_16x16x32_bf16 v[144:147], a[12:15], v[24:27], 0
    v_or3_b32 v1, v40, v41, v1
    v_xor_b32 v42, s32, v42
    v_mfma_f32_16x16x32_bf16 v[148:151], a[16:19], v[24:27], 0
    v_xor_b32 v43, s32, v43
    v_or3_b32 v1, v42, v43, v1
    v_mfma_f32_16x16x32_bf16 v[152:155], a[0:3], v[28:31], 0
    s_add_u32 s45, s37, 4096
    buffer_load_dwordx4 v[192:195], v252, s[12:15], s45 offen offset:0 sc1
    v_mfma_f32_16x16x32_bf16 v[156:159], a[4:7], v[28:31], 0
    s_waitcnt vmcnt(18)
    v_xor_b32 v44, s32, v44
    v_xor_b32 v45, s32, v45
    v_mfma_f32_16x16x32_bf16 v[160:163], a[8:11], v[28:31], 0
    v_or3_b32 v1, v44, v45, v1
    v_xor_b32 v46, s32, v46
    v_mfma_f32_16x16x32_bf16 v[164:167], a[12:15], v[28:31], 0
    s_add_u32 s45, s38, 4096
    buffer_load_dwordx4 v[196:199], v252, s[12:15], s45 offen offset:0 sc1
    v_mfma_f32_16x16x32_bf16 v[168:171], a[16:19], v[28:31], 0
    v_xor_b32 v47, s32, v47
    v_or3_b32 v1, v46, v47, v1
    v_and_b32 v1, 0x10001, v1
    v_cmp_ne_u32 vcc, 0, v1
    s_nop 1
    s_cbranch_vccnz va55
vad56:
    v_mfma_f32_16x16x32_bf16 v[92:95], a[60:63], v[32:35], v[92:95]
    s_add_u32 s45, s39, 4096
    buffer_load_dwordx4 v[200:203], v252, s[12:15], s45 offen offset:0 sc1
    v_mfma_f32_16x16x32_bf16 v[96:99], a[64:67], v[32:35], v[96:99]
    s_waitcnt vmcnt(19)
    v_xor_b32 v48, s32, v48
    v_xor_b32 v49, s32, v49
    v_mfma_f32_16x16x32_bf16 v[100:103], a[68:71], v[32:35], v[100:103]
    v_or_b32 v1, v48, v49
    v_xor_b32 v50, s32, v50
    v_mfma_f32_16x16x32_bf16 v[104:107], a[72:75], v[32:35], v[104:107]
    s_add_u32 s45, s36, 4096
    buffer_load_dwordx4 v[204:207], v252, s[12:15], s45 offen offset:3072 sc1
    v_mfma_f32_16x16x32_bf16 v[108:111], a[76:79], v[32:35], v[108:111]
    v_xor_b32 v51, s32, v51
    v_or3_b32 v1, v50, v51, v1
    v_mfma_f32_16x16x32_bf16 v[112:115], a[60:63], v[36:39], v[112:115]
    v_accvgpr_read_b32 v5, a240
    v_accvgpr_read_b32 v6, a241
    v_mfma_f32_16x16x32_bf16 v[116:119], a[64:67], v[36:39], v[116:119]
    s_add_u32 s45, s37, 4096
    buffer_load_dwordx4 v[208:211], v252, s[12:15], s45 offen offset:3072 sc1
    v_mfma_f32_16x16x32_bf16 v[120:123], a[68:71], v[36:39], v[120:123]
    s_waitcnt vmcnt(20)
    v_xor_b32 v52, s32, v52
    v_xor_b32 v53, s32, v53
    v_mfma_f32_16x16x32_bf16 v[124:127], a[72:75], v[36:39], v[124:127]
    v_or3_b32 v1, v52, v53, v1
    v_xor_b32 v54, s32, v54
    v_mfma_f32_16x16x32_bf16 v[128:131], a[76:79], v[36:39], v[128:131]
    s_add_u32 s45, s38, 4096
    buffer_load_dwordx4 v[212:215], v252, s[12:15], s45 offen offset:3072 sc1
    v_mfma_f32_16x16x32_bf16 v[132:135], a[60:63], v[40:43], v[132:135]
    v_xor_b32 v55, s32, v55
    v_or3_b32 v1, v54, v55, v1
    v_mfma_f32_16x16x32_bf16 v[136:139], a[64:67], v[40:43], v[136:139]
    s_waitcnt vmcnt(20)
    v_xor_b32 v56, s32, v56
    v_xor_b32 v57, s32, v57
    v_mfma_f32_16x16x32_bf16 v[140:143], a[68:71], v[40:43], v[140:143]
    s_add_u32 s45, s39, 4096
    buffer_load_dwordx4 v[216:219], v252, s[12:15], s45 offen offset:3072 sc1
    v_mfma_f32_16x16x32_bf16 v[144:147], a[72:75], v[40:43], v[144:147]
    v_or3_b32 v1, v56, v57, v1
    v_xor_b32 v58, s32, v58
    v_mfma_f32_16x16x32_bf16 v[148:151], a[76:79], v[40:43], v[148:151]
    v_xor_b32 v59, s32, v59
    v_or3_b32 v1, v58, v59, v1
    v_mfma_f32_16x16x32_bf16 v[152:155], a[60:63], v[44:47], v[152:155]
    s_add_u32 s45, s36, 8192
    buffer_load_dwordx4 v[220:223], v252, s[12:15], s45 offen offset:2048 sc1
    v_mfma_f32_16x16x32_bf16 v[156:159], a[64:67], v[44:47], v[156:159]
    s_waitcnt vmcnt(21)
    v_xor_b32 v60, s32, v60
    v_xor_b32 v61, s32, v61
    v_mfma_f32_16x16x32_bf16 v[160:163], a[68:71], v[44:47], v[160:163]
    v_or3_b32 v1, v60, v61, v1
    v_xor_b32 v62, s32, v62
    v_mfma_f32_16x16x32_bf16 v[164:167], a[72:75], v[44:47], v[164:167]
    v_xor_b32 v63, s32, v63
    v_or3_b32 v1, v62, v63, v1
    v_mfma_f32_16x16x32_bf16 v[168:171], a[76:79], v[44:47], v[168:171]
    v_and_b32 v1, 0x10001, v1
    v_cmp_ne_u32 vcc, 0, v1
    s_nop 1
    s_cbranch_vccnz va57
vad58:
    v_mfma_f32_16x16x32_bf16 v[92:95], a[120:123], v[48:51], v[92:95]
    s_add_u32 s45, s37, 8192
    buffer_load_dwordx4 v[224:227], v252, s[12:15], s45 offen offset:2048 sc1
    v_mfma_f32_16x16x32_bf16 v[96:99], a[124:127], v[48:51], v[96:99]
    s_waitcnt vmcnt(21)
    v_xor_b32 v64, s32, v64
    v_xor_b32 v65, s32, v65
    v_mfma_f32_16x16x32_bf16 v[100:103], a[128:131], v[48:51], v[100:103]
    v_or_b32 v1, v64, v65
    v_xor_b32 v66, s32, v66
    v_mfma_f32_16x16x32_bf16 v[104:107], a[132:135], v[48:51], v[104:107]
    v_xor_b32 v67, s32, v67
    v_or3_b32 v1, v66, v67, v1
    v_mfma_f32_16x16x32_bf16 v[108:111], a[136:139], v[48:51], v[108:111]
    v_accvgpr_read_b32 v7, a242
    v_accvgpr_read_b32 v8, a243
    v_mfma_f32_16x16x32_bf16 v[112:115], a[120:123], v[52:55], v[112:115]
    v_accvgpr_read_b32 v9, a244
    v_accvgpr_read_b32 v10, a245
    v_mfma_f32_16x16x32_bf16 v[116:119], a[124:127], v[52:55], v[116:119]
    s_add_u32 s45, s38, 8192
    buffer_load_dwordx4 v[228:231], v252, s[12:15], s45 offen offset:2048 sc1
    v_mfma_f32_16x16x32_bf16 v[120:123], a[128:131], v[52:55], v[120:123]
    s_waitcnt vmcnt(21)
    v_xor_b32 v68, s32, v68
    v_xor_b32 v69, s32, v69
    v_mfma_f32_16x16x32_bf16 v[124:127], a[132:135], v[52:55], v[124:127]
    v_or3_b32 v1, v68, v69, v1
    v_xor_b32 v70, s32, v70
    v_mfma_f32_16x16x32_bf16 v[128:131], a[136:139], v[52:55], v[128:131]
    v_xor_b32 v71, s32, v71
    v_or3_b32 v1, v70, v71, v1
    v_mfma_f32_16x16x32_bf16 v[132:135], a[120:123], v[56:59], v[132:135]
    v_accvgpr_read_b32 v11, a246
    v_accvgpr_read_b32 v12, a247
    v_mfma_f32_16x16x32_bf16 v[136:139], a[124:127], v[56:59], v[136:139]
    s_waitcnt vmcnt(20)
    v_xor_b32 v72, s32, v72
    v_xor_b32 v73, s32, v73
    v_mfma_f32_16x16x32_bf16 v[140:143], a[128:131], v[56:59], v[140:143]
    s_add_u32 s45, s39, 8192
    buffer_load_dwordx4 v[232:235], v252, s[12:15], s45 offen offset:2048 sc1
    v_mfma_f32_16x16x32_bf16 v[144:147], a[132:135], v[56:59], v[144:147]
    v_or3_b32 v1, v72, v73, v1
    v_xor_b32 v74, s32, v74
    v_mfma_f32_16x16x32_bf16 v[148:151], a[136:139], v[56:59], v[148:151]
    v_xor_b32 v75, s32, v75
    v_or3_b32 v1, v74, v75, v1
    v_mfma_f32_16x16x32_bf16 v[152:155], a[120:123], v[60:63], v[152:155]
    s_waitcnt vmcnt(20)
    v_xor_b32 v76, s32, v76
    v_xor_b32 v77, s32, v77
    v_mfma_f32_16x16x32_bf16 v[156:159], a[124:127], v[60:63], v[156:159]
    v_or3_b32 v1, v76, v77, v1
    v_xor_b32 v78, s32, v78
    v_mfma_f32_16x16x32_bf16 v[160:163], a[128:131], v[60:63], v[160:163]
    v_xor_b32 v79, s32, v79
    v_or3_b32 v1, v78, v79, v1
    v_mfma_f32_16x16x32_bf16 v[164:167], a[132:135], v[60:63], v[164:167]
    v_and_b32 v1, 0x10001, v1
    v_cmp_ne_u32 vcc, 0, v1
    v_mfma_f32_16x16x32_bf16 v[168:171], a[136:139], v[60:63], v[168:171]
    v_accvgpr_read_b32 v13, a248
    v_accvgpr_read_b32 v14, a249
    s_cbranch_vccnz va59
vad60:
    v_mfma_f32_16x16x32_bf16 v[92:95], a[180:183], v[64:67], v[92:95]
    buffer_load_dwordx4 v[236:239], v252, s[12:15], s36 offen offset:2048 sc1
    v_mfma_f32_16x16x32_bf16 v[96:99], a[184:187], v[64:67], v[96:99]
    s_waitcnt vmcnt(16)
    v_xor_b32 v172, s32, v172
    v_xor_b32 v173, s32, v173
    v_mfma_f32_16x16x32_bf16 v[100:103], a[188:191], v[64:67], v[100:103]
    v_or_b32 v1, v172, v173
    v_xor_b32 v174, s32, v174
    v_mfma_f32_16x16x32_bf16 v[104:107], a[192:195], v[64:67], v[104:107]
    buffer_load_dwordx4 v[240:243], v252, s[12:15], s37 offen offset:2048 sc1
    v_mfma_f32_16x16x32_bf16 v[108:111], a[196:199], v[64:67], v[108:111]
    v_xor_b32 v175, s32, v175
    v_or3_b32 v1, v174, v175, v1
    v_mfma_f32_16x16x32_bf16 v[112:115], a[180:183], v[68:71], v[112:115]
    s_add_u32 s58, s34, 102400
    v_mov_b32 v4, s28
    s_mov_b64 exec, 1
    buffer_store_dword v4, off, s[12:15], s58 offset:0 sc1
    s_mov_b64 exec, -1
    v_mfma_f32_16x16x32_bf16 v[116:119], a[184:187], v[68:71], v[116:119]
    buffer_load_dwordx4 v[244:247], v252, s[12:15], s38 offen offset:2048 sc1
    v_mfma_f32_16x16x32_bf16 v[120:123], a[188:191], v[68:71], v[120:123]
    s_waitcnt vmcnt(18)
    v_xor_b32 v176, s32, v176
    v_xor_b32 v177, s32, v177
    v_mfma_f32_16x16x32_bf16 v[124:127], a[192:195], v[68:71], v[124:127]
    v_or3_b32 v1, v176, v177, v1
    v_xor_b32 v178, s32, v178
    v_mfma_f32_16x16x32_bf16 v[128:131], a[196:199], v[68:71], v[128:131]
    v_xor_b32 v179, s32, v179
    v_or3_b32 v1, v178, v179, v1
    v_mfma_f32_16x16x32_bf16 v[132:135], a[180:183], v[72:75], v[132:135]
    v_accvgpr_read_b32 v15, a250
    v_mfma_f32_16x16x32_bf16 v[136:139], a[184:187], v[72:75], v[136:139]
    s_waitcnt vmcnt(17)
    v_xor_b32 v180, s32, v180
    v_xor_b32 v181, s32, v181
    v_mfma_f32_16x16x32_bf16 v[140:143], a[188:191], v[72:75], v[140:143]
    buffer_load_dwordx4 v[248:251], v252, s[12:15], s39 offen offset:2048 sc1
    v_mfma_f32_16x16x32_bf16 v[144:147], a[192:195], v[72:75], v[144:147]
    v_or3_b32 v1, v180, v181, v1
    v_xor_b32 v182, s32, v182
    v_mfma_f32_16x16x32_bf16 v[148:151], a[196:199], v[72:75], v[148:151]
    v_xor_b32 v183, s32, v183
    v_or3_b32 v1, v182, v183, v1
    v_mfma_f32_16x16x32_bf16 v[152:155], a[180:183], v[76:79], v[152:155]
    s_add_u32 s45, s36, 4096
    buffer_load_dwordx4 v[80:83], v252, s[12:15], s45 offen offset:1024 sc1
    v_mfma_f32_16x16x32_bf16 v[156:159], a[184:187], v[76:79], v[156:159]
    s_waitcnt vmcnt(18)
    v_xor_b32 v184, s32, v184
    v_xor_b32 v185, s32, v185
    v_mfma_f32_16x16x32_bf16 v[160:163], a[188:191], v[76:79], v[160:163]
    v_or3_b32 v1, v184, v185, v1
    v_xor_b32 v186, s32, v186
    v_mfma_f32_16x16x32_bf16 v[164:167], a[192:195], v[76:79], v[164:167]
    v_xor_b32 v187, s32, v187
    v_or3_b32 v1, v186, v187, v1
    v_mfma_f32_16x16x32_bf16 v[168:171], a[196:199], v[76:79], v[168:171]
    v_and_b32 v1, 0x10001, v1
    v_cmp_ne_u32 vcc, 0, v1
    s_nop 1
    s_cbranch_vccnz va61
vad62:
    v_mfma_f32_16x16x32_bf16 v[92:95], a[20:23], v[172:175], v[92:95]
    s_add_u32 s45, s37, 4096
    buffer_load_dwordx4 v[84:87], v252, s[12:15], s45 offen offset:1024 sc1
    v_mfma_f32_16x16x32_bf16 v[96:99], a[24:27], v[172:175], v[96:99]
    s_waitcnt vmcnt(18)
    v_xor_b32 v188, s32, v188
    v_xor_b32 v189, s32, v189
    v_mfma_f32_16x16x32_bf16 v[100:103], a[28:31], v[172:175], v[100:103]
    v_or_b32 v1, v188, v189
    v_xor_b32 v190, s32, v190
    v_mfma_f32_16x16x32_bf16 v[104:107], a[32:35], v[172:175], v[104:107]
    v_xor_b32 v191, s32, v191
    v_or3_b32 v1, v190, v191, v1
    v_mfma_f32_16x16x32_bf16 v[108:111], a[36:39], v[172:175], v[108:111]
    v_mfma_f32_16x16x32_bf16 v[112:115], a[20:23], v[176:179], v[112:115]
    v_mfma_f32_16x16x32_bf16 v[116:119], a[24:27], v[176:179], v[116:119]
    s_add_u32 s45, s38, 4096
    buffer_load_dwordx4 v[172:175], v252, s[12:15], s45 offen offset:1024 sc1
    v_mfma_f32_16x16x32_bf16 v[120:123], a[28:31], v[176:179], v[120:123]
    s_waitcnt vmcnt(18)
    v_xor_b32 v192, s32, v192
    v_xor_b32 v193, s32, v193
    v_mfma_f32_16x16x32_bf16 v[124:127], a[32:35], v[176:179], v[124:127]
    v_or3_b32 v1, v192, v193, v1
    v_xor_b32 v194, s32, v194
    v_mfma_f32_16x16x32_bf16 v[128:131], a[36:39], v[176:179], v[128:131]
    v_xor_b32 v195, s32, v195
    v_or3_b32 v1, v194, v195, v1
    v_mfma_f32_16x16x32_bf16 v[132:135], a[20:23], v[180:183], v[132:135]
    v_mfma_f32_16x16x32_bf16 v[136:139], a[24:27], v[180:183], v[136:139]
    s_waitcnt vmcnt(17)
    v_xor_b32 v196, s32, v196
    v_xor_b32 v197, s32, v197
    v_mfma_f32_16x16x32_bf16 v[140:143], a[28:31], v[180:183], v[140:143]
    s_add_u32 s45, s39, 4096
    buffer_load_dwordx4 v[176:179], v252, s[12:15], s45 offen offset:1024 sc1
    v_mfma_f32_16x16x32_bf16 v[144:147], a[32:35], v[180:183], v[144:147]
    v_or3_b32 v1, v196, v197, v1
    v_xor_b32 v198, s32, v198
    v_mfma_f32_16x16x32_bf16 v[148:151], a[36:39], v[180:183], v[148:151]
    v_xor_b32 v199, s32, v199
    v_or3_b32 v1, v198, v199, v1
    v_mfma_f32_16x16x32_bf16 v[152:155], a[20:23], v[184:187], v[152:155]
    s_add_u32 s45, s36, 8192
    buffer_load_dwordx4 v[88:91], v252, s[12:15], s45 offen offset:0 sc1
    v_mfma_f32_16x16x32_bf16 v[156:159], a[24:27], v[184:187], v[156:159]
    s_waitcnt vmcnt(18)
    v_xor_b32 v200, s32, v200
    v_xor_b32 v201, s32, v201
    v_mfma_f32_16x16x32_bf16 v[160:163], a[28:31], v[184:187], v[160:163]
    v_or3_b32 v1, v200, v201, v1
    v_xor_b32 v202, s32, v202
    v_mfma_f32_16x16x32_bf16 v[164:167], a[32:35], v[184:187], v[164:167]
    v_xor_b32 v203, s32, v203
    v_or3_b32 v1, v202, v203, v1
    v_mfma_f32_16x16x32_bf16 v[168:171], a[36:39], v[184:187], v[168:171]
    v_and_b32 v1, 0x10001, v1
    v_cmp_ne_u32 vcc, 0, v1
    s_nop 1
    s_cbranch_vccnz va63
vad64:
    v_mfma_f32_16x16x32_bf16 v[92:95], a[80:83], v[188:191], v[92:95]
    s_add_u32 s45, s37, 8192
    buffer_load_dwordx4 v[16:19], v252, s[12:15], s45 offen offset:0 sc1
    v_mfma_f32_16x16x32_bf16 v[96:99], a[84:87], v[188:191], v[96:99]
    s_waitcnt vmcnt(18)
    v_xor_b32 v204, s32, v204
    v_xor_b32 v205, s32, v205
    v_mfma_f32_16x16x32_bf16 v[100:103], a[88:91], v[188:191], v[100:103]
    v_or_b32 v1, v204, v205
    v_xor_b32 v206, s32, v206
    v_mfma_f32_16x16x32_bf16 v[104:107], a[92:95], v[188:191], v[104:107]
    v_xor_b32 v207, s32, v207
    v_or3_b32 v1, v206, v207, v1
    v_mfma_f32_16x16x32_bf16 v[108:111], a[96:99], v[188:191], v[108:111]
    v_mfma_f32_16x16x32_bf16 v[112:115], a[80:83], v[192:195], v[112:115]
    v_mfma_f32_16x16x32_bf16 v[116:119], a[84:87], v[192:195], v[116:119]
    s_add_u32 s45, s38, 8192
    buffer_load_dwordx4 v[20:23], v252, s[12:15], s45 offen offset:0 sc1
    v_mfma_f32_16x16x32_bf16 v[120:123], a[88:91], v[192:195], v[120:123]
    s_waitcnt vmcnt(18)
    v_xor_b32 v208, s32, v208
    v_xor_b32 v209, s32, v209
    v_mfma_f32_16x16x32_bf16 v[124:127], a[92:95], v[192:195], v[124:127]
    v_or3_b32 v1, v208, v209, v1
    v_xor_b32 v210, s32, v210
    v_mfma_f32_16x16x32_bf16 v[128:131], a[96:99], v[192:195], v[128:131]
    v_xor_b32 v211, s32, v211
    v_or3_b32 v1, v210, v211, v1
    v_mfma_f32_16x16x32_bf16 v[132:135], a[80:83], v[196:199], v[132:135]
    v_mfma_f32_16x16x32_bf16 v[136:139], a[84:87], v[196:199], v[136:139]
    s_waitcnt vmcnt(17)
    v_xor_b32 v212, s32, v212
    v_xor_b32 v213, s32, v213
    v_mfma_f32_16x16x32_bf16 v[140:143], a[88:91], v[196:199], v[140:143]
    s_add_u32 s45, s39, 8192
    buffer_load_dwordx4 v[24:27], v252, s[12:15], s45 offen offset:0 sc1
    v_mfma_f32_16x16x32_bf16 v[144:147], a[92:95], v[196:199], v[144:147]
    v_or3_b32 v1, v212, v213, v1
    v_xor_b32 v214, s32, v214
    v_mfma_f32_16x16x32_bf16 v[148:151], a[96:99], v[196:199], v[148:151]
    v_xor_b32 v215, s32, v215
    v_or3_b32 v1, v214, v215, v1
    v_mfma_f32_16x16x32_bf16 v[152:155], a[80:83], v[200:203], v[152:155]
    s_add_u32 s45, s36, 8192
    buffer_load_dwordx4 v[28:31], v252, s[12:15], s45 offen offset:3072 sc1
    v_mfma_f32_16x16x32_bf16 v[156:159], a[84:87], v[200:203], v[156:159]
    s_waitcnt vmcnt(18)
    v_xor_b32 v216, s32, v216
    v_xor_b32 v217, s32, v217
    v_mfma_f32_16x16x32_bf16 v[160:163], a[88:91], v[200:203], v[160:163]
    v_or3_b32 v1, v216, v217, v1
    v_xor_b32 v218, s32, v218
    v_mfma_f32_16x16x32_bf16 v[164:167], a[92:95], v[200:203], v[164:167]
    v_xor_b32 v219, s32, v219
    v_or3_b32 v1, v218, v219, v1
    v_mfma_f32_16x16x32_bf16 v[168:171], a[96:99], v[200:203], v[168:171]
    v_and_b32 v1, 0x10001, v1
    v_cmp_ne_u32 vcc, 0, v1
    s_nop 1
    s_cbranch_vccnz va65
vad66:
    v_mfma_f32_16x16x32_bf16 v[92:95], a[140:143], v[204:207], v[92:95]
    s_add_u32 s45, s37, 8192
    buffer_load_dwordx4 v[32:35], v252, s[12:15], s45 offen offset:3072 sc1
    v_mfma_f32_16x16x32_bf16 v[96:99], a[144:147], v[204:207], v[96:99]
    s_waitcnt vmcnt(18)
    v_xor_b32 v220, s32, v220
    v_xor_b32 v221, s32, v221
    v_mfma_f32_16x16x32_bf16 v[100:103], a[148:151], v[204:207], v[100:103]
    v_or_b32 v1, v220, v221
    v_xor_b32 v222, s32, v222
    v_mfma_f32_16x16x32_bf16 v[104:107], a[152:155], v[204:207], v[104:107]
    v_xor_b32 v223, s32, v223
    v_or3_b32 v1, v222, v223, v1
    v_mfma_f32_16x16x32_bf16 v[108:111], a[156:159], v[204:207], v[108:111]
    v_mfma_f32_16x16x32_bf16 v[112:115], a[140:143], v[208:211], v[112:115]
    v_mfma_f32_16x16x32_bf16 v[116:119], a[144:147], v[208:211], v[116:119]
    s_add_u32 s45, s38, 8192
    buffer_load_dwordx4 v[36:39], v252, s[12:15], s45 offen offset:3072 sc1
    v_mfma_f32_16x16x32_bf16 v[120:123], a[148:151], v[208:211], v[120:123]
    s_waitcnt vmcnt(18)
    v_xor_b32 v224, s32, v224
    v_xor_b32 v225, s32, v225
    v_mfma_f32_16x16x32_bf16 v[124:127], a[152:155], v[208:211], v[124:127]
    v_or3_b32 v1, v224, v225, v1
    v_xor_b32 v226, s32, v226
    v_mfma_f32_16x16x32_bf16 v[128:131], a[156:159], v[208:211], v[128:131]
    v_xor_b32 v227, s32, v227
    v_or3_b32 v1, v226, v227, v1
    v_mfma_f32_16x16x32_bf16 v[132:135], a[140:143], v[212:215], v[132:135]
    v_mfma_f32_16x16x32_bf16 v[136:139], a[144:147], v[212:215], v[136:139]
    s_waitcnt vmcnt(17)
    v_xor_b32 v228, s32, v228
    v_xor_b32 v229, s32, v229
    v_mfma_f32_16x16x32_bf16 v[140:143], a[148:151], v[212:215], v[140:143]
    s_add_u32 s45, s39, 8192
    buffer_load_dwordx4 v[40:43], v252, s[12:15], s45 offen offset:3072 sc1
    v_mfma_f32_16x16x32_bf16 v[144:147], a[152:155], v[212:215], v[144:147]
    v_or3_b32 v1, v228, v229, v1
    v_xor_b32 v230, s32, v230
    v_mfma_f32_16x16x32_bf16 v[148:151], a[156:159], v[212:215], v[148:151]
    v_xor_b32 v231, s32, v231
    v_or3_b32 v1, v230, v231, v1
    v_mfma_f32_16x16x32_bf16 v[152:155], a[140:143], v[216:219], v[152:155]
    s_waitcnt vmcnt(17)
    v_xor_b32 v232, s32, v232
    v_xor_b32 v233, s32, v233
    v_mfma_f32_16x16x32_bf16 v[156:159], a[144:147], v[216:219], v[156:159]
    v_or3_b32 v1, v232, v233, v1
    v_xor_b32 v234, s32, v234
    v_mfma_f32_16x16x32_bf16 v[160:163], a[148:151], v[216:219], v[160:163]
    v_xor_b32 v235, s32, v235
    v_or3_b32 v1, v234, v235, v1
    v_mfma_f32_16x16x32_bf16 v[164:167], a[152:155], v[216:219], v[164:167]
    v_and_b32 v1, 0x10001, v1
    v_cmp_ne_u32 vcc, 0, v1
    v_mfma_f32_16x16x32_bf16 v[168:171], a[156:159], v[216:219], v[168:171]
    s_nop 0
    s_cbranch_vccnz va67
vad68:
    v_mfma_f32_16x16x32_bf16 v[92:95], a[200:203], v[220:223], v[92:95]
    buffer_load_dword v4, v2, s[12:15], s95 offen sc1
    v_mfma_f32_16x16x32_bf16 v[96:99], a[204:207], v[220:223], v[96:99]
    s_waitcnt vmcnt(17)
    v_xor_b32 v236, s32, v236
    v_xor_b32 v237, s32, v237
    v_mfma_f32_16x16x32_bf16 v[100:103], a[208:211], v[220:223], v[100:103]
    v_or_b32 v1, v236, v237
    v_xor_b32 v238, s32, v238
    v_mfma_f32_16x16x32_bf16 v[104:107], a[212:215], v[220:223], v[104:107]
    v_xor_b32 v239, s32, v239
    v_or3_b32 v1, v238, v239, v1
    v_mfma_f32_16x16x32_bf16 v[108:111], a[216:219], v[220:223], v[108:111]
    v_mfma_f32_16x16x32_bf16 v[112:115], a[200:203], v[224:227], v[112:115]
    v_mfma_f32_16x16x32_bf16 v[116:119], a[204:207], v[224:227], v[116:119]
    s_waitcnt vmcnt(16)
    v_xor_b32 v240, s32, v240
    v_xor_b32 v241, s32, v241
    v_mfma_f32_16x16x32_bf16 v[120:123], a[208:211], v[224:227], v[120:123]
    v_or3_b32 v1, v240, v241, v1
    v_xor_b32 v242, s32, v242
    v_mfma_f32_16x16x32_bf16 v[124:127], a[212:215], v[224:227], v[124:127]
    v_xor_b32 v243, s32, v243
    v_or3_b32 v1, v242, v243, v1
    v_mfma_f32_16x16x32_bf16 v[128:131], a[216:219], v[224:227], v[128:131]
    v_mfma_f32_16x16x32_bf16 v[132:135], a[200:203], v[228:231], v[132:135]
    v_mfma_f32_16x16x32_bf16 v[136:139], a[204:207], v[228:231], v[136:139]
    s_waitcnt vmcnt(14)
    v_xor_b32 v244, s32, v244
    v_xor_b32 v245, s32, v245
    v_mfma_f32_16x16x32_bf16 v[140:143], a[208:211], v[228:231], v[140:143]
    v_or3_b32 v1, v244, v245, v1
    v_xor_b32 v246, s32, v246
    v_mfma_f32_16x16x32_bf16 v[144:147], a[212:215], v[228:231], v[144:147]
    v_xor_b32 v247, s32, v247
    v_or3_b32 v1, v246, v247, v1
    v_mfma_f32_16x16x32_bf16 v[148:151], a[216:219], v[228:231], v[148:151]
    s_waitcnt vmcnt(13)
    v_xor_b32 v248, s32, v248
    v_xor_b32 v249, s32, v249
    v_mfma_f32_16x16x32_bf16 v[152:155], a[200:203], v[232:235], v[152:155]
    v_or3_b32 v1, v248, v249, v1
    v_xor_b32 v250, s32, v250
    v_mfma_f32_16x16x32_bf16 v[156:159], a[204:207], v[232:235], v[156:159]
    v_xor_b32 v251, s32, v251
    v_or3_b32 v1, v250, v251, v1
    v_mfma_f32_16x16x32_bf16 v[160:163], a[208:211], v[232:235], v[160:163]
    v_and_b32 v1, 0x10001, v1
    v_cmp_ne_u32 vcc, 0, v1
    v_mfma_f32_16x16x32_bf16 v[164:167], a[212:215], v[232:235], v[164:167]
    v_mfma_f32_16x16x32_bf16 v[168:171], a[216:219], v[232:235], v[168:171]
    s_cbranch_vccnz va69
vad70:
    v_mfma_f32_16x16x32_bf16 v[92:95], a[40:43], v[236:239], v[92:95]
    v_mfma_f32_16x16x32_bf16 v[96:99], a[44:47], v[236:239], v[96:99]
    s_waitcnt vmcnt(12)
    v_xor_b32 v80, s32, v80
    v_xor_b32 v81, s32, v81
    v_mfma_f32_16x16x32_bf16 v[100:103], a[48:51], v[236:239], v[100:103]
    v_or_b32 v1, v80, v81
    v_xor_b32 v82, s32, v82
    v_mfma_f32_16x16x32_bf16 v[104:107], a[52:55], v[236:239], v[104:107]
    v_xor_b32 v83, s32, v83
    v_or3_b32 v1, v82, v83, v1
    v_mfma_f32_16x16x32_bf16 v[108:111], a[56:59], v[236:239], v[108:111]
    v_mfma_f32_16x16x32_bf16 v[112:115], a[40:43], v[240:243], v[112:115]
    v_mfma_f32_16x16x32_bf16 v[116:119], a[44:47], v[240:243], v[116:119]
    s_waitcnt vmcnt(11)
    v_xor_b32 v84, s32, v84
    v_xor_b32 v85, s32, v85
    v_mfma_f32_16x16x32_bf16 v[120:123], a[48:51], v[240:243], v[120:123]
    v_or3_b32 v1, v84, v85, v1
    v_xor_b32 v86, s32, v86
    v_mfma_f32_16x16x32_bf16 v[124:127], a[52:55], v[240:243], v[124:127]
    v_xor_b32 v87, s32, v87
    v_or3_b32 v1, v86, v87, v1
    v_mfma_f32_16x16x32_bf16 v[128:131], a[56:59], v[240:243], v[128:131]
    v_mfma_f32_16x16x32_bf16 v[132:135], a[40:43], v[244:247], v[132:135]
    v_mfma_f32_16x16x32_bf16 v[136:139], a[44:47], v[244:247], v[136:139]
    s_waitcnt vmcnt(10)
    v_xor_b32 v172, s32, v172
    v_xor_b32 v173, s32, v173
    v_mfma_f32_16x16x32_bf16 v[140:143], a[48:51], v[244:247], v[140:143]
    v_or3_b32 v1, v172, v173, v1
    v_xor_b32 v174, s32, v174
    v_mfma_f32_16x16x32_bf16 v[144:147], a[52:55], v[244:247], v[144:147]
    v_xor_b32 v175, s32, v175
    v_or3_b32 v1, v174, v175, v1
    v_mfma_f32_16x16x32_bf16 v[148:151], a[56:59], v[244:247], v[148:151]
    s_waitcnt vmcnt(9)
    v_xor_b32 v176, s32, v176
    v_xor_b32 v177, s32, v177
    v_mfma_f32_16x16x32_bf16 v[152:155], a[40:43], v[248:251], v[152:155]
    v_or3_b32 v1, v176, v177, v1
    v_xor_b32 v178, s32, v178
    v_mfma_f32_16x16x32_bf16 v[156:159], a[44:47], v[248:251], v[156:159]
    v_xor_b32 v179, s32, v179
    v_or3_b32 v1, v178, v179, v1
    v_mfma_f32_16x16x32_bf16 v[160:163], a[48:51], v[248:251], v[160:163]
    v_and_b32 v1, 0x10001, v1
    v_cmp_ne_u32 vcc, 0, v1
    v_mfma_f32_16x16x32_bf16 v[164:167], a[52:55], v[248:251], v[164:167]
    v_mfma_f32_16x16x32_bf16 v[168:171], a[56:59], v[248:251], v[168:171]
    s_cbranch_vccnz va71
vad72:
    s_waitcnt vmcnt(0)
    v_cmp_ne_u32 vcc, s28, v4
    s_nop 1
    s_cbranch_vccnz fa73
fad74:
    v_mfma_f32_16x16x32_bf16 v[92:95], a[100:103], v[80:83], v[92:95]
    buffer_load_dwordx4 v[44:47], v252, s[12:15], s40 offen offset:0 sc1
    v_mfma_f32_16x16x32_bf16 v[96:99], a[104:107], v[80:83], v[96:99]
    v_xor_b32 v88, s32, v88
    v_xor_b32 v89, s32, v89
    v_mfma_f32_16x16x32_bf16 v[100:103], a[108:111], v[80:83], v[100:103]
    v_or_b32 v1, v88, v89
    v_xor_b32 v90, s32, v90
    v_mfma_f32_16x16x32_bf16 v[104:107], a[112:115], v[80:83], v[104:107]
    buffer_load_dwordx4 v[48:51], v252, s[12:15], s40 offen offset:1024 sc1
    v_mfma_f32_16x16x32_bf16 v[108:111], a[116:119], v[80:83], v[108:111]
    v_xor_b32 v91, s32, v91
    v_or3_b32 v1, v90, v91, v1
    v_mfma_f32_16x16x32_bf16 v[112:115], a[100:103], v[84:87], v[112:115]
    v_mfma_f32_16x16x32_bf16 v[116:119], a[104:107], v[84:87], v[116:119]
    buffer_load_dwordx4 v[52:55], v252, s[12:15], s40 offen offset:2048 sc1
    v_mfma_f32_16x16x32_bf16 v[120:123], a[108:111], v[84:87], v[120:123]
    v_xor_b32 v16, s32, v16
    v_xor_b32 v17, s32, v17
    v_mfma_f32_16x16x32_bf16 v[124:127], a[112:115], v[84:87], v[124:127]
    v_or3_b32 v1, v16, v17, v1
    v_xor_b32 v18, s32, v18
    v_mfma_f32_16x16x32_bf16 v[128:131], a[116:119], v[84:87], v[128:131]
    buffer_load_dwordx4 v[56:59], v252, s[12:15], s40 offen offset:3072 sc1
    v_mfma_f32_16x16x32_bf16 v[132:135], a[100:103], v[172:175], v[132:135]
    v_xor_b32 v19, s32, v19
    v_or3_b32 v1, v18, v19, v1
    v_mfma_f32_16x16x32_bf16 v[136:139], a[104:107], v[172:175], v[136:139]
    v_xor_b32 v20, s32, v20
    v_xor_b32 v21, s32, v21
    v_mfma_f32_16x16x32_bf16 v[140:143], a[108:111], v[172:175], v[140:143]
    s_add_u32 s45, s40, 4096
    buffer_load_dwordx4 v[60:63], v252, s[12:15], s45 offen offset:0 sc1
    v_mfma_f32_16x16x32_bf16 v[144:147], a[112:115], v[172:175], v[144:147]
    v_or3_b32 v1, v20, v21, v1
    v_xor_b32 v22, s32, v22
    v_mfma_f32_16x16x32_bf16 v[148:151], a[116:119], v[172:175], v[148:151]
    v_xor_b32 v23, s32, v23
    v_or3_b32 v1, v22, v23, v1
    v_mfma_f32_16x16x32_bf16 v[152:155], a[100:103], v[176:179], v[152:155]
    s_add_u32 s45, s40, 4096
    buffer_load_dwordx4 v[64:67], v252, s[12:15], s45 offen offset:1024 sc1
    v_mfma_f32_16x16x32_bf16 v[156:159], a[104:107], v[176:179], v[156:159]
    v_xor_b32 v24, s32, v24
    v_xor_b32 v25, s32, v25
    v_mfma_f32_16x16x32_bf16 v[160:163], a[108:111], v[176:179], v[160:163]
    v_or3_b32 v1, v24, v25, v1
    v_xor_b32 v26, s32, v26
    v_mfma_f32_16x16x32_bf16 v[164:167], a[112:115], v[176:179], v[164:167]
    s_add_u32 s45, s40, 4096
    buffer_load_dwordx4 v[68:71], v252, s[12:15], s45 offen offset:2048 sc1
    v_mfma_f32_16x16x32_bf16 v[168:171], a[116:119], v[176:179], v[168:171]
    v_xor_b32 v27, s32, v27
    v_or3_b32 v1, v26, v27, v1
    v_and_b32 v1, 0x10001, v1
    v_cmp_ne_u32 vcc, 0, v1
    s_nop 1
    s_cbranch_vccnz va75
vad76:
    v_mfma_f32_16x16x32_bf16 v[92:95], a[160:163], v[88:91], v[92:95]
    s_add_u32 s45, s40, 4096
    buffer_load_dwordx4 v[72:75], v252, s[12:15], s45 offen offset:3072 sc1
    v_mfma_f32_16x16x32_bf16 v[96:99], a[164:167], v[88:91], v[96:99]
    v_xor_b32 v28, s32, v28
    v_xor_b32 v29, s32, v29
    v_mfma_f32_16x16x32_bf16 v[100:103], a[168:171], v[88:91], v[100:103]
    v_or_b32 v1, v28, v29
    v_xor_b32 v30, s32, v30
    v_mfma_f32_16x16x32_bf16 v[104:107], a[172:175], v[88:91], v[104:107]
    s_add_u32 s45, s40, 8192
    buffer_load_dwordx4 v[76:79], v252, s[12:15], s45 offen offset:0 sc1
    v_mfma_f32_16x16x32_bf16 v[108:111], a[176:179], v[88:91], v[108:111]
    v_xor_b32 v31, s32, v31
    v_or3_b32 v1, v30, v31, v1
    v_mfma_f32_16x16x32_bf16 v[112:115], a[160:163], v[16:19], v[112:115]
    v_mfma_f32_16x16x32_bf16 v[116:119], a[164:167], v[16:19], v[116:119]
    s_add_u32 s45, s40, 8192
    buffer_load_dwordx4 v[80:83], v252, s[12:15], s45 offen offset:1024 sc1
    v_mfma_f32_16x16x32_bf16 v[120:123], a[168:171], v[16:19], v[120:123]
    v_xor_b32 v32, s32, v32
    v_xor_b32 v33, s32, v33
    v_mfma_f32_16x16x32_bf16 v[124:127], a[172:175], v[16:19], v[124:127]
    v_or3_b32 v1, v32, v33, v1
    v_xor_b32 v34, s32, v34
    v_mfma_f32_16x16x32_bf16 v[128:131], a[176:179], v[16:19], v[128:131]
    s_add_u32 s45, s40, 8192
    buffer_load_dwordx4 v[84:87], v252, s[12:15], s45 offen offset:2048 sc1
    v_mfma_f32_16x16x32_bf16 v[132:135], a[160:163], v[20:23], v[132:135]
    v_xor_b32 v35, s32, v35
    v_or3_b32 v1, v34, v35, v1
    v_mfma_f32_16x16x32_bf16 v[136:139], a[164:167], v[20:23], v[136:139]
    v_xor_b32 v36, s32, v36
    v_xor_b32 v37, s32, v37
    v_mfma_f32_16x16x32_bf16 v[140:143], a[168:171], v[20:23], v[140:143]
    s_add_u32 s45, s40, 8192
    buffer_load_dwordx4 v[88:91], v252, s[12:15], s45 offen offset:3072 sc1
    v_mfma_f32_16x16x32_bf16 v[144:147], a[172:175], v[20:23], v[144:147]
    v_or3_b32 v1, v36, v37, v1
    v_xor_b32 v38, s32, v38
    v_mfma_f32_16x16x32_bf16 v[148:151], a[176:179], v[20:23], v[148:151]
    v_xor_b32 v39, s32, v39
    v_or3_b32 v1, v38, v39, v1
    v_mfma_f32_16x16x32_bf16 v[152:155], a[160:163], v[24:27], v[152:155]
    buffer_load_dwordx4 v[16:19], v252, s[12:15], s41 offen offset:0 sc1
    v_mfma_f32_16x16x32_bf16 v[156:159], a[164:167], v[24:27], v[156:159]
    v_xor_b32 v40, s32, v40
    v_xor_b32 v41, s32, v41
    v_mfma_f32_16x16x32_bf16 v[160:163], a[168:171], v[24:27], v[160:163]
    v_or3_b32 v1, v40, v41, v1
    v_xor_b32 v42, s32, v42
    v_mfma_f32_16x16x32_bf16 v[164:167], a[172:175], v[24:27], v[164:167]
    buffer_load_dwordx4 v[20:23], v252, s[12:15], s41 offen offset:1024 sc1
    v_mfma_f32_16x16x32_bf16 v[168:171], a[176:179], v[24:27], v[168:171]
    v_xor_b32 v43, s32, v43
    v_or3_b32 v1, v42, v43, v1
    v_and_b32 v1, 0x10001, v1
    v_cmp_ne_u32 vcc, 0, v1
    s_nop 1
    s_cbranch_vccnz va77
vad78:
    v_mfma_f32_16x16x32_bf16 v[92:95], a[220:223], v[28:31], v[92:95]
    buffer_load_dwordx4 v[24:27], v252, s[12:15], s41 offen offset:2048 sc1
    v_mfma_f32_16x16x32_bf16 v[96:99], a[224:227], v[28:31], v[96:99]
    v_mfma_f32_16x16x32_bf16 v[100:103], a[228:231], v[28:31], v[100:103]
    v_mfma_f32_16x16x32_bf16 v[104:107], a[232:235], v[28:31], v[104:107]
    v_mfma_f32_16x16x32_bf16 v[108:111], a[236:239], v[28:31], v[108:111]
    v_mfma_f32_16x16x32_bf16 v[112:115], a[220:223], v[32:35], v[112:115]
    v_mfma_f32_16x16x32_bf16 v[116:119], a[224:227], v[32:35], v[116:119]
    buffer_load_dwordx4 v[28:31], v252, s[12:15], s41 offen offset:3072 sc1
    v_mfma_f32_16x16x32_bf16 v[120:123], a[228:231], v[32:35], v[120:123]
    v_mfma_f32_16x16x32_bf16 v[124:127], a[232:235], v[32:35], v[124:127]
    ds_write_b128 v5, v[92:95] offset:0
    v_mfma_f32_16x16x32_bf16 v[128:131], a[236:239], v[32:35], v[128:131]
    v_mfma_f32_16x16x32_bf16 v[132:135], a[220:223], v[36:39], v[132:135]
    ds_write_b128 v5, v[96:99] offset:64
    v_mfma_f32_16x16x32_bf16 v[136:139], a[224:227], v[36:39], v[136:139]
    v_mfma_f32_16x16x32_bf16 v[140:143], a[228:231], v[36:39], v[140:143]
    s_add_u32 s45, s41, 4096
    buffer_load_dwordx4 v[32:35], v252, s[12:15], s45 offen offset:0 sc1
    v_mfma_f32_16x16x32_bf16 v[144:147], a[232:235], v[36:39], v[144:147]
    ds_write_b128 v5, v[100:103] offset:128
    v_mfma_f32_16x16x32_bf16 v[148:151], a[236:239], v[36:39], v[148:151]
    v_mfma_f32_16x16x32_bf16 v[152:155], a[220:223], v[40:43], v[152:155]
    s_add_u32 s45, s41, 4096
    buffer_load_dwordx4 v[36:39], v252, s[12:15], s45 offen offset:1024 sc1
    v_mfma_f32_16x16x32_bf16 v[156:159], a[224:227], v[40:43], v[156:159]
    ds_write_b128 v5, v[104:107] offset:192
    v_mfma_f32_16x16x32_bf16 v[160:163], a[228:231], v[40:43], v[160:163]
    v_mfma_f32_16x16x32_bf16 v[164:167], a[232:235], v[40:43], v[164:167]
    ds_write_b128 v5, v[108:111] offset:256
    v_mfma_f32_16x16x32_bf16 v[168:171], a[236:239], v[40:43], v[168:171]
    s_waitcnt vmcnt(17)
    v_mfma_f32_16x16x32_bf16 v[172:175], a[0:3], v[44:47], 0
    s_add_u32 s45, s41, 4096
    buffer_load_dwordx4 v[40:43], v252, s[12:15], s45 offen offset:2048 sc1
    v_mfma_f32_16x16x32_bf16 v[176:179], a[4:7], v[44:47], 0
    ds_write_b128 v5, v[112:115] offset:5376
    v_mfma_f32_16x16x32_bf16 v[180:183], a[8:11], v[44:47], 0
    v_mfma_f32_16x16x32_bf16 v[184:187], a[12:15], v[44:47], 0
    ds_write_b128 v5, v[116:119] offset:5440
    v_mfma_f32_16x16x32_bf16 v[188:191], a[16:19], v[44:47], 0
    s_waitcnt vmcnt(17)
    v_mfma_f32_16x16x32_bf16 v[172:175], a[20:23], v[48:51], v[172:175]
    s_add_u32 s45, s41, 4096
    buffer_load_dwordx4 v[44:47], v252, s[12:15], s45 offen offset:3072 sc1
    v_mfma_f32_16x16x32_bf16 v[176:179], a[24:27], v[48:51], v[176:179]
    ds_write_b128 v5, v[120:123] offset:5504
    v_mfma_f32_16x16x32_bf16 v[180:183], a[28:31], v[48:51], v[180:183]
    v_mfma_f32_16x16x32_bf16 v[184:187], a[32:35], v[48:51], v[184:187]
    ds_write_b128 v5, v[124:127] offset:5568
    v_mfma_f32_16x16x32_bf16 v[188:191], a[36:39], v[48:51], v[188:191]
    s_waitcnt vmcnt(17)
    v_mfma_f32_16x16x32_bf16 v[172:175], a[40:43], v[52:55], v[172:175]
    s_add_u32 s45, s41, 8192
    buffer_load_dwordx4 v[48:51], v252, s[12:15], s45 offen offset:0 sc1
    v_mfma_f32_16x16x32_bf16 v[176:179], a[44:47], v[52:55], v[176:179]
    ds_write_b128 v5, v[128:131] offset:5632
    v_mfma_f32_16x16x32_bf16 v[180:183], a[48:51], v[52:55], v[180:183]
    v_mfma_f32_16x16x32_bf16 v[184:187], a[52:55], v[52:55], v[184:187]
    ds_write_b128 v5, v[132:135] offset:10752
    v_mfma_f32_16x16x32_bf16 v[188:191], a[56:59], v[52:55], v[188:191]
    s_waitcnt vmcnt(17)
    v_mfma_f32_16x16x32_bf16 v[172:175], a[60:63], v[56:59], v[172:175]
    s_add_u32 s45, s41, 8192
    buffer_load_dwordx4 v[52:55], v252, s[12:15], s45 offen offset:1024 sc1
    v_mfma_f32_16x16x32_bf16 v[176:179], a[64:67], v[56:59], v[176:179]
    ds_write_b128 v5, v[136:139] offset:10816
    v_mfma_f32_16x16x32_bf16 v[180:183], a[68:71], v[56:59], v[180:183]
    v_mfma_f32_16x16x32_bf16 v[184:187], a[72:75], v[56:59], v[184:187]
    ds_write_b128 v5, v[140:143] offset:10880
    v_mfma_f32_16x16x32_bf16 v[188:191], a[76:79], v[56:59], v[188:191]
    s_waitcnt vmcnt(17)
    v_mfma_f32_16x16x32_bf16 v[172:175], a[80:83], v[60:63], v[172:175]
    s_add_u32 s45, s41, 8192
    buffer_load_dwordx4 v[56:59], v252, s[12:15], s45 offen offset:2048 sc1
    v_mfma_f32_16x16x32_bf16 v[176:179], a[84:87], v[60:63], v[176:179]
    ds_write_b128 v5, v[144:147] offset:10944
    v_mfma_f32_16x16x32_bf16 v[180:183], a[88:91], v[60:63], v[180:183]
    v_mfma_f32_16x16x32_bf16 v[184:187], a[92:95], v[60:63], v[184:187]
    s_waitcnt lgkmcnt(9)
    ds_write_b128 v5, v[148:151] offset:11008
    v_mfma_f32_16x16x32_bf16 v[188:191], a[96:99], v[60:63], v[188:191]
    s_waitcnt vmcnt(17)
    v_mfma_f32_16x16x32_bf16 v[172:175], a[100:103], v[64:67], v[172:175]
    s_add_u32 s45, s41, 8192
    buffer_load_dwordx4 v[60:63], v252, s[12:15], s45 offen offset:3072 sc1
    v_mfma_f32_16x16x32_bf16 v[176:179], a[104:107], v[64:67], v[176:179]
    v_mfma_f32_16x16x32_bf16 v[180:183], a[108:111], v[64:67], v[180:183]
    v_mfma_f32_16x16x32_bf16 v[184:187], a[112:115], v[64:67], v[184:187]
    ds_write_b128 v5, v[152:155] offset:16128
    v_mfma_f32_16x16x32_bf16 v[188:191], a[116:119], v[64:67], v[188:191]
    s_waitcnt vmcnt(17)
    v_mfma_f32_16x16x32_bf16 v[172:175], a[120:123], v[68:71], v[172:175]
    buffer_load_dwordx4 v[64:67], v252, s[12:15], s42 offen offset:0 sc1
    v_mfma_f32_16x16x32_bf16 v[176:179], a[124:127], v[68:71], v[176:179]
    ds_write_b128 v5, v[156:159] offset:16192
    v_mfma_f32_16x16x32_bf16 v[180:183], a[128:131], v[68:71], v[180:183]
    v_mfma_f32_16x16x32_bf16 v[184:187], a[132:135], v[68:71], v[184:187]
    ds_write_b128 v5, v[160:163] offset:16256
    v_mfma_f32_16x16x32_bf16 v[188:191], a[136:139], v[68:71], v[188:191]
    s_waitcnt vmcnt(17)
    v_mfma_f32_16x16x32_bf16 v[172:175], a[140:143], v[72:75], v[172:175]
    buffer_load_dwordx4 v[68:71], v252, s[12:15], s42 offen offset:1024 sc1
    v_mfma_f32_16x16x32_bf16 v[176:179], a[144:147], v[72:75], v[176:179]
    ds_write_b128 v5, v[164:167] offset:16320
    v_mfma_f32_16x16x32_bf16 v[180:183], a[148:151], v[72:75], v[180:183]
    v_mfma_f32_16x16x32_bf16 v[184:187], a[152:155], v[72:75], v[184:187]
    s_waitcnt lgkmcnt(9)
    ds_write_b128 v5, v[168:171] offset:16384
    v_mfma_f32_16x16x32_bf16 v[188:191], a[156:159], v[72:75], v[188:191]
    s_waitcnt vmcnt(17)
    v_mfma_f32_16x16x32_bf16 v[172:175], a[160:163], v[76:79], v[172:175]
    buffer_load_dwordx4 v[72:75], v252, s[12:15], s42 offen offset:2048 sc1
    v_mfma_f32_16x16x32_bf16 v[176:179], a[164:167], v[76:79], v[176:179]
    v_mfma_f32_16x16x32_bf16 v[180:183], a[168:171], v[76:79], v[180:183]
    s_waitcnt lgkmcnt(0)
    s_barrier
    v_mfma_f32_16x16x32_bf16 v[184:187], a[172:175], v[76:79], v[184:187]
    ds_read_b128 v[92:95], v6 offset:0
    v_mfma_f32_16x16x32_bf16 v[188:191], a[176:179], v[76:79], v[188:191]
    ds_read_b128 v[96:99], v6 offset:21504
    s_waitcnt vmcnt(17)
    v_mfma_f32_16x16x32_bf16 v[172:175], a[180:183], v[80:83], v[172:175]
    buffer_load_dwordx4 v[76:79], v252, s[12:15], s42 offen offset:3072 sc1
    ds_read_b128 v[100:103], v6 offset:43008
    v_mfma_f32_16x16x32_bf16 v[176:179], a[184:187], v[80:83], v[176:179]
    ds_read_b128 v[104:107], v6 offset:64512
    v_mfma_f32_16x16x32_bf16 v[180:183], a[188:191], v[80:83], v[180:183]
    ds_read_b128 v[108:111], v7 offset:0
    v_mfma_f32_16x16x32_bf16 v[184:187], a[192:195], v[80:83], v[184:187]
    ds_read_b128 v[112:115], v7 offset:21504
    v_mfma_f32_16x16x32_bf16 v[188:191], a[196:199], v[80:83], v[188:191]
    ds_read_b128 v[116:119], v7 offset:43008
    s_waitcnt vmcnt(17)
    v_mfma_f32_16x16x32_bf16 v[172:175], a[200:203], v[84:87], v[172:175]
    s_add_u32 s45, s42, 4096
    buffer_load_dwordx4 v[80:83], v252, s[12:15], s45 offen offset:0 sc1
    v_mfma_f32_16x16x32_bf16 v[176:179], a[204:207], v[84:87], v[176:179]
    ds_read_b128 v[120:123], v7 offset:64512
    v_mfma_f32_16x16x32_bf16 v[180:183], a[208:211], v[84:87], v[180:183]
    s_waitcnt lgkmcnt(4)
    v_mfma_f32_16x16x32_bf16 v[184:187], a[212:215], v[84:87], v[184:187]
    ds_read_b128 v[124:127], v8 offset:0
    v_add_f32 v92, v92, v96
    v_mfma_f32_16x16x32_bf16 v[188:191], a[216:219], v[84:87], v[188:191]
    v_add_f32 v93, v93, v97
    v_add_f32 v94, v94, v98
    s_waitcnt vmcnt(17)
    v_mfma_f32_16x16x32_bf16 v[172:175], a[220:223], v[88:91], v[172:175]
    s_add_u32 s45, s42, 4096
    buffer_load_dwordx4 v[84:87], v252, s[12:15], s45 offen offset:1024 sc1
    v_mfma_f32_16x16x32_bf16 v[176:179], a[224:227], v[88:91], v[176:179]
    ds_read_b128 v[128:131], v8 offset:21504
    v_add_f32 v95, v95, v99
    v_mfma_f32_16x16x32_bf16 v[180:183], a[228:231], v[88:91], v[180:183]
    v_add_f32 v100, v100, v104
    v_add_f32 v101, v101, v105
    v_mfma_f32_16x16x32_bf16 v[184:187], a[232:235], v[88:91], v[184:187]
    ds_read_b128 v[132:135], v8 offset:43008
    v_add_f32 v102, v102, v106
    v_mfma_f32_16x16x32_bf16 v[188:191], a[236:239], v[88:91], v[188:191]
    v_add_f32 v103, v103, v107
    v_add_f32 v92, v92, v100
    s_waitcnt vmcnt(17)
    v_mfma_f32_16x16x32_bf16 v[192:195], a[0:3], v[16:19], 0
    s_add_u32 s45, s42, 4096
    buffer_load_dwordx4 v[88:91], v252, s[12:15], s45 offen offset:2048 sc1
    v_mfma_f32_16x16x32_bf16 v[196:199], a[4:7], v[16:19], 0
    ds_read_b128 v[136:139], v8 offset:64512
    v_add_f32 v93, v93, v101
    v_mfma_f32_16x16x32_bf16 v[200:203], a[8:11], v[16:19], 0
    v_add_f32 v94, v94, v102
    v_add_f32 v95, v95, v103
    v_mfma_f32_16x16x32_bf16 v[204:207], a[12:15], v[16:19], 0
    s_waitcnt lgkmcnt(4)
    ds_read_b128 v[140:143], v9 offset:0
    v_mfma_f32_16x16x32_bf16 v[208:211], a[16:19], v[16:19], 0
    v_add_f32 v108, v108, v112
    v_add_f32 v109, v109, v113
    s_waitcnt vmcnt(17)
    v_mfma_f32_16x16x32_bf16 v[192:195], a[20:23], v[20:23], v[192:195]
    s_add_u32 s45, s42, 4096
    buffer_load_dwordx4 v[16:19], v252, s[12:15], s45 offen offset:3072 sc1
    v_mfma_f32_16x16x32_bf16 v[196:199], a[24:27], v[20:23], v[196:199]
    v_add_f32 v110, v110, v114
    ds_read_b128 v[144:147], v9 offset:21504
    v_mfma_f32_16x16x32_bf16 v[200:203], a[28:31], v[20:23], v[200:203]
    v_add_f32 v111, v111, v115
    v_add_f32 v116, v116, v120
    v_mfma_f32_16x16x32_bf16 v[204:207], a[32:35], v[20:23], v[204:207]
    v_add_f32 v117, v117, v121
    ds_read_b128 v[148:151], v9 offset:43008
    v_mfma_f32_16x16x32_bf16 v[208:211], a[36:39], v[20:23], v[208:211]
    v_add_f32 v118, v118, v122
    v_add_f32 v119, v119, v123
    s_waitcnt vmcnt(17)
    v_mfma_f32_16x16x32_bf16 v[192:195], a[40:43], v[24:27], v[192:195]
    s_add_u32 s45, s42, 8192
    buffer_load_dwordx4 v[20:23], v252, s[12:15], s45 offen offset:0 sc1
    v_mfma_f32_16x16x32_bf16 v[196:199], a[44:47], v[24:27], v[196:199]
    v_add_f32 v108, v108, v116
    ds_read_b128 v[152:155], v9 offset:64512
    v_mfma_f32_16x16x32_bf16 v[200:203], a[48:51], v[24:27], v[200:203]
    v_add_f32 v109, v109, v117
    v_add_f32 v110, v110, v118
    v_mfma_f32_16x16x32_bf16 v[204:207], a[52:55], v[24:27], v[204:207]
    v_add_f32 v111, v111, v119
    v_and_or_b32 v92, v92, s83, v3
    v_mfma_f32_16x16x32_bf16 v[208:211], a[56:59], v[24:27], v[208:211]
    v_and_or_b32 v93, v93, s83, v3
    v_and_or_b32 v94, v94, s83, v3
    s_waitcnt vmcnt(17)
    v_mfma_f32_16x16x32_bf16 v[192:195], a[60:63], v[28:31], v[192:195]
    s_add_u32 s45, s42, 8192
    buffer_load_dwordx4 v[24:27], v252, s[12:15], s45 offen offset:1024 sc1
    v_mfma_f32_16x16x32_bf16 v[196:199], a[64:67], v[28:31], v[196:199]
    v_and_or_b32 v95, v95, s83, v3
    buffer_store_dwordx4 v[92:95], v252, s[12:15], s96 offen offset:0 sc1
    v_mfma_f32_16x16x32_bf16 v[200:203], a[68:71], v[28:31], v[200:203]
    s_waitcnt lgkmcnt(4)
    ds_read_b128 v[156:159], v10 offset:0
    v_mfma_f32_16x16x32_bf16 v[204:207], a[72:75], v[28:31], v[204:207]
    v_add_f32 v124, v124, v128
    v_add_f32 v125, v125, v129
    v_mfma_f32_16x16x32_bf16 v[208:211], a[76:79], v[28:31], v[208:211]
    v_add_f32 v126, v126, v130
    ds_read_b128 v[160:163], v10 offset:21504
    s_waitcnt vmcnt(18)
    v_mfma_f32_16x16x32_bf16 v[192:195], a[80:83], v[32:35], v[192:195]
    s_add_u32 s45, s42, 8192
    buffer_load_dwordx4 v[28:31], v252, s[12:15], s45 offen offset:2048 sc1
    v_mfma_f32_16x16x32_bf16 v[196:199], a[84:87], v[32:35], v[196:199]
    v_add_f32 v127, v127, v131
    v_add_f32 v132, v132, v136
    v_mfma_f32_16x16x32_bf16 v[200:203], a[88:91], v[32:35], v[200:203]
    v_add_f32 v133, v133, v137
    ds_read_b128 v[164:167], v10 offset:43008
    v_mfma_f32_16x16x32_bf16 v[204:207], a[92:95], v[32:35], v[204:207]
    v_add_f32 v134, v134, v138
    v_add_f32 v135, v135, v139
    v_mfma_f32_16x16x32_bf16 v[208:211], a[96:99], v[32:35], v[208:211]
    v_add_f32 v124, v124, v132
    ds_read_b128 v[168:171], v10 offset:64512
    s_waitcnt vmcnt(18)
    v_mfma_f32_16x16x32_bf16 v[192:195], a[100:103], v[36:39], v[192:195]
    s_add_u32 s45, s42, 8192
    buffer_load_dwordx4 v[32:35], v252, s[12:15], s45 offen offset:3072 sc1
    v_mfma_f32_16x16x32_bf16 v[196:199], a[104:107], v[36:39], v[196:199]
    v_add_f32 v125, v125, v133
    v_add_f32 v126, v126, v134
    v_mfma_f32_16x16x32_bf16 v[200:203], a[108:111], v[36:39], v[200:203]
    v_add_f32 v127, v127, v135
    v_and_or_b32 v108, v108, s83, v3
    v_mfma_f32_16x16x32_bf16 v[204:207], a[112:115], v[36:39], v[204:207]
    v_and_or_b32 v109, v109, s83, v3
    v_and_or_b32 v110, v110, s83, v3
    v_mfma_f32_16x16x32_bf16 v[208:211], a[116:119], v[36:39], v[208:211]
    v_and_or_b32 v111, v111, s83, v3
    buffer_store_dwordx4 v[108:111], v252, s[12:15], s96 offen offset:1024 sc1
    s_waitcnt vmcnt(19)
    v_mfma_f32_16x16x32_bf16 v[192:195], a[120:123], v[40:43], v[192:195]
    buffer_load_dwordx4 v[36:39], v252, s[12:15], s43 offen offset:0 sc1
    s_waitcnt lgkmcnt(4)
    v_mfma_f32_16x16x32_bf16 v[196:199], a[124:127], v[40:43], v[196:199]
    v_add_f32 v140, v140, v144
    v_add_f32 v141, v141, v145
    v_mfma_f32_16x16x32_bf16 v[200:203], a[128:131], v[40:43], v[200:203]
    v_add_f32 v142, v142, v146
    v_add_f32 v143, v143, v147
    v_mfma_f32_16x16x32_bf16 v[204:207], a[132:135], v[40:43], v[204:207]
    v_add_f32 v148, v148, v152
    v_add_f32 v149, v149, v153
    v_mfma_f32_16x16x32_bf16 v[208:211], a[136:139], v[40:43], v[208:211]
    v_add_f32 v150, v150, v154
    v_add_f32 v151, v151, v155
    s_waitcnt vmcnt(19)
    v_mfma_f32_16x16x32_bf16 v[192:195], a[140:143], v[44:47], v[192:195]
    buffer_load_dwordx4 v[40:43], v252, s[12:15], s43 offen offset:1024 sc1
    v_add_f32 v140, v140, v148
    v_mfma_f32_16x16x32_bf16 v[196:199], a[144:147], v[44:47], v[196:199]
    v_add_f32 v141, v141, v149
    v_add_f32 v142, v142, v150
    v_mfma_f32_16x16x32_bf16 v[200:203], a[148:151], v[44:47], v[200:203]
    v_add_f32 v143, v143, v151
    v_and_or_b32 v124, v124, s83, v3
    v_mfma_f32_16x16x32_bf16 v[204:207], a[152:155], v[44:47], v[204:207]
    v_and_or_b32 v125, v125, s83, v3
    v_and_or_b32 v126, v126, s83, v3
    v_mfma_f32_16x16x32_bf16 v[208:211], a[156:159], v[44:47], v[208:211]
    v_and_or_b32 v127, v127, s83, v3
    buffer_store_dwordx4 v[124:127], v252, s[12:15], s96 offen offset:2048 sc1
    s_waitcnt vmcnt(20)
    v_mfma_f32_16x16x32_bf16 v[192:195], a[160:163], v[48:51], v[192:195]
    buffer_load_dwordx4 v[44:47], v252, s[12:15], s43 offen offset:2048 sc1
    s_waitcnt lgkmcnt(0)
    v_mfma_f32_16x16x32_bf16 v[196:199], a[164:167], v[48:51], v[196:199]
    v_add_f32 v156, v156, v160
    v_add_f32 v157, v157, v161
    v_mfma_f32_16x16x32_bf16 v[200:203], a[168:171], v[48:51], v[200:203]
    v_add_f32 v158, v158, v162
    v_add_f32 v159, v159, v163
    v_mfma_f32_16x16x32_bf16 v[204:207], a[172:175], v[48:51], v[204:207]
    v_add_f32 v164, v164, v168
    v_add_f32 v165, v165, v169
    v_mfma_f32_16x16x32_bf16 v[208:211], a[176:179], v[48:51], v[208:211]
    v_add_f32 v166, v166, v170
    v_add_f32 v167, v167, v171
    s_waitcnt vmcnt(20)
    v_mfma_f32_16x16x32_bf16 v[192:195], a[180:183], v[52:55], v[192:195]
    buffer_load_dwordx4 v[48:51], v252, s[12:15], s43 offen offset:3072 sc1
    v_add_f32 v156, v156, v164
    v_mfma_f32_16x16x32_bf16 v[196:199], a[184:187], v[52:55], v[196:199]
    v_add_f32 v157, v157, v165
    v_add_f32 v158, v158, v166
    v_mfma_f32_16x16x32_bf16 v[200:203], a[188:191], v[52:55], v[200:203]
    v_add_f32 v159, v159, v167
    v_and_or_b32 v140, v140, s83, v3
    v_mfma_f32_16x16x32_bf16 v[204:207], a[192:195], v[52:55], v[204:207]
    v_and_or_b32 v141, v141, s83, v3
    v_and_or_b32 v142, v142, s83, v3
    v_mfma_f32_16x16x32_bf16 v[208:211], a[196:199], v[52:55], v[208:211]
    v_and_or_b32 v143, v143, s83, v3
    buffer_store_dwordx4 v[140:143], v252, s[12:15], s96 offen offset:3072 sc1
    s_waitcnt vmcnt(21)
    v_mfma_f32_16x16x32_bf16 v[192:195], a[200:203], v[56:59], v[192:195]
    s_add_u32 s45, s43, 4096
    buffer_load_dwordx4 v[52:55], v252, s[12:15], s45 offen offset:0 sc1
    v_mfma_f32_16x16x32_bf16 v[196:199], a[204:207], v[56:59], v[196:199]
    v_and_or_b32 v156, v156, s83, v3
    v_and_or_b32 v157, v157, s83, v3
    v_mfma_f32_16x16x32_bf16 v[200:203], a[208:211], v[56:59], v[200:203]
    v_and_or_b32 v158, v158, s83, v3
    v_and_or_b32 v159, v159, s83, v3
    v_mfma_f32_16x16x32_bf16 v[204:207], a[212:215], v[56:59], v[204:207]
    buffer_store_dwordx4 v[156:159], v252, s[12:15], s97 offen offset:0 sc1
    v_mfma_f32_16x16x32_bf16 v[208:211], a[216:219], v[56:59], v[208:211]
    s_barrier
    s_waitcnt vmcnt(22)
    v_mfma_f32_16x16x32_bf16 v[192:195], a[220:223], v[60:63], v[192:195]
    s_add_u32 s45, s43, 4096
    buffer_load_dwordx4 v[56:59], v252, s[12:15], s45 offen offset:1024 sc1
    v_mfma_f32_16x16x32_bf16 v[196:199], a[224:227], v[60:63], v[196:199]
    ds_write_b128 v5, v[172:175] offset:0
    v_mfma_f32_16x16x32_bf16 v[200:203], a[228:231], v[60:63], v[200:203]
    v_mfma_f32_16x16x32_bf16 v[204:207], a[232:235], v[60:63], v[204:207]
    ds_write_b128 v5, v[176:179] offset:64
    v_mfma_f32_16x16x32_bf16 v[208:211], a[236:239], v[60:63], v[208:211]
    s_waitcnt vmcnt(22)
    v_mfma_f32_16x16x32_bf16 v[212:215], a[0:3], v[64:67], 0
    s_add_u32 s45, s43, 4096
    buffer_load_dwordx4 v[60:63], v252, s[12:15], s45 offen offset:2048 sc1
    v_mfma_f32_16x16x32_bf16 v[216:219], a[4:7], v[64:67], 0
    ds_write_b128 v5, v[180:183] offset:128
    v_mfma_f32_16x16x32_bf16 v[220:223], a[8:11], v[64:67], 0
    v_mfma_f32_16x16x32_bf16 v[224:227], a[12:15], v[64:67], 0
    ds_write_b128 v5, v[184:187] offset:192
    v_mfma_f32_16x16x32_bf16 v[228:231], a[16:19], v[64:67], 0
    s_waitcnt vmcnt(22)
    v_mfma_f32_16x16x32_bf16 v[212:215], a[20:23], v[68:71], v[212:215]
    s_add_u32 s45, s43, 4096
    buffer_load_dwordx4 v[64:67], v252, s[12:15], s45 offen offset:3072 sc1
    v_mfma_f32_16x16x32_bf16 v[216:219], a[24:27], v[68:71], v[216:219]
    ds_write_b128 v5, v[188:191] offset:256
    v_mfma_f32_16x16x32_bf16 v[220:223], a[28:31], v[68:71], v[220:223]
    v_mfma_f32_16x16x32_bf16 v[224:227], a[32:35], v[68:71], v[224:227]
    ds_write_b128 v5, v[192:195] offset:5376
    v_mfma_f32_16x16x32_bf16 v[228:231], a[36:39], v[68:71], v[228:231]
    s_waitcnt vmcnt(22)
    v_mfma_f32_16x16x32_bf16 v[212:215], a[40:43], v[72:75], v[212:215]
    s_add_u32 s45, s43, 8192
    buffer_load_dwordx4 v[68:71], v252, s[12:15], s45 offen offset:0 sc1
    v_mfma_f32_16x16x32_bf16 v[216:219], a[44:47], v[72:75], v[216:219]
    ds_write_b128 v5, v[196:199] offset:5440
    v_mfma_f32_16x16x32_bf16 v[220:223], a[48:51], v[72:75], v[220:223]
    v_mfma_f32_16x16x32_bf16 v[224:227], a[52:55], v[72:75], v[224:227]
    ds_write_b128 v5, v[200:203] offset:5504
    v_mfma_f32_16x16x32_bf16 v[228:231], a[56:59], v[72:75], v[228:231]
    s_waitcnt vmcnt(22)
    v_mfma_f32_16x16x32_bf16 v[212:215], a[60:63], v[76:79], v[212:215]
    s_add_u32 s45, s43, 8192
    buffer_load_dwordx4 v[72:75], v252, s[12:15], s45 offen offset:1024 sc1
    v_mfma_f32_16x16x32_bf16 v[216:219], a[64:67], v[76:79], v[216:219]
    ds_write_b128 v5, v[204:207] offset:5568
    v_mfma_f32_16x16x32_bf16 v[220:223], a[68:71], v[76:79], v[220:223]
    v_mfma_f32_16x16x32_bf16 v[224:227], a[72:75], v[76:79], v[224:227]
    ds_write_b128 v5, v[208:211] offset:5632
    v_mfma_f32_16x16x32_bf16 v[228:231], a[76:79], v[76:79], v[228:231]
    s_waitcnt vmcnt(22)
    v_mfma_f32_16x16x32_bf16 v[212:215], a[80:83], v[80:83], v[212:215]
    s_add_u32 s45, s43, 8192
    buffer_load_dwordx4 v[76:79], v252, s[12:15], s45 offen offset:2048 sc1
    v_mfma_f32_16x16x32_bf16 v[216:219], a[84:87], v[80:83], v[216:219]
    v_mfma_f32_16x16x32_bf16 v[220:223], a[88:91], v[80:83], v[220:223]
    v_mfma_f32_16x16x32_bf16 v[224:227], a[92:95], v[80:83], v[224:227]
    v_mfma_f32_16x16x32_bf16 v[228:231], a[96:99], v[80:83], v[228:231]
    s_waitcnt vmcnt(22)
    v_mfma_f32_16x16x32_bf16 v[212:215], a[100:103], v[84:87], v[212:215]
    s_add_u32 s45, s43, 8192
    buffer_load_dwordx4 v[80:83], v252, s[12:15], s45 offen offset:3072 sc1
    v_mfma_f32_16x16x32_bf16 v[216:219], a[104:107], v[84:87], v[216:219]
    v_mfma_f32_16x16x32_bf16 v[220:223], a[108:111], v[84:87], v[220:223]
    v_mfma_f32_16x16x32_bf16 v[224:227], a[112:115], v[84:87], v[224:227]
    v_mfma_f32_16x16x32_bf16 v[228:231], a[116:119], v[84:87], v[228:231]
    s_waitcnt vmcnt(22)
    v_mfma_f32_16x16x32_bf16 v[212:215], a[120:123], v[88:91], v[212:215]
    v_mfma_f32_16x16x32_bf16 v[216:219], a[124:127], v[88:91], v[216:219]
    v_mfma_f32_16x16x32_bf16 v[220:223], a[128:131], v[88:91], v[220:223]
    v_mfma_f32_16x16x32_bf16 v[224:227], a[132:135], v[88:91], v[224:227]
    v_mfma_f32_16x16x32_bf16 v[228:231], a[136:139], v[88:91], v[228:231]
    s_waitcnt vmcnt(21)
    v_mfma_f32_16x16x32_bf16 v[212:215], a[140:143], v[16:19], v[212:215]
    v_mfma_f32_16x16x32_bf16 v[216:219], a[144:147], v[16:19], v[216:219]
    v_mfma_f32_16x16x32_bf16 v[220:223], a[148:151], v[16:19], v[220:223]
    v_mfma_f32_16x16x32_bf16 v[224:227], a[152:155], v[16:19], v[224:227]
    v_mfma_f32_16x16x32_bf16 v[228:231], a[156:159], v[16:19], v[228:231]
    s_waitcnt vmcnt(20)
    v_mfma_f32_16x16x32_bf16 v[212:215], a[160:163], v[20:23], v[212:215]
    v_mfma_f32_16x16x32_bf16 v[216:219], a[164:167], v[20:23], v[216:219]
    v_mfma_f32_16x16x32_bf16 v[220:223], a[168:171], v[20:23], v[220:223]
    v_mfma_f32_16x16x32_bf16 v[224:227], a[172:175], v[20:23], v[224:227]
    v_mfma_f32_16x16x32_bf16 v[228:231], a[176:179], v[20:23], v[228:231]
    s_waitcnt vmcnt(19)
    v_mfma_f32_16x16x32_bf16 v[212:215], a[180:183], v[24:27], v[212:215]
    v_mfma_f32_16x16x32_bf16 v[216:219], a[184:187], v[24:27], v[216:219]
    v_mfma_f32_16x16x32_bf16 v[220:223], a[188:191], v[24:27], v[220:223]
    v_mfma_f32_16x16x32_bf16 v[224:227], a[192:195], v[24:27], v[224:227]
    v_mfma_f32_16x16x32_bf16 v[228:231], a[196:199], v[24:27], v[228:231]
    s_waitcnt vmcnt(17)
    v_mfma_f32_16x16x32_bf16 v[212:215], a[200:203], v[28:31], v[212:215]
    v_mfma_f32_16x16x32_bf16 v[216:219], a[204:207], v[28:31], v[216:219]
    v_mfma_f32_16x16x32_bf16 v[220:223], a[208:211], v[28:31], v[220:223]
    v_mfma_f32_16x16x32_bf16 v[224:227], a[212:215], v[28:31], v[224:227]
    v_mfma_f32_16x16x32_bf16 v[228:231], a[216:219], v[28:31], v[228:231]
    s_waitcnt vmcnt(16)
    v_mfma_f32_16x16x32_bf16 v[212:215], a[220:223], v[32:35], v[212:215]
    v_mfma_f32_16x16x32_bf16 v[216:219], a[224:227], v[32:35], v[216:219]
    v_mfma_f32_16x16x32_bf16 v[220:223], a[228:231], v[32:35], v[220:223]
    v_mfma_f32_16x16x32_bf16 v[224:227], a[232:235], v[32:35], v[224:227]
    v_mfma_f32_16x16x32_bf16 v[228:231], a[236:239], v[32:35], v[228:231]
    s_waitcnt vmcnt(14)
    v_mfma_f32_16x16x32_bf16 v[232:235], a[0:3], v[36:39], 0
    v_mfma_f32_16x16x32_bf16 v[236:239], a[4:7], v[36:39], 0
    v_mfma_f32_16x16x32_bf16 v[240:243], a[8:11], v[36:39], 0
    v_mfma_f32_16x16x32_bf16 v[244:247], a[12:15], v[36:39], 0
    v_mfma_f32_16x16x32_bf16 v[248:251], a[16:19], v[36:39], 0
    s_waitcnt vmcnt(13)
    v_mfma_f32_16x16x32_bf16 v[232:235], a[20:23], v[40:43], v[232:235]
    ds_write_b128 v5, v[212:215] offset:10752
    v_mfma_f32_16x16x32_bf16 v[236:239], a[24:27], v[40:43], v[236:239]
    v_mfma_f32_16x16x32_bf16 v[240:243], a[28:31], v[40:43], v[240:243]
    ds_write_b128 v5, v[216:219] offset:10816
    v_mfma_f32_16x16x32_bf16 v[244:247], a[32:35], v[40:43], v[244:247]
    v_mfma_f32_16x16x32_bf16 v[248:251], a[36:39], v[40:43], v[248:251]
    ds_write_b128 v5, v[220:223] offset:10880
    s_waitcnt vmcnt(11)
    v_mfma_f32_16x16x32_bf16 v[232:235], a[40:43], v[44:47], v[232:235]
    v_mfma_f32_16x16x32_bf16 v[236:239], a[44:47], v[44:47], v[236:239]
    ds_write_b128 v5, v[224:227] offset:10944
    v_mfma_f32_16x16x32_bf16 v[240:243], a[48:51], v[44:47], v[240:243]
    v_mfma_f32_16x16x32_bf16 v[244:247], a[52:55], v[44:47], v[244:247]
    s_waitcnt lgkmcnt(9)
    ds_write_b128 v5, v[228:231] offset:11008
    v_mfma_f32_16x16x32_bf16 v[248:251], a[56:59], v[44:47], v[248:251]
    s_waitcnt vmcnt(10)
    v_mfma_f32_16x16x32_bf16 v[232:235], a[60:63], v[48:51], v[232:235]
    v_mfma_f32_16x16x32_bf16 v[236:239], a[64:67], v[48:51], v[236:239]
    v_mfma_f32_16x16x32_bf16 v[240:243], a[68:71], v[48:51], v[240:243]
    v_mfma_f32_16x16x32_bf16 v[244:247], a[72:75], v[48:51], v[244:247]
    v_mfma_f32_16x16x32_bf16 v[248:251], a[76:79], v[48:51], v[248:251]
    s_waitcnt vmcnt(8)
    v_mfma_f32_16x16x32_bf16 v[232:235], a[80:83], v[52:55], v[232:235]
    v_mfma_f32_16x16x32_bf16 v[236:239], a[84:87], v[52:55], v[236:239]
    v_mfma_f32_16x16x32_bf16 v[240:243], a[88:91], v[52:55], v[240:243]
    v_mfma_f32_16x16x32_bf16 v[244:247], a[92:95], v[52:55], v[244:247]
    v_mfma_f32_16x16x32_bf16 v[248:251], a[96:99], v[52:55], v[248:251]
    s_waitcnt vmcnt(6)
    v_mfma_f32_16x16x32_bf16 v[232:235], a[100:103], v[56:59], v[232:235]
    v_mfma_f32_16x16x32_bf16 v[236:239], a[104:107], v[56:59], v[236:239]
    v_mfma_f32_16x16x32_bf16 v[240:243], a[108:111], v[56:59], v[240:243]
    v_mfma_f32_16x16x32_bf16 v[244:247], a[112:115], v[56:59], v[244:247]
    v_mfma_f32_16x16x32_bf16 v[248:251], a[116:119], v[56:59], v[248:251]
    s_waitcnt vmcnt(5)
    v_mfma_f32_16x16x32_bf16 v[232:235], a[120:123], v[60:63], v[232:235]
    v_mfma_f32_16x16x32_bf16 v[236:239], a[124:127], v[60:63], v[236:239]
    v_mfma_f32_16x16x32_bf16 v[240:243], a[128:131], v[60:63], v[240:243]
    v_mfma_f32_16x16x32_bf16 v[244:247], a[132:135], v[60:63], v[244:247]
    v_mfma_f32_16x16x32_bf16 v[248:251], a[136:139], v[60:63], v[248:251]
    s_waitcnt vmcnt(4)
    v_mfma_f32_16x16x32_bf16 v[232:235], a[140:143], v[64:67], v[232:235]
    v_mfma_f32_16x16x32_bf16 v[236:239], a[144:147], v[64:67], v[236:239]
    v_mfma_f32_16x16x32_bf16 v[240:243], a[148:151], v[64:67], v[240:243]
    v_mfma_f32_16x16x32_bf16 v[244:247], a[152:155], v[64:67], v[244:247]
    v_mfma_f32_16x16x32_bf16 v[248:251], a[156:159], v[64:67], v[248:251]
    s_waitcnt vmcnt(3)
    v_mfma_f32_16x16x32_bf16 v[232:235], a[160:163], v[68:71], v[232:235]
    v_mfma_f32_16x16x32_bf16 v[236:239], a[164:167], v[68:71], v[236:239]
    v_mfma_f32_16x16x32_bf16 v[240:243], a[168:171], v[68:71], v[240:243]
    v_mfma_f32_16x16x32_bf16 v[244:247], a[172:175], v[68:71], v[244:247]
    v_mfma_f32_16x16x32_bf16 v[248:251], a[176:179], v[68:71], v[248:251]
    s_waitcnt vmcnt(2)
    v_mfma_f32_16x16x32_bf16 v[232:235], a[180:183], v[72:75], v[232:235]
    v_mfma_f32_16x16x32_bf16 v[236:239], a[184:187], v[72:75], v[236:239]
    v_mfma_f32_16x16x32_bf16 v[240:243], a[188:191], v[72:75], v[240:243]
    v_mfma_f32_16x16x32_bf16 v[244:247], a[192:195], v[72:75], v[244:247]
    v_mfma_f32_16x16x32_bf16 v[248:251], a[196:199], v[72:75], v[248:251]
    buffer_load_dwordx4 v[104:107], v252, s[12:15], s88 offen offset:0 sc1
    buffer_load_dwordx4 v[120:123], v252, s[12:15], s88 offen offset:1024 sc1
    buffer_load_dwordx4 v[136:139], v252, s[12:15], s88 offen offset:2048 sc1
    buffer_load_dwordx4 v[152:155], v252, s[12:15], s88 offen offset:3072 sc1
    buffer_load_dwordx4 v[168:171], v252, s[12:15], s89 offen offset:0 sc1
    s_waitcnt vmcnt(6)
    v_mfma_f32_16x16x32_bf16 v[232:235], a[200:203], v[76:79], v[232:235]
    v_mfma_f32_16x16x32_bf16 v[236:239], a[204:207], v[76:79], v[236:239]
    v_mfma_f32_16x16x32_bf16 v[240:243], a[208:211], v[76:79], v[240:243]
    v_mfma_f32_16x16x32_bf16 v[244:247], a[212:215], v[76:79], v[244:247]
    v_mfma_f32_16x16x32_bf16 v[248:251], a[216:219], v[76:79], v[248:251]
    s_waitcnt vmcnt(5)
    v_mfma_f32_16x16x32_bf16 v[232:235], a[220:223], v[80:83], v[232:235]
    v_mfma_f32_16x16x32_bf16 v[236:239], a[224:227], v[80:83], v[236:239]
    v_mfma_f32_16x16x32_bf16 v[240:243], a[228:231], v[80:83], v[240:243]
    v_mfma_f32_16x16x32_bf16 v[244:247], a[232:235], v[80:83], v[244:247]
    v_mfma_f32_16x16x32_bf16 v[248:251], a[236:239], v[80:83], v[248:251]
    s_nop 3
    ds_write_b128 v5, v[232:235] offset:16128
    ds_write_b128 v5, v[236:239] offset:16192
    ds_write_b128 v5, v[240:243] offset:16256
    ds_write_b128 v5, v[244:247] offset:16320
    s_waitcnt lgkmcnt(9)
    ds_write_b128 v5, v[248:251] offset:16384
    s_waitcnt lgkmcnt(0)
    s_barrier
    ds_read_b128 v[172:175], v6 offset:0
    ds_read_b128 v[176:179], v6 offset:21504
    ds_read_b128 v[180:183], v6 offset:43008
    ds_read_b128 v[184:187], v6 offset:64512
    ds_read_b128 v[188:191], v7 offset:0
    ds_read_b128 v[192:195], v7 offset:21504
    ds_read_b128 v[196:199], v7 offset:43008
    ds_read_b128 v[200:203], v7 offset:64512
    ds_read_b128 v[204:207], v8 offset:0
    ds_read_b128 v[208:211], v8 offset:21504
    ds_read_b128 v[212:215], v8 offset:43008
    ds_read_b128 v[216:219], v8 offset:64512
    ds_read_b128 v[220:223], v9 offset:0
    ds_read_b128 v[224:227], v9 offset:21504
    s_waitcnt lgkmcnt(9)
    ds_read_b128 v[228:231], v9 offset:43008
    ds_read_b128 v[232:235], v9 offset:64512
    ds_read_b128 v[236:239], v10 offset:0
    ds_read_b128 v[240:243], v10 offset:21504
    ds_read_b128 v[244:247], v10 offset:43008
    s_waitcnt lgkmcnt(9)
    ds_read_b128 v[248:251], v10 offset:64512
    s_waitcnt vmcnt(0)
    v_xor_b32 v104, s82, v104
    v_xor_b32 v105, s82, v105
    v_or_b32 v1, v104, v105
    v_xor_b32 v106, s82, v106
    v_xor_b32 v107, s82, v107
    v_or3_b32 v1, v106, v107, v1
    v_xor_b32 v120, s82, v120
    v_xor_b32 v121, s82, v121
    v_or3_b32 v1, v120, v121, v1
    v_xor_b32 v122, s82, v122
    v_xor_b32 v123, s82, v123
    v_or3_b32 v1, v122, v123, v1
    v_xor_b32 v136, s82, v136
    v_xor_b32 v137, s82, v137
    v_or3_b32 v1, v136, v137, v1
    v_xor_b32 v138, s82, v138
    v_xor_b32 v139, s82, v139
    v_or3_b32 v1, v138, v139, v1
    v_xor_b32 v152, s82, v152
    v_xor_b32 v153, s82, v153
    v_or3_b32 v1, v152, v153, v1
    v_xor_b32 v154, s82, v154
    v_xor_b32 v155, s82, v155
    v_or3_b32 v1, v154, v155, v1
    v_xor_b32 v168, s82, v168
    v_xor_b32 v169, s82, v169
    v_or3_b32 v1, v168, v169, v1
    v_xor_b32 v170, s82, v170
    v_xor_b32 v171, s82, v171
    v_or3_b32 v1, v170, v171, v1
    v_and_b32 v1, 3, v1
    v_cmp_ne_u32 vcc, 0, v1
    s_nop 1
    s_cbranch_vccnz pp79
ppd80:
    v_pk_add_f32 v[172:173], v[172:173], v[176:177]
    v_pk_add_f32 v[180:181], v[180:181], v[184:185]
    v_pk_add_f32 v[174:175], v[174:175], v[178:179]
    v_pk_add_f32 v[182:183], v[182:183], v[186:187]
    v_pk_add_f32 v[172:173], v[172:173], v[104:105]
    v_pk_add_f32 v[174:175], v[174:175], v[106:107]
    v_pk_add_f32 v[172:173], v[172:173], v[180:181]
    v_pk_add_f32 v[174:175], v[174:175], v[182:183]
    buffer_store_dwordx4 v[172:175], v11, s[16:19], s35 offen sc1
    v_pk_add_f32 v[188:189], v[188:189], v[192:193]
    v_pk_add_f32 v[196:197], v[196:197], v[200:201]
    v_pk_add_f32 v[190:191], v[190:191], v[194:195]
    v_pk_add_f32 v[198:199], v[198:199], v[202:203]
    v_pk_add_f32 v[188:189], v[188:189], v[120:121]
    v_pk_add_f32 v[190:191], v[190:191], v[122:123]
    v_pk_add_f32 v[188:189], v[188:189], v[196:197]
    v_pk_add_f32 v[190:191], v[190:191], v[198:199]
    buffer_store_dwordx4 v[188:191], v12, s[16:19], s35 offen sc1
    s_waitcnt lgkmcnt(8)
    v_pk_add_f32 v[204:205], v[204:205], v[208:209]
    v_pk_add_f32 v[212:213], v[212:213], v[216:217]
    v_pk_add_f32 v[206:207], v[206:207], v[210:211]
    v_pk_add_f32 v[214:215], v[214:215], v[218:219]
    v_pk_add_f32 v[204:205], v[204:205], v[136:137]
    v_pk_add_f32 v[206:207], v[206:207], v[138:139]
    v_pk_add_f32 v[204:205], v[204:205], v[212:213]
    v_pk_add_f32 v[206:207], v[206:207], v[214:215]
    buffer_store_dwordx4 v[204:207], v13, s[16:19], s35 offen sc1
    s_waitcnt lgkmcnt(4)
    v_pk_add_f32 v[220:221], v[220:221], v[224:225]
    v_pk_add_f32 v[228:229], v[228:229], v[232:233]
    v_pk_add_f32 v[222:223], v[222:223], v[226:227]
    v_pk_add_f32 v[230:231], v[230:231], v[234:235]
    v_pk_add_f32 v[220:221], v[220:221], v[152:153]
    v_pk_add_f32 v[222:223], v[222:223], v[154:155]
    v_pk_add_f32 v[220:221], v[220:221], v[228:229]
    v_pk_add_f32 v[222:223], v[222:223], v[230:231]
    buffer_store_dwordx4 v[220:223], v14, s[16:19], s35 offen sc1
    s_waitcnt lgkmcnt(0)
    v_pk_add_f32 v[236:237], v[236:237], v[240:241]
    v_pk_add_f32 v[244:245], v[244:245], v[248:249]
    v_pk_add_f32 v[238:239], v[238:239], v[242:243]
    v_pk_add_f32 v[246:247], v[246:247], v[250:251]
    v_pk_add_f32 v[236:237], v[236:237], v[168:169]
    v_pk_add_f32 v[238:239], v[238:239], v[170:171]
    v_pk_add_f32 v[236:237], v[236:237], v[244:245]
    v_pk_add_f32 v[238:239], v[238:239], v[246:247]
    buffer_store_dwordx4 v[236:239], v15, s[16:19], s35 offen sc1
    s_endpgm
pb49:
    s_mov_b32 s63, 100000
pb49t81:
    buffer_load_dword v254, v253, s[12:15], s60 offen sc1
    s_waitcnt vmcnt(0)
    v_cmp_ne_u32 vcc, s28, v254
    s_nop 1
    s_cbranch_vccz pbd50
    s_sub_u32 s63, s63, 1
    s_cmp_lg_u32 s63, 0
    s_cbranch_scc1 pb49t81
    s_branch pbd50
ps51:
    s_mov_b32 s63, 100000
ps51t82:
    buffer_load_dwordx4 v[168:171], v10, s[12:15], s57 offen sc1
    buffer_load_dwordx4 v[172:175], v10, s[12:15], s57 offen offset:512 sc1
    s_waitcnt vmcnt(0)
    v_xor_b32 v202, s28, v169
    v_bitop3_b32 v202, s29, v171, v202 bitop3:0xbe
    v_bitop3_b32 v202, s28, v173, v202 bitop3:0xbe
    v_bitop3_b32 v202, s29, v175, v202 bitop3:0xbe
    v_cmp_ne_u32 vcc, 0, v202
    s_nop 1
    s_cbranch_vccz psd52
    s_sub_u32 s63, s63, 1
    s_cmp_lg_u32 s63, 0
    s_cbranch_scc1 ps51t82
    s_branch psd52
va53:
    s_mov_b32 s63, 100000
va53t83:
    buffer_load_dwordx4 v[16:19], v252, s[12:15], s36 offen offset:0 sc1
    buffer_load_dwordx4 v[20:23], v252, s[12:15], s37 offen offset:0 sc1
    buffer_load_dwordx4 v[24:27], v252, s[12:15], s38 offen offset:0 sc1
    buffer_load_dwordx4 v[28:31], v252, s[12:15], s39 offen offset:0 sc1
    buffer_load_dwordx4 v[32:35], v252, s[12:15], s36 offen offset:3072 sc1
    buffer_load_dwordx4 v[36:39], v252, s[12:15], s37 offen offset:3072 sc1
    buffer_load_dwordx4 v[40:43], v252, s[12:15], s38 offen offset:3072 sc1
    buffer_load_dwordx4 v[44:47], v252, s[12:15], s39 offen offset:3072 sc1
    s_add_u32 s45, s36, 4096
    buffer_load_dwordx4 v[48:51], v252, s[12:15], s45 offen offset:2048 sc1
    s_add_u32 s45, s37, 4096
    buffer_load_dwordx4 v[52:55], v252, s[12:15], s45 offen offset:2048 sc1
    s_add_u32 s45, s38, 4096
    buffer_load_dwordx4 v[56:59], v252, s[12:15], s45 offen offset:2048 sc1
    s_add_u32 s45, s39, 4096
    buffer_load_dwordx4 v[60:63], v252, s[12:15], s45 offen offset:2048 sc1
    s_add_u32 s45, s36, 8192
    buffer_load_dwordx4 v[64:67], v252, s[12:15], s45 offen offset:1024 sc1
    s_add_u32 s45, s37, 8192
    buffer_load_dwordx4 v[68:71], v252, s[12:15], s45 offen offset:1024 sc1
    s_add_u32 s45, s38, 8192
    buffer_load_dwordx4 v[72:75], v252, s[12:15], s45 offen offset:1024 sc1
    s_add_u32 s45, s39, 8192
    buffer_load_dwordx4 v[76:79], v252, s[12:15], s45 offen offset:1024 sc1
    s_waitcnt vmcnt(0)
    v_xor_b32 v16, s32, v16
    v_xor_b32 v17, s32, v17
    v_or_b32 v1, v16, v17
    v_xor_b32 v18, s32, v18
    v_xor_b32 v19, s32, v19
    v_or3_b32 v1, v18, v19, v1
    v_xor_b32 v20, s32, v20
    v_xor_b32 v21, s32, v21
    v_or3_b32 v1, v20, v21, v1
    v_xor_b32 v22, s32, v22
    v_xor_b32 v23, s32, v23
    v_or3_b32 v1, v22, v23, v1
    v_xor_b32 v24, s32, v24
    v_xor_b32 v25, s32, v25
    v_or3_b32 v1, v24, v25, v1
    v_xor_b32 v26, s32, v26
    v_xor_b32 v27, s32, v27
    v_or3_b32 v1, v26, v27, v1
    v_xor_b32 v28, s32, v28
    v_xor_b32 v29, s32, v29
    v_or3_b32 v1, v28, v29, v1
    v_xor_b32 v30, s32, v30
    v_xor_b32 v31, s32, v31
    v_or3_b32 v1, v30, v31, v1
    v_and_b32 v1, 0x10001, v1
    v_cmp_ne_u32 vcc, 0, v1
    s_nop 1
    s_cbranch_vccz vad54
    s_sub_u32 s63, s63, 1
    s_cmp_lg_u32 s63, 0
    s_cbranch_scc1 va53t83
    s_branch vad54
va55:
    s_mov_b32 s63, 100000
va55t84:
    buffer_load_dwordx4 v[32:35], v252, s[12:15], s36 offen offset:3072 sc1
    buffer_load_dwordx4 v[36:39], v252, s[12:15], s37 offen offset:3072 sc1
    buffer_load_dwordx4 v[40:43], v252, s[12:15], s38 offen offset:3072 sc1
    buffer_load_dwordx4 v[44:47], v252, s[12:15], s39 offen offset:3072 sc1
    s_add_u32 s45, s36, 4096
    buffer_load_dwordx4 v[48:51], v252, s[12:15], s45 offen offset:2048 sc1
    s_add_u32 s45, s37, 4096
    buffer_load_dwordx4 v[52:55], v252, s[12:15], s45 offen offset:2048 sc1
    s_add_u32 s45, s38, 4096
    buffer_load_dwordx4 v[56:59], v252, s[12:15], s45 offen offset:2048 sc1
    s_add_u32 s45, s39, 4096
    buffer_load_dwordx4 v[60:63], v252, s[12:15], s45 offen offset:2048 sc1
    s_add_u32 s45, s36, 8192
    buffer_load_dwordx4 v[64:67], v252, s[12:15], s45 offen offset:1024 sc1
    s_add_u32 s45, s37, 8192
    buffer_load_dwordx4 v[68:71], v252, s[12:15], s45 offen offset:1024 sc1
    s_add_u32 s45, s38, 8192
    buffer_load_dwordx4 v[72:75], v252, s[12:15], s45 offen offset:1024 sc1
    s_add_u32 s45, s39, 8192
    buffer_load_dwordx4 v[76:79], v252, s[12:15], s45 offen offset:1024 sc1
    buffer_load_dwordx4 v[172:175], v252, s[12:15], s36 offen offset:1024 sc1
    buffer_load_dwordx4 v[176:179], v252, s[12:15], s37 offen offset:1024 sc1
    buffer_load_dwordx4 v[180:183], v252, s[12:15], s38 offen offset:1024 sc1
    buffer_load_dwordx4 v[184:187], v252, s[12:15], s39 offen offset:1024 sc1
    s_add_u32 s45, s36, 4096
    buffer_load_dwordx4 v[188:191], v252, s[12:15], s45 offen offset:0 sc1
    s_add_u32 s45, s37, 4096
    buffer_load_dwordx4 v[192:195], v252, s[12:15], s45 offen offset:0 sc1
    s_add_u32 s45, s38, 4096
    buffer_load_dwordx4 v[196:199], v252, s[12:15], s45 offen offset:0 sc1
    s_waitcnt vmcnt(0)
    v_xor_b32 v32, s32, v32
    v_xor_b32 v33, s32, v33
    v_or_b32 v1, v32, v33
    v_xor_b32 v34, s32, v34
    v_xor_b32 v35, s32, v35
    v_or3_b32 v1, v34, v35, v1
    v_xor_b32 v36, s32, v36
    v_xor_b32 v37, s32, v37
    v_or3_b32 v1, v36, v37, v1
    v_xor_b32 v38, s32, v38
    v_xor_b32 v39, s32, v39
    v_or3_b32 v1, v38, v39, v1
    v_xor_b32 v40, s32, v40
    v_xor_b32 v41, s32, v41
    v_or3_b32 v1, v40, v41, v1
    v_xor_b32 v42, s32, v42
    v_xor_b32 v43, s32, v43
    v_or3_b32 v1, v42, v43, v1
    v_xor_b32 v44, s32, v44
    v_xor_b32 v45, s32, v45
    v_or3_b32 v1, v44, v45, v1
    v_xor_b32 v46, s32, v46
    v_xor_b32 v47, s32, v47
    v_or3_b32 v1, v46, v47, v1
    v_and_b32 v1, 0x10001, v1
    v_cmp_ne_u32 vcc, 0, v1
    s_nop 1
    s_cbranch_vccz vad56
    s_sub_u32 s63, s63, 1
    s_cmp_lg_u32 s63, 0
    s_cbranch_scc1 va55t84
    s_branch vad56
va57:
    s_mov_b32 s63, 100000
va57t85:
    s_add_u32 s45, s36, 4096
    buffer_load_dwordx4 v[48:51], v252, s[12:15], s45 offen offset:2048 sc1
    s_add_u32 s45, s37, 4096
    buffer_load_dwordx4 v[52:55], v252, s[12:15], s45 offen offset:2048 sc1
    s_add_u32 s45, s38, 4096
    buffer_load_dwordx4 v[56:59], v252, s[12:15], s45 offen offset:2048 sc1
    s_add_u32 s45, s39, 4096
    buffer_load_dwordx4 v[60:63], v252, s[12:15], s45 offen offset:2048 sc1
    s_add_u32 s45, s36, 8192
    buffer_load_dwordx4 v[64:67], v252, s[12:15], s45 offen offset:1024 sc1
    s_add_u32 s45, s37, 8192
    buffer_load_dwordx4 v[68:71], v252, s[12:15], s45 offen offset:1024 sc1
    s_add_u32 s45, s38, 8192
    buffer_load_dwordx4 v[72:75], v252, s[12:15], s45 offen offset:1024 sc1
    s_add_u32 s45, s39, 8192
    buffer_load_dwordx4 v[76:79], v252, s[12:15], s45 offen offset:1024 sc1
    buffer_load_dwordx4 v[172:175], v252, s[12:15], s36 offen offset:1024 sc1
    buffer_load_dwordx4 v[176:179], v252, s[12:15], s37 offen offset:1024 sc1
    buffer_load_dwordx4 v[180:183], v252, s[12:15], s38 offen offset:1024 sc1
    buffer_load_dwordx4 v[184:187], v252, s[12:15], s39 offen offset:1024 sc1
    s_add_u32 s45, s36, 4096
    buffer_load_dwordx4 v[188:191], v252, s[12:15], s45 offen offset:0 sc1
    s_add_u32 s45, s37, 4096
    buffer_load_dwordx4 v[192:195], v252, s[12:15], s45 offen offset:0 sc1
    s_add_u32 s45, s38, 4096
    buffer_load_dwordx4 v[196:199], v252, s[12:15], s45 offen offset:0 sc1
    s_add_u32 s45, s39, 4096
    buffer_load_dwordx4 v[200:203], v252, s[12:15], s45 offen offset:0 sc1
    s_add_u32 s45, s36, 4096
    buffer_load_dwordx4 v[204:207], v252, s[12:15], s45 offen offset:3072 sc1
    s_add_u32 s45, s37, 4096
    buffer_load_dwordx4 v[208:211], v252, s[12:15], s45 offen offset:3072 sc1
    s_add_u32 s45, s38, 4096
    buffer_load_dwordx4 v[212:215], v252, s[12:15], s45 offen offset:3072 sc1
    s_add_u32 s45, s39, 4096
    buffer_load_dwordx4 v[216:219], v252, s[12:15], s45 offen offset:3072 sc1
    s_add_u32 s45, s36, 8192
    buffer_load_dwordx4 v[220:223], v252, s[12:15], s45 offen offset:2048 sc1
    s_waitcnt vmcnt(0)
    v_xor_b32 v48, s32, v48
    v_xor_b32 v49, s32, v49
    v_or_b32 v1, v48, v49
    v_xor_b32 v50, s32, v50
    v_xor_b32 v51, s32, v51
    v_or3_b32 v1, v50, v51, v1
    v_xor_b32 v52, s32, v52
    v_xor_b32 v53, s32, v53
    v_or3_b32 v1, v52, v53, v1
    v_xor_b32 v54, s32, v54
    v_xor_b32 v55, s32, v55
    v_or3_b32 v1, v54, v55, v1
    v_xor_b32 v56, s32, v56
    v_xor_b32 v57, s32, v57
    v_or3_b32 v1, v56, v57, v1
    v_xor_b32 v58, s32, v58
    v_xor_b32 v59, s32, v59
    v_or3_b32 v1, v58, v59, v1
    v_xor_b32 v60, s32, v60
    v_xor_b32 v61, s32, v61
    v_or3_b32 v1, v60, v61, v1
    v_xor_b32 v62, s32, v62
    v_xor_b32 v63, s32, v63
    v_or3_b32 v1, v62, v63, v1
    v_and_b32 v1, 0x10001, v1
    v_cmp_ne_u32 vcc, 0, v1
    s_nop 1
    s_cbranch_vccz vad58
    s_sub_u32 s63, s63, 1
    s_cmp_lg_u32 s63, 0
    s_cbranch_scc1 va57t85
    s_branch vad58
va59:
    s_mov_b32 s63, 100000
va59t86:
    s_add_u32 s45, s36, 8192
    buffer_load_dwordx4 v[64:67], v252, s[12:15], s45 offen offset:1024 sc1
    s_add_u32 s45, s37, 8192
    buffer_load_dwordx4 v[68:71], v252, s[12:15], s45 offen offset:1024 sc1
    s_add_u32 s45, s38, 8192
    buffer_load_dwordx4 v[72:75], v252, s[12:15], s45 offen offset:1024 sc1
    s_add_u32 s45, s39, 8192
    buffer_load_dwordx4 v[76:79], v252, s[12:15], s45 offen offset:1024 sc1
    buffer_load_dwordx4 v[172:175], v252, s[12:15], s36 offen offset:1024 sc1
    buffer_load_dwordx4 v[176:179], v252, s[12:15], s37 offen offset:1024 sc1
    buffer_load_dwordx4 v[180:183], v252, s[12:15], s38 offen offset:1024 sc1
    buffer_load_dwordx4 v[184:187], v252, s[12:15], s39 offen offset:1024 sc1
    s_add_u32 s45, s36, 4096
    buffer_load_dwordx4 v[188:191], v252, s[12:15], s45 offen offset:0 sc1
    s_add_u32 s45, s37, 4096
    buffer_load_dwordx4 v[192:195], v252, s[12:15], s45 offen offset:0 sc1
    s_add_u32 s45, s38, 4096
    buffer_load_dwordx4 v[196:199], v252, s[12:15], s45 offen offset:0 sc1
    s_add_u32 s45, s39, 4096
    buffer_load_dwordx4 v[200:203], v252, s[12:15], s45 offen offset:0 sc1
    s_add_u32 s45, s36, 4096
    buffer_load_dwordx4 v[204:207], v252, s[12:15], s45 offen offset:3072 sc1
    s_add_u32 s45, s37, 4096
    buffer_load_dwordx4 v[208:211], v252, s[12:15], s45 offen offset:3072 sc1
    s_add_u32 s45, s38, 4096
    buffer_load_dwordx4 v[212:215], v252, s[12:15], s45 offen offset:3072 sc1
    s_add_u32 s45, s39, 4096
    buffer_load_dwordx4 v[216:219], v252, s[12:15], s45 offen offset:3072 sc1
    s_add_u32 s45, s36, 8192
    buffer_load_dwordx4 v[220:223], v252, s[12:15], s45 offen offset:2048 sc1
    s_add_u32 s45, s37, 8192
    buffer_load_dwordx4 v[224:227], v252, s[12:15], s45 offen offset:2048 sc1
    s_add_u32 s45, s38, 8192
    buffer_load_dwordx4 v[228:231], v252, s[12:15], s45 offen offset:2048 sc1
    s_add_u32 s45, s39, 8192
    buffer_load_dwordx4 v[232:235], v252, s[12:15], s45 offen offset:2048 sc1
    s_waitcnt vmcnt(0)
    v_xor_b32 v64, s32, v64
    v_xor_b32 v65, s32, v65
    v_or_b32 v1, v64, v65
    v_xor_b32 v66, s32, v66
    v_xor_b32 v67, s32, v67
    v_or3_b32 v1, v66, v67, v1
    v_xor_b32 v68, s32, v68
    v_xor_b32 v69, s32, v69
    v_or3_b32 v1, v68, v69, v1
    v_xor_b32 v70, s32, v70
    v_xor_b32 v71, s32, v71
    v_or3_b32 v1, v70, v71, v1
    v_xor_b32 v72, s32, v72
    v_xor_b32 v73, s32, v73
    v_or3_b32 v1, v72, v73, v1
    v_xor_b32 v74, s32, v74
    v_xor_b32 v75, s32, v75
    v_or3_b32 v1, v74, v75, v1
    v_xor_b32 v76, s32, v76
    v_xor_b32 v77, s32, v77
    v_or3_b32 v1, v76, v77, v1
    v_xor_b32 v78, s32, v78
    v_xor_b32 v79, s32, v79
    v_or3_b32 v1, v78, v79, v1
    v_and_b32 v1, 0x10001, v1
    v_cmp_ne_u32 vcc, 0, v1
    s_nop 1
    s_cbranch_vccz vad60
    s_sub_u32 s63, s63, 1
    s_cmp_lg_u32 s63, 0
    s_cbranch_scc1 va59t86
    s_branch vad60
va61:
    s_mov_b32 s63, 100000
va61t87:
    buffer_load_dwordx4 v[172:175], v252, s[12:15], s36 offen offset:1024 sc1
    buffer_load_dwordx4 v[176:179], v252, s[12:15], s37 offen offset:1024 sc1
    buffer_load_dwordx4 v[180:183], v252, s[12:15], s38 offen offset:1024 sc1
    buffer_load_dwordx4 v[184:187], v252, s[12:15], s39 offen offset:1024 sc1
    s_add_u32 s45, s36, 4096
    buffer_load_dwordx4 v[188:191], v252, s[12:15], s45 offen offset:0 sc1
    s_add_u32 s45, s37, 4096
    buffer_load_dwordx4 v[192:195], v252, s[12:15], s45 offen offset:0 sc1
    s_add_u32 s45, s38, 4096
    buffer_load_dwordx4 v[196:199], v252, s[12:15], s45 offen offset:0 sc1
    s_add_u32 s45, s39, 4096
    buffer_load_dwordx4 v[200:203], v252, s[12:15], s45 offen offset:0 sc1
    s_add_u32 s45, s36, 4096
    buffer_load_dwordx4 v[204:207], v252, s[12:15], s45 offen offset:3072 sc1
    s_add_u32 s45, s37, 4096
    buffer_load_dwordx4 v[208:211], v252, s[12:15], s45 offen offset:3072 sc1
    s_add_u32 s45, s38, 4096
    buffer_load_dwordx4 v[212:215], v252, s[12:15], s45 offen offset:3072 sc1
    s_add_u32 s45, s39, 4096
    buffer_load_dwordx4 v[216:219], v252, s[12:15], s45 offen offset:3072 sc1
    s_add_u32 s45, s36, 8192
    buffer_load_dwordx4 v[220:223], v252, s[12:15], s45 offen offset:2048 sc1
    s_add_u32 s45, s37, 8192
    buffer_load_dwordx4 v[224:227], v252, s[12:15], s45 offen offset:2048 sc1
    s_add_u32 s45, s38, 8192
    buffer_load_dwordx4 v[228:231], v252, s[12:15], s45 offen offset:2048 sc1
    s_add_u32 s45, s39, 8192
    buffer_load_dwordx4 v[232:235], v252, s[12:15], s45 offen offset:2048 sc1
    buffer_load_dwordx4 v[236:239], v252, s[12:15], s36 offen offset:2048 sc1
    buffer_load_dwordx4 v[240:243], v252, s[12:15], s37 offen offset:2048 sc1
    buffer_load_dwordx4 v[244:247], v252, s[12:15], s38 offen offset:2048 sc1
    buffer_load_dwordx4 v[248:251], v252, s[12:15], s39 offen offset:2048 sc1
    s_add_u32 s45, s36, 4096
    buffer_load_dwordx4 v[80:83], v252, s[12:15], s45 offen offset:1024 sc1
    s_waitcnt vmcnt(0)
    v_xor_b32 v172, s32, v172
    v_xor_b32 v173, s32, v173
    v_or_b32 v1, v172, v173
    v_xor_b32 v174, s32, v174
    v_xor_b32 v175, s32, v175
    v_or3_b32 v1, v174, v175, v1
    v_xor_b32 v176, s32, v176
    v_xor_b32 v177, s32, v177
    v_or3_b32 v1, v176, v177, v1
    v_xor_b32 v178, s32, v178
    v_xor_b32 v179, s32, v179
    v_or3_b32 v1, v178, v179, v1
    v_xor_b32 v180, s32, v180
    v_xor_b32 v181, s32, v181
    v_or3_b32 v1, v180, v181, v1
    v_xor_b32 v182, s32, v182
    v_xor_b32 v183, s32, v183
    v_or3_b32 v1, v182, v183, v1
    v_xor_b32 v184, s32, v184
    v_xor_b32 v185, s32, v185
    v_or3_b32 v1, v184, v185, v1
    v_xor_b32 v186, s32, v186
    v_xor_b32 v187, s32, v187
    v_or3_b32 v1, v186, v187, v1
    v_and_b32 v1, 0x10001, v1
    v_cmp_ne_u32 vcc, 0, v1
    s_nop 1
    s_cbranch_vccz vad62
    s_sub_u32 s63, s63, 1
    s_cmp_lg_u32 s63, 0
    s_cbranch_scc1 va61t87
    s_branch vad62
va63:
    s_mov_b32 s63, 100000
va63t88:
    s_add_u32 s45, s36, 4096
    buffer_load_dwordx4 v[188:191], v252, s[12:15], s45 offen offset:0 sc1
    s_add_u32 s45, s37, 4096
    buffer_load_dwordx4 v[192:195], v252, s[12:15], s45 offen offset:0 sc1
    s_add_u32 s45, s38, 4096
    buffer_load_dwordx4 v[196:199], v252, s[12:15], s45 offen offset:0 sc1
    s_add_u32 s45, s39, 4096
    buffer_load_dwordx4 v[200:203], v252, s[12:15], s45 offen offset:0 sc1
    s_add_u32 s45, s36, 4096
    buffer_load_dwordx4 v[204:207], v252, s[12:15], s45 offen offset:3072 sc1
    s_add_u32 s45, s37, 4096
    buffer_load_dwordx4 v[208:211], v252, s[12:15], s45 offen offset:3072 sc1
    s_add_u32 s45, s38, 4096
    buffer_load_dwordx4 v[212:215], v252, s[12:15], s45 offen offset:3072 sc1
    s_add_u32 s45, s39, 4096
    buffer_load_dwordx4 v[216:219], v252, s[12:15], s45 offen offset:3072 sc1
    s_add_u32 s45, s36, 8192
    buffer_load_dwordx4 v[220:223], v252, s[12:15], s45 offen offset:2048 sc1
    s_add_u32 s45, s37, 8192
    buffer_load_dwordx4 v[224:227], v252, s[12:15], s45 offen offset:2048 sc1
    s_add_u32 s45, s38, 8192
    buffer_load_dwordx4 v[228:231], v252, s[12:15], s45 offen offset:2048 sc1
    s_add_u32 s45, s39, 8192
    buffer_load_dwordx4 v[232:235], v252, s[12:15], s45 offen offset:2048 sc1
    buffer_load_dwordx4 v[236:239], v252, s[12:15], s36 offen offset:2048 sc1
    buffer_load_dwordx4 v[240:243], v252, s[12:15], s37 offen offset:2048 sc1
    buffer_load_dwordx4 v[244:247], v252, s[12:15], s38 offen offset:2048 sc1
    buffer_load_dwordx4 v[248:251], v252, s[12:15], s39 offen offset:2048 sc1
    s_add_u32 s45, s36, 4096
    buffer_load_dwordx4 v[80:83], v252, s[12:15], s45 offen offset:1024 sc1
    s_add_u32 s45, s37, 4096
    buffer_load_dwordx4 v[84:87], v252, s[12:15], s45 offen offset:1024 sc1
    s_add_u32 s45, s38, 4096
    buffer_load_dwordx4 v[172:175], v252, s[12:15], s45 offen offset:1024 sc1
    s_add_u32 s45, s39, 4096
    buffer_load_dwordx4 v[176:179], v252, s[12:15], s45 offen offset:1024 sc1
    s_add_u32 s45, s36, 8192
    buffer_load_dwordx4 v[88:91], v252, s[12:15], s45 offen offset:0 sc1
    s_waitcnt vmcnt(0)
    v_xor_b32 v188, s32, v188
    v_xor_b32 v189, s32, v189
    v_or_b32 v1, v188, v189
    v_xor_b32 v190, s32, v190
    v_xor_b32 v191, s32, v191
    v_or3_b32 v1, v190, v191, v1
    v_xor_b32 v192, s32, v192
    v_xor_b32 v193, s32, v193
    v_or3_b32 v1, v192, v193, v1
    v_xor_b32 v194, s32, v194
    v_xor_b32 v195, s32, v195
    v_or3_b32 v1, v194, v195, v1
    v_xor_b32 v196, s32, v196
    v_xor_b32 v197, s32, v197
    v_or3_b32 v1, v196, v197, v1
    v_xor_b32 v198, s32, v198
    v_xor_b32 v199, s32, v199
    v_or3_b32 v1, v198, v199, v1
    v_xor_b32 v200, s32, v200
    v_xor_b32 v201, s32, v201
    v_or3_b32 v1, v200, v201, v1
    v_xor_b32 v202, s32, v202
    v_xor_b32 v203, s32, v203
    v_or3_b32 v1, v202, v203, v1
    v_and_b32 v1, 0x10001, v1
    v_cmp_ne_u32 vcc, 0, v1
    s_nop 1
    s_cbranch_vccz vad64
    s_sub_u32 s63, s63, 1
    s_cmp_lg_u32 s63, 0
    s_cbranch_scc1 va63t88
    s_branch vad64
va65:
    s_mov_b32 s63, 100000
va65t89:
    s_add_u32 s45, s36, 4096
    buffer_load_dwordx4 v[204:207], v252, s[12:15], s45 offen offset:3072 sc1
    s_add_u32 s45, s37, 4096
    buffer_load_dwordx4 v[208:211], v252, s[12:15], s45 offen offset:3072 sc1
    s_add_u32 s45, s38, 4096
    buffer_load_dwordx4 v[212:215], v252, s[12:15], s45 offen offset:3072 sc1
    s_add_u32 s45, s39, 4096
    buffer_load_dwordx4 v[216:219], v252, s[12:15], s45 offen offset:3072 sc1
    s_add_u32 s45, s36, 8192
    buffer_load_dwordx4 v[220:223], v252, s[12:15], s45 offen offset:2048 sc1
    s_add_u32 s45, s37, 8192
    buffer_load_dwordx4 v[224:227], v252, s[12:15], s45 offen offset:2048 sc1
    s_add_u32 s45, s38, 8192
    buffer_load_dwordx4 v[228:231], v252, s[12:15], s45 offen offset:2048 sc1
    s_add_u32 s45, s39, 8192
    buffer_load_dwordx4 v[232:235], v252, s[12:15], s45 offen offset:2048 sc1
    buffer_load_dwordx4 v[236:239], v252, s[12:15], s36 offen offset:2048 sc1
    buffer_load_dwordx4 v[240:243], v252, s[12:15], s37 offen offset:2048 sc1
    buffer_load_dwordx4 v[244:247], v252, s[12:15], s38 offen offset:2048 sc1
    buffer_load_dwordx4 v[248:251], v252, s[12:15], s39 offen offset:2048 sc1
    s_add_u32 s45, s36, 4096
    buffer_load_dwordx4 v[80:83], v252, s[12:15], s45 offen offset:1024 sc1
    s_add_u32 s45, s37, 4096
    buffer_load_dwordx4 v[84:87], v252, s[12:15], s45 offen offset:1024 sc1
    s_add_u32 s45, s38, 4096
    buffer_load_dwordx4 v[172:175], v252, s[12:15], s45 offen offset:1024 sc1
    s_add_u32 s45, s39, 4096
    buffer_load_dwordx4 v[176:179], v252, s[12:15], s45 offen offset:1024 sc1
    s_add_u32 s45, s36, 8192
    buffer_load_dwordx4 v[88:91], v252, s[12:15], s45 offen offset:0 sc1
    s_add_u32 s45, s37, 8192
    buffer_load_dwordx4 v[16:19], v252, s[12:15], s45 offen offset:0 sc1
    s_add_u32 s45, s38, 8192
    buffer_load_dwordx4 v[20:23], v252, s[12:15], s45 offen offset:0 sc1
    s_add_u32 s45, s39, 8192
    buffer_load_dwordx4 v[24:27], v252, s[12:15], s45 offen offset:0 sc1
    s_add_u32 s45, s36, 8192
    buffer_load_dwordx4 v[28:31], v252, s[12:15], s45 offen offset:3072 sc1
    s_waitcnt vmcnt(0)
    v_xor_b32 v204, s32, v204
    v_xor_b32 v205, s32, v205
    v_or_b32 v1, v204, v205
    v_xor_b32 v206, s32, v206
    v_xor_b32 v207, s32, v207
    v_or3_b32 v1, v206, v207, v1
    v_xor_b32 v208, s32, v208
    v_xor_b32 v209, s32, v209
    v_or3_b32 v1, v208, v209, v1
    v_xor_b32 v210, s32, v210
    v_xor_b32 v211, s32, v211
    v_or3_b32 v1, v210, v211, v1
    v_xor_b32 v212, s32, v212
    v_xor_b32 v213, s32, v213
    v_or3_b32 v1, v212, v213, v1
    v_xor_b32 v214, s32, v214
    v_xor_b32 v215, s32, v215
    v_or3_b32 v1, v214, v215, v1
    v_xor_b32 v216, s32, v216
    v_xor_b32 v217, s32, v217
    v_or3_b32 v1, v216, v217, v1
    v_xor_b32 v218, s32, v218
    v_xor_b32 v219, s32, v219
    v_or3_b32 v1, v218, v219, v1
    v_and_b32 v1, 0x10001, v1
    v_cmp_ne_u32 vcc, 0, v1
    s_nop 1
    s_cbranch_vccz vad66
    s_sub_u32 s63, s63, 1
    s_cmp_lg_u32 s63, 0
    s_cbranch_scc1 va65t89
    s_branch vad66
va67:
    s_mov_b32 s63, 100000
va67t90:
    s_add_u32 s45, s36, 8192
    buffer_load_dwordx4 v[220:223], v252, s[12:15], s45 offen offset:2048 sc1
    s_add_u32 s45, s37, 8192
    buffer_load_dwordx4 v[224:227], v252, s[12:15], s45 offen offset:2048 sc1
    s_add_u32 s45, s38, 8192
    buffer_load_dwordx4 v[228:231], v252, s[12:15], s45 offen offset:2048 sc1
    s_add_u32 s45, s39, 8192
    buffer_load_dwordx4 v[232:235], v252, s[12:15], s45 offen offset:2048 sc1
    buffer_load_dwordx4 v[236:239], v252, s[12:15], s36 offen offset:2048 sc1
    buffer_load_dwordx4 v[240:243], v252, s[12:15], s37 offen offset:2048 sc1
    buffer_load_dwordx4 v[244:247], v252, s[12:15], s38 offen offset:2048 sc1
    buffer_load_dwordx4 v[248:251], v252, s[12:15], s39 offen offset:2048 sc1
    s_add_u32 s45, s36, 4096
    buffer_load_dwordx4 v[80:83], v252, s[12:15], s45 offen offset:1024 sc1
    s_add_u32 s45, s37, 4096
    buffer_load_dwordx4 v[84:87], v252, s[12:15], s45 offen offset:1024 sc1
    s_add_u32 s45, s38, 4096
    buffer_load_dwordx4 v[172:175], v252, s[12:15], s45 offen offset:1024 sc1
    s_add_u32 s45, s39, 4096
    buffer_load_dwordx4 v[176:179], v252, s[12:15], s45 offen offset:1024 sc1
    s_add_u32 s45, s36, 8192
    buffer_load_dwordx4 v[88:91], v252, s[12:15], s45 offen offset:0 sc1
    s_add_u32 s45, s37, 8192
    buffer_load_dwordx4 v[16:19], v252, s[12:15], s45 offen offset:0 sc1
    s_add_u32 s45, s38, 8192
    buffer_load_dwordx4 v[20:23], v252, s[12:15], s45 offen offset:0 sc1
    s_add_u32 s45, s39, 8192
    buffer_load_dwordx4 v[24:27], v252, s[12:15], s45 offen offset:0 sc1
    s_add_u32 s45, s36, 8192
    buffer_load_dwordx4 v[28:31], v252, s[12:15], s45 offen offset:3072 sc1
    s_add_u32 s45, s37, 8192
    buffer_load_dwordx4 v[32:35], v252, s[12:15], s45 offen offset:3072 sc1
    s_add_u32 s45, s38, 8192
    buffer_load_dwordx4 v[36:39], v252, s[12:15], s45 offen offset:3072 sc1
    s_add_u32 s45, s39, 8192
    buffer_load_dwordx4 v[40:43], v252, s[12:15], s45 offen offset:3072 sc1
    s_waitcnt vmcnt(0)
    v_xor_b32 v220, s32, v220
    v_xor_b32 v221, s32, v221
    v_or_b32 v1, v220, v221
    v_xor_b32 v222, s32, v222
    v_xor_b32 v223, s32, v223
    v_or3_b32 v1, v222, v223, v1
    v_xor_b32 v224, s32, v224
    v_xor_b32 v225, s32, v225
    v_or3_b32 v1, v224, v225, v1
    v_xor_b32 v226, s32, v226
    v_xor_b32 v227, s32, v227
    v_or3_b32 v1, v226, v227, v1
    v_xor_b32 v228, s32, v228
    v_xor_b32 v229, s32, v229
    v_or3_b32 v1, v228, v229, v1
    v_xor_b32 v230, s32, v230
    v_xor_b32 v231, s32, v231
    v_or3_b32 v1, v230, v231, v1
    v_xor_b32 v232, s32, v232
    v_xor_b32 v233, s32, v233
    v_or3_b32 v1, v232, v233, v1
    v_xor_b32 v234, s32, v234
    v_xor_b32 v235, s32, v235
    v_or3_b32 v1, v234, v235, v1
    v_and_b32 v1, 0x10001, v1
    v_cmp_ne_u32 vcc, 0, v1
    s_nop 1
    s_cbranch_vccz vad68
    s_sub_u32 s63, s63, 1
    s_cmp_lg_u32 s63, 0
    s_cbranch_scc1 va67t90
    s_branch vad68
va69:
    s_mov_b32 s63, 100000
va69t91:
    buffer_load_dwordx4 v[236:239], v252, s[12:15], s36 offen offset:2048 sc1
    buffer_load_dwordx4 v[240:243], v252, s[12:15], s37 offen offset:2048 sc1
    buffer_load_dwordx4 v[244:247], v252, s[12:15], s38 offen offset:2048 sc1
    buffer_load_dwordx4 v[248:251], v252, s[12:15], s39 offen offset:2048 sc1
    s_add_u32 s45, s36, 4096
    buffer_load_dwordx4 v[80:83], v252, s[12:15], s45 offen offset:1024 sc1
    s_add_u32 s45, s37, 4096
    buffer_load_dwordx4 v[84:87], v252, s[12:15], s45 offen offset:1024 sc1
    s_add_u32 s45, s38, 4096
    buffer_load_dwordx4 v[172:175], v252, s[12:15], s45 offen offset:1024 sc1
    s_add_u32 s45, s39, 4096
    buffer_load_dwordx4 v[176:179], v252, s[12:15], s45 offen offset:1024 sc1
    s_add_u32 s45, s36, 8192
    buffer_load_dwordx4 v[88:91], v252, s[12:15], s45 offen offset:0 sc1
    s_add_u32 s45, s37, 8192
    buffer_load_dwordx4 v[16:19], v252, s[12:15], s45 offen offset:0 sc1
    s_add_u32 s45, s38, 8192
    buffer_load_dwordx4 v[20:23], v252, s[12:15], s45 offen offset:0 sc1
    s_add_u32 s45, s39, 8192
    buffer_load_dwordx4 v[24:27], v252, s[12:15], s45 offen offset:0 sc1
    s_add_u32 s45, s36, 8192
    buffer_load_dwordx4 v[28:31], v252, s[12:15], s45 offen offset:3072 sc1
    s_add_u32 s45, s37, 8192
    buffer_load_dwordx4 v[32:35], v252, s[12:15], s45 offen offset:3072 sc1
    s_add_u32 s45, s38, 8192
    buffer_load_dwordx4 v[36:39], v252, s[12:15], s45 offen offset:3072 sc1
    s_add_u32 s45, s39, 8192
    buffer_load_dwordx4 v[40:43], v252, s[12:15], s45 offen offset:3072 sc1
    s_waitcnt vmcnt(0)
    v_xor_b32 v236, s32, v236
    v_xor_b32 v237, s32, v237
    v_or_b32 v1, v236, v237
    v_xor_b32 v238, s32, v238
    v_xor_b32 v239, s32, v239
    v_or3_b32 v1, v238, v239, v1
    v_xor_b32 v240, s32, v240
    v_xor_b32 v241, s32, v241
    v_or3_b32 v1, v240, v241, v1
    v_xor_b32 v242, s32, v242
    v_xor_b32 v243, s32, v243
    v_or3_b32 v1, v242, v243, v1
    v_xor_b32 v244, s32, v244
    v_xor_b32 v245, s32, v245
    v_or3_b32 v1, v244, v245, v1
    v_xor_b32 v246, s32, v246
    v_xor_b32 v247, s32, v247
    v_or3_b32 v1, v246, v247, v1
    v_xor_b32 v248, s32, v248
    v_xor_b32 v249, s32, v249
    v_or3_b32 v1, v248, v249, v1
    v_xor_b32 v250, s32, v250
    v_xor_b32 v251, s32, v251
    v_or3_b32 v1, v250, v251, v1
    v_and_b32 v1, 0x10001, v1
    v_cmp_ne_u32 vcc, 0, v1
    s_nop 1
    s_cbranch_vccz vad70
    s_sub_u32 s63, s63, 1
    s_cmp_lg_u32 s63, 0
    s_cbranch_scc1 va69t91
    s_branch vad70
va71:
    s_mov_b32 s63, 100000
va71t92:
    s_add_u32 s45, s36, 4096
    buffer_load_dwordx4 v[80:83], v252, s[12:15], s45 offen offset:1024 sc1
    s_add_u32 s45, s37, 4096
    buffer_load_dwordx4 v[84:87], v252, s[12:15], s45 offen offset:1024 sc1
    s_add_u32 s45, s38, 4096
    buffer_load_dwordx4 v[172:175], v252, s[12:15], s45 offen offset:1024 sc1
    s_add_u32 s45, s39, 4096
    buffer_load_dwordx4 v[176:179], v252, s[12:15], s45 offen offset:1024 sc1
    s_add_u32 s45, s36, 8192
    buffer_load_dwordx4 v[88:91], v252, s[12:15], s45 offen offset:0 sc1
    s_add_u32 s45, s37, 8192
    buffer_load_dwordx4 v[16:19], v252, s[12:15], s45 offen offset:0 sc1
    s_add_u32 s45, s38, 8192
    buffer_load_dwordx4 v[20:23], v252, s[12:15], s45 offen offset:0 sc1
    s_add_u32 s45, s39, 8192
    buffer_load_dwordx4 v[24:27], v252, s[12:15], s45 offen offset:0 sc1
    s_add_u32 s45, s36, 8192
    buffer_load_dwordx4 v[28:31], v252, s[12:15], s45 offen offset:3072 sc1
    s_add_u32 s45, s37, 8192
    buffer_load_dwordx4 v[32:35], v252, s[12:15], s45 offen offset:3072 sc1
    s_add_u32 s45, s38, 8192
    buffer_load_dwordx4 v[36:39], v252, s[12:15], s45 offen offset:3072 sc1
    s_add_u32 s45, s39, 8192
    buffer_load_dwordx4 v[40:43], v252, s[12:15], s45 offen offset:3072 sc1
    s_waitcnt vmcnt(0)
    v_xor_b32 v80, s32, v80
    v_xor_b32 v81, s32, v81
    v_or_b32 v1, v80, v81
    v_xor_b32 v82, s32, v82
    v_xor_b32 v83, s32, v83
    v_or3_b32 v1, v82, v83, v1
    v_xor_b32 v84, s32, v84
    v_xor_b32 v85, s32, v85
    v_or3_b32 v1, v84, v85, v1
    v_xor_b32 v86, s32, v86
    v_xor_b32 v87, s32, v87
    v_or3_b32 v1, v86, v87, v1
    v_xor_b32 v172, s32, v172
    v_xor_b32 v173, s32, v173
    v_or3_b32 v1, v172, v173, v1
    v_xor_b32 v174, s32, v174
    v_xor_b32 v175, s32, v175
    v_or3_b32 v1, v174, v175, v1
    v_xor_b32 v176, s32, v176
    v_xor_b32 v177, s32, v177
    v_or3_b32 v1, v176, v177, v1
    v_xor_b32 v178, s32, v178
    v_xor_b32 v179, s32, v179
    v_or3_b32 v1, v178, v179, v1
    v_and_b32 v1, 0x10001, v1
    v_cmp_ne_u32 vcc, 0, v1
    s_nop 1
    s_cbranch_vccz vad72
    s_sub_u32 s63, s63, 1
    s_cmp_lg_u32 s63, 0
    s_cbranch_scc1 va71t92
    s_branch vad72
fa73:
    s_mov_b32 s63, 100000
fa73t93:
    buffer_load_dword v4, v2, s[12:15], s95 offen sc1
    s_waitcnt vmcnt(0)
    v_cmp_ne_u32 vcc, s28, v4
    s_nop 1
    s_cbranch_vccz fad74
    s_sub_u32 s63, s63, 1
    s_cmp_lg_u32 s63, 0
    s_cbranch_scc1 fa73t93
    s_branch fad74
va75:
    s_mov_b32 s63, 100000
va75t94:
    s_add_u32 s45, s36, 8192
    buffer_load_dwordx4 v[88:91], v252, s[12:15], s45 offen offset:0 sc1
    s_add_u32 s45, s37, 8192
    buffer_load_dwordx4 v[16:19], v252, s[12:15], s45 offen offset:0 sc1
    s_add_u32 s45, s38, 8192
    buffer_load_dwordx4 v[20:23], v252, s[12:15], s45 offen offset:0 sc1
    s_add_u32 s45, s39, 8192
    buffer_load_dwordx4 v[24:27], v252, s[12:15], s45 offen offset:0 sc1
    s_add_u32 s45, s36, 8192
    buffer_load_dwordx4 v[28:31], v252, s[12:15], s45 offen offset:3072 sc1
    s_add_u32 s45, s37, 8192
    buffer_load_dwordx4 v[32:35], v252, s[12:15], s45 offen offset:3072 sc1
    s_add_u32 s45, s38, 8192
    buffer_load_dwordx4 v[36:39], v252, s[12:15], s45 offen offset:3072 sc1
    s_add_u32 s45, s39, 8192
    buffer_load_dwordx4 v[40:43], v252, s[12:15], s45 offen offset:3072 sc1
    s_waitcnt vmcnt(0)
    v_xor_b32 v88, s32, v88
    v_xor_b32 v89, s32, v89
    v_or_b32 v1, v88, v89
    v_xor_b32 v90, s32, v90
    v_xor_b32 v91, s32, v91
    v_or3_b32 v1, v90, v91, v1
    v_xor_b32 v16, s32, v16
    v_xor_b32 v17, s32, v17
    v_or3_b32 v1, v16, v17, v1
    v_xor_b32 v18, s32, v18
    v_xor_b32 v19, s32, v19
    v_or3_b32 v1, v18, v19, v1
    v_xor_b32 v20, s32, v20
    v_xor_b32 v21, s32, v21
    v_or3_b32 v1, v20, v21, v1
    v_xor_b32 v22, s32, v22
    v_xor_b32 v23, s32, v23
    v_or3_b32 v1, v22, v23, v1
    v_xor_b32 v24, s32, v24
    v_xor_b32 v25, s32, v25
    v_or3_b32 v1, v24, v25, v1
    v_xor_b32 v26, s32, v26
    v_xor_b32 v27, s32, v27
    v_or3_b32 v1, v26, v27, v1
    v_and_b32 v1, 0x10001, v1
    v_cmp_ne_u32 vcc, 0, v1
    s_nop 1
    s_cbranch_vccz vad76
    s_sub_u32 s63, s63, 1
    s_cmp_lg_u32 s63, 0
    s_cbranch_scc1 va75t94
    s_branch vad76
va77:
    s_mov_b32 s63, 100000
va77t95:
    s_add_u32 s45, s36, 8192
    buffer_load_dwordx4 v[28:31], v252, s[12:15], s45 offen offset:3072 sc1
    s_add_u32 s45, s37, 8192
    buffer_load_dwordx4 v[32:35], v252, s[12:15], s45 offen offset:3072 sc1
    s_add_u32 s45, s38, 8192
    buffer_load_dwordx4 v[36:39], v252, s[12:15], s45 offen offset:3072 sc1
    s_add_u32 s45, s39, 8192
    buffer_load_dwordx4 v[40:43], v252, s[12:15], s45 offen offset:3072 sc1
    s_waitcnt vmcnt(0)
    v_xor_b32 v28, s32, v28
    v_xor_b32 v29, s32, v29
    v_or_b32 v1, v28, v29
    v_xor_b32 v30, s32, v30
    v_xor_b32 v31, s32, v31
    v_or3_b32 v1, v30, v31, v1
    v_xor_b32 v32, s32, v32
    v_xor_b32 v33, s32, v33
    v_or3_b32 v1, v32, v33, v1
    v_xor_b32 v34, s32, v34
    v_xor_b32 v35, s32, v35
    v_or3_b32 v1, v34, v35, v1
    v_xor_b32 v36, s32, v36
    v_xor_b32 v37, s32, v37
    v_or3_b32 v1, v36, v37, v1
    v_xor_b32 v38, s32, v38
    v_xor_b32 v39, s32, v39
    v_or3_b32 v1, v38, v39, v1
    v_xor_b32 v40, s32, v40
    v_xor_b32 v41, s32, v41
    v_or3_b32 v1, v40, v41, v1
    v_xor_b32 v42, s32, v42
    v_xor_b32 v43, s32, v43
    v_or3_b32 v1, v42, v43, v1
    v_and_b32 v1, 0x10001, v1
    v_cmp_ne_u32 vcc, 0, v1
    s_nop 1
    s_cbranch_vccz vad78
    s_sub_u32 s63, s63, 1
    s_cmp_lg_u32 s63, 0
    s_cbranch_scc1 va77t95
    s_branch vad78
pp79:
    s_mov_b32 s63, 100000
pp79t96:
    buffer_load_dwordx4 v[104:107], v252, s[12:15], s88 offen offset:0 sc1
    buffer_load_dwordx4 v[120:123], v252, s[12:15], s88 offen offset:1024 sc1
    buffer_load_dwordx4 v[136:139], v252, s[12:15], s88 offen offset:2048 sc1
    buffer_load_dwordx4 v[152:155], v252, s[12:15], s88 offen offset:3072 sc1
    buffer_load_dwordx4 v[168:171], v252, s[12:15], s89 offen offset:0 sc1
    s_waitcnt vmcnt(0)
    v_xor_b32 v104, s82, v104
    v_xor_b32 v105, s82, v105
    v_or_b32 v1, v104, v105
    v_xor_b32 v106, s82, v106
    v_xor_b32 v107, s82, v107
    v_or3_b32 v1, v106, v107, v1
    v_xor_b32 v120, s82, v120
    v_xor_b32 v121, s82, v121
    v_or3_b32 v1, v120, v121, v1
    v_xor_b32 v122, s82, v122
    v_xor_b32 v123, s82, v123
    v_or3_b32 v1, v122, v123, v1
    v_xor_b32 v136, s82, v136
    v_xor_b32 v137, s82, v137
    v_or3_b32 v1, v136, v137, v1
    v_xor_b32 v138, s82, v138
    v_xor_b32 v139, s82, v139
    v_or3_b32 v1, v138, v139, v1
    v_xor_b32 v152, s82, v152
    v_xor_b32 v153, s82, v153
    v_or3_b32 v1, v152, v153, v1
    v_xor_b32 v154, s82, v154
    v_xor_b32 v155, s82, v155
    v_or3_b32 v1, v154, v155, v1
    v_xor_b32 v168, s82, v168
    v_xor_b32 v169, s82, v169
    v_or3_b32 v1, v168, v169, v1
    v_xor_b32 v170, s82, v170
    v_xor_b32 v171, s82, v171
    v_or3_b32 v1, v170, v171, v1
    v_and_b32 v1, 3, v1
    v_cmp_ne_u32 vcc, 0, v1
    s_nop 1
    s_cbranch_vccz ppd80
    s_sub_u32 s63, s63, 1
    s_cmp_lg_u32 s63, 0
    s_cbranch_scc1 pp79t96
    s_branch ppd80
L_end:
    s_endpgm
.section .rodata,"a"
.p2align 6
.amdhsa_kernel parallel_sum__ssm_conv_s5__mixer_channel_mlp__prompt_kernel
  .amdhsa_next_free_vgpr 512
  .amdhsa_next_free_sgpr 102
  .amdhsa_accum_offset 256
  .amdhsa_group_segment_fixed_size 0
  .amdhsa_kernarg_size 136
  .amdhsa_user_sgpr_count 2
  .amdhsa_user_sgpr_kernarg_segment_ptr 1
  .amdhsa_system_sgpr_workgroup_id_x 1
.end_amdhsa_kernel
```
